```python
import torch

def _softmax(x, axis=-1):
    return torch.softmax(x, dim=axis)

def _gelu(x):
    return torch.nn.functional.gelu(x, approximate='tanh')

def _silu(x):
    return torch.nn.functional.silu(x)

def _sigmoid(x):
    return torch.sigmoid(x)

def _layernorm(x, axis=-1, eps=1e-05):
    m = x.mean(dim=axis, keepdim=True)
    v = x.var(dim=axis, keepdim=True, unbiased=False)
    return (x - m) / torch.sqrt(v + eps)

def _scatter_add(tgt, idx, src, axis=0):
    return tgt.clone().index_add_(axis, idx, src)

def _segment_sum(src, seg, n):
    out = torch.zeros((n,) + src.shape[1:], dtype=src.dtype)
    return out.index_add_(0, seg, src)

def _pad(x, pw):
    flat = tuple((v for pair in reversed(pw) for v in pair))
    return torch.nn.functional.pad(x, flat)
kernel_name = 'sequential_preLN__ssm_conv_s4d__mixer_gmlp__prompt'

def setup_inputs():

    _w = lambda a: (lambda t: t.to(torch.bfloat16) if t.is_floating_point() else t)(torch.as_tensor(a))

    def _A_setup():
        Bsz, L, D, N = (1, 2048, 640, 192)
        return {'u': _w((lambda *s: torch.randn(*s, dtype=torch.bfloat16) * 0.05)(Bsz, L, D)), 'log_A_real': _w((lambda *s: torch.randn(*s, dtype=torch.bfloat16) * 6.4)(D, N) * 0.5), 'A_imag': _w((lambda *s: torch.randn(*s, dtype=torch.bfloat16) * 0.05)(D, N) * 3.14), 'C_real': _w((lambda *s: torch.randn(*s, dtype=torch.bfloat16) * 0.05)(D, N) / N ** 0.5), 'C_imag': _w((lambda *s: torch.randn(*s, dtype=torch.bfloat16) * 0.05)(D, N) / N ** 0.5), 'log_dt': _w((lambda *s: torch.randn(*s, dtype=torch.bfloat16) * 0.05)(D) * 0.5 - 4.0), 'D_skip': _w((lambda *s: torch.randn(*s, dtype=torch.bfloat16) * 0.05)(D))}
    _A_in = _A_setup()

    def _B_setup():
        B, S, D, F = (1, 2048, 640, 1536)
        Fh = F // 2
        return {'x': _w((lambda *s: torch.randn(*s, dtype=torch.bfloat16) * 0.05)(B, S, D)), 'w_in': _w((lambda *s: torch.randn(*s, dtype=torch.bfloat16) * 0.4)(D, 2 * Fh)), 'w_sp': _w(0.01 * (lambda *s: torch.randn(*s, dtype=torch.bfloat16) * 0.4)(S, S)), 'b_sp': _w(1.0 + 0.01 * (lambda *s: torch.randn(*s, dtype=torch.bfloat16) * 0.05)(S)), 'w_out': _w((lambda *s: torch.randn(*s, dtype=torch.bfloat16) * 0.05)(Fh, D))}
    _B_in = _B_setup()
    return {'A_u': _A_in['u'], 'A_log_A_real': _A_in['log_A_real'], 'A_A_imag': _A_in['A_imag'], 'A_C_real': _A_in['C_real'], 'A_C_imag': _A_in['C_imag'], 'A_log_dt': _A_in['log_dt'], 'A_D_skip': _A_in['D_skip'], 'B_x': _B_in['x'], 'B_w_in': _B_in['w_in'], 'B_w_sp': _B_in['w_sp'], 'B_b_sp': _B_in['b_sp'], 'B_w_out': _B_in['w_out']}

def reference(A_u, A_log_A_real, A_A_imag, A_C_real, A_C_imag, A_log_dt, A_D_skip, B_x, B_w_in, B_w_sp, B_b_sp, B_w_out):

    def _A_ref(u, log_A_real, A_imag, C_real, C_imag, log_dt, D_skip):
        L = u.shape[1]
        dt = torch.exp(log_dt)
        A = -torch.exp(log_A_real) + 1j * A_imag
        C = (C_real + 1j * C_imag) * dt[:, None]
        pos = (lambda x, dt: x.to(dt))(torch.arange(L), log_dt.dtype)
        P = torch.exp((A * dt[:, None])[:, :, None] * pos[None, None, :])
        K = 2.0 * torch.einsum('dn,dnl->dl', C, P).real
        L2 = 2 * L
        u_t = (lambda x, *d: x.permute(*d))(u, 0, 2, 1)
        Kf = (lambda x, *a, **k: torch.fft.rfft(x.float(), *a, **k))(K, L2)
        Uf = (lambda x, *a, **k: torch.fft.rfft(x.float(), *a, **k))(u_t, L2)
        y = (lambda x, *a, **k: torch.fft.irfft(x, *a, **k).to(torch.bfloat16))(Uf * Kf[None, :, :], L2)[:, :, :L]
        y = (lambda x, *d: x.permute(*d))(y, 0, 2, 1)
        return y + u * D_skip[None, None, :]

    def _B_ref(x, w_in, w_sp, b_sp, w_out):
        B, S, D = x.shape
        F = w_in.shape[-1]
        Fh = F // 2
        z = _gelu(torch.einsum('bsd,df->bsf', x, w_in))
        z1 = z[..., :Fh].clone()
        z2 = _layernorm(z[..., Fh:], axis=-1)
        g = torch.einsum('ts,bsf->btf', w_sp, z2) + b_sp[None, :, None]
        return torch.einsum('bsf,fd->bsd', z1 * g, w_out)
    x = A_u
    h = x + _A_ref(_layernorm(x, axis=-1), A_log_A_real, A_A_imag, A_C_real, A_C_imag, A_log_dt, A_D_skip)
    h2 = h + _B_ref(_layernorm(h, axis=-1), B_w_in, B_w_sp, B_b_sp, B_w_out)
    return h2
```

```asm
; @launch grid=(256,1,1) block=(512,1,1) lds=163840
.amdgcn_target "amdgcn-amd-amdhsa--gfx950"
.text
.globl sequential_preLN__ssm_conv_s4d__mixer_gmlp__prompt_kernel
.p2align 8
.type sequential_preLN__ssm_conv_s4d__mixer_gmlp__prompt_kernel,@function
sequential_preLN__ssm_conv_s4d__mixer_gmlp__prompt_kernel:
K_START:
    s_cmp_ge_u32 s2, 256
    s_cbranch_scc1 K_END
    s_load_dwordx16 s[16:31], s[0:1], 0
    s_load_dwordx8 s[32:39], s[0:1], 64
    s_load_dwordx4 s[40:43], s[0:1], 104
    s_load_dwordx2 s[44:45], s[0:1], 96
    v_and_b32 v1, 63, v0
    v_lshrrev_b32 v2, 6, v0
    s_and_b32 s6, s2, 7
    s_lshr_b32 s7, s2, 3
    v_readfirstlane_b32 s8, v2
    s_lshr_b32 s9, s2, 5
    s_cmp_lg_u32 s9, 2
    s_cbranch_scc1 K_NOPF
    s_cmp_eq_u32 s2, 95
    s_cbranch_scc1 K1_INIT
    s_getpc_b64 s[10:11]
K_PC:
    v_lshlrev_b32 v2, 7, v0
    v_min_u32 v2, CODE_END-K_PC, v2
    global_load_dword v255, v2, s[10:11]
K_NOPF:
    s_lshl_b32 s46, s6, 2
    s_lshr_b32 s9, s7, 3
    s_add_u32 s46, s46, s9
    s_and_b32 s47, s7, 7
    s_and_b32 s3, s8, 3
    s_lshl_b32 s9, s8, 2
    s_add_u32 s9, s9, 163776
    v_mov_b32 v2, s9
    v_mov_b32 v3, 0
    ds_write_b32 v2, v3
    ds_write_b32 v2, v3 offset:32
    s_cmp_lt_u32 s7, 12
    s_cbranch_scc1 K1_HELPER
    s_mul_i32 s9, s6, 20
    s_add_u32 s9, s9, s7
    s_sub_u32 s9, s9, 12
    s_lshl_b32 s10, s9, 2
    s_add_u32 s10, s10, s3
    s_mul_i32 s11, s10, 384
    v_lshl_add_u32 v14, v1, 2, s11
    s_add_u32 s11, s11, 256
    v_lshl_add_u32 v15, v1, 1, s11
    s_lshl_b32 s12, s10, 1
    s_and_b32 s12, s12, -4
    s_waitcnt lgkmcnt(0)
    global_load_dword v16, v14, s[18:19]
    global_load_ushort v17, v15, s[18:19]
    global_load_dword v18, v14, s[20:21]
    global_load_ushort v19, v15, s[20:21]
    s_load_dword s74, s[26:27], s12
    s_load_dword s58, s[28:29], s12
    global_load_dword v20, v14, s[22:23]
    global_load_ushort v21, v15, s[22:23]
    global_load_dword v22, v14, s[24:25]
    global_load_ushort v23, v15, s[24:25]
    s_mul_i32 s59, s3, 4352
    s_add_u32 s59, s59, 78848
    v_and_b32 v10, 15, v1
    v_lshrrev_b32 v11, 4, v1
    s_cmp_lt_u32 s8, 4
    s_cbranch_scc1 K1_AW
    s_lshl_b32 s12, s46, 7
    s_lshl_b32 s13, s3, 5
    s_add_u32 s12, s12, s13
    v_and_b32 v126, 15, v1
    v_lshl_add_u32 v126, v126, 1, s12
    global_load_ushort v126, v126, s[36:37]
    s_barrier
    v_subrev_u32 v2, 256, v0
    v_mul_u32_u24 v3, 10240, v2
    s_lshl_b32 s11, s9, 3
    s_and_b32 s63, s7, 1
    s_mul_i32 s12, s63, 5120
    s_add_u32 s13, s11, s12
    s_sub_u32 s11, s11, s12
    s_add_u32 s11, s11, 5120
    v_add_u32 v5, s11, v3
    v_add_u32 v3, s13, v3
    global_load_dwordx2 v[160:161], v3, s[16:17] offset:0
    s_branch K1_BW
K1_INIT:
    v_lshlrev_b32 v2, 4, v0
    v_add_u32 v2, 2621440, v2
    v_mov_b32 v4, 0
    v_mov_b32 v5, 0
    v_mov_b32 v6, 0
    v_mov_b32 v7, 0
    v_mov_b32 v8, 1
    v_mov_b32 v9, 2
    s_waitcnt lgkmcnt(0)
    global_store_dwordx4 v2, v[4:7], s[42:43] sc1
    s_waitcnt vmcnt(0)
    s_barrier
    v_cmp_eq_u32 vcc, 0, v0
    s_nop 0
    s_and_saveexec_b64 s[10:11], vcc
    s_cbranch_execz K1_I1
    global_store_dword v4, v8, s[40:41] sc1
K1_I1:
    s_mov_b64 exec, -1
    s_barrier
    v_add_u32 v2, 0x2000, v2
    global_store_dwordx4 v2, v[4:7], s[42:43] sc1
    v_add_u32 v2, 0x2000, v2
    global_store_dwordx4 v2, v[4:7], s[42:43] sc1
    v_add_u32 v2, 0x2000, v2
    global_store_dwordx4 v2, v[4:7], s[42:43] sc1
    s_waitcnt vmcnt(0)
    s_barrier
    s_cmp_lg_u32 s8, 0
    s_cbranch_scc1 K_NOPF
    s_mov_b64 exec, 1
    global_store_dword v4, v9, s[40:41] sc1
    s_mov_b64 exec, -1
    s_branch K_NOPF
K1_AW:
    s_getpc_b64 s[48:49]
K1_PB:
    s_add_u32 s48, s48, BANDTAB-K1_PB
    s_addc_u32 s49, s49, 0
    v_lshlrev_b32 v2, 4, v1
    global_load_dwordx4 v[212:215], v2, s[48:49]
    global_load_dwordx4 v[216:219], v2, s[48:49] offset:1024
    global_load_dwordx4 v[220:223], v2, s[48:49] offset:2048
    s_barrier
    s_mul_i32 s61, s3, 4224
    s_add_u32 s61, s61, 96352
    s_mul_i32 s62, s3, 4608
    s_add_u32 s62, s62, 44032
    s_lshl_b32 s63, s3, 12
    s_add_u32 s63, s63, 62464
    s_mul_i32 s60, s3, 8448
    s_add_u32 s60, s60, 113152
    v_lshl_add_u32 v2, v1, 3, s60
    v_mul_u32_u24 v4, 528, v10
    v_lshl_add_u32 v4, v11, 4, v4
    v_add_u32 v4, s60, v4
    s_mul_i32 s60, s3, 11008
    v_mov_b32 v12, 0
    v_mov_b32 v13, 0
    v_mov_b32 v14, 0
    v_mov_b32 v15, 0
    v_lshl_add_u32 v5, v1, 4, s60
    s_mov_b32 exec_hi, 0xff
    ds_write_b128 v5, v[12:15]
    ds_write_b128 v5, v[12:15] offset:2176
    ds_write_b128 v5, v[12:15] offset:4928
    ds_write_b128 v5, v[12:15] offset:7680
    ds_write_b128 v5, v[12:15] offset:10432
    s_mov_b32 exec_hi, -1
    v_lshl_add_u32 v5, v1, 3, s62
    ds_write_b64 v5, v[12:13]
    s_sub_u32 s48, s61, 96
    v_lshl_add_u32 v5, v1, 2, s48
    ds_write_b32 v5, v12
    v_max_u32 v12, 1, v11
    v_sub_u32 v12, 6, v12
    v_lshlrev_b32 v5, v12, v10
    v_lshlrev_b32 v13, 4, v11
    v_lshlrev_b32 v6, 9, v11
    v_cmp_gt_u32 vcc, 2, v11
    s_nop 1
    v_cndmask_b32 v13, v6, v13, vcc
    v_add3_u32 v5, v5, v13, s61
    v_mov_b32 v13, 0x100
    v_cmp_eq_u32 vcc, 3, v11
    s_nop 1
    v_cndmask_b32 v13, 8, v13, vcc
    v_lshlrev_b32 v12, v12, 16
    v_add_u32 v7, v5, v12
    v_add_u32 v8, v7, v13
    v_lshl_add_u32 v9, v10, 2, v6
    v_add_u32 v6, v5, v13
    s_add_u32 s48, s61, 2048
    v_add_u32 v9, s48, v9
    v_add_u32 v12, 1, v10
    v_and_b32 v12, 3, v12
    v_mul_u32_u24 v13, 2754, v12
    v_lshlrev_b32 v12, 3, v11
    v_sub_u32 v12, v12, v10
    v_lshl_add_u32 v13, v12, 1, v13
    s_add_u32 s48, s60, 30
    v_add_u32 v200, s48, v13
    v_lshlrev_b32 v13, 3, v11
    v_sub_u32 v224, v200, v13
    v_lshlrev_b32 v12, 5, v10
    v_lshl_add_u32 v12, v11, 4, v12
    s_add_u32 s48, s62, 32
    v_add_u32 v201, s48, v12
    v_lshlrev_b32 v12, 2, v10
    v_add_u32 v12, v12, v11
    v_lshl_add_u32 v202, v12, 3, s63
    s_add_u32 s48, s62, 512
    v_lshl_add_u32 v225, v12, 3, s48
    v_and_b32 v12, 1, v11
    v_lshrrev_b32 v13, 2, v10
    v_lshl_add_u32 v12, v12, 2, v13
    v_mul_u32_u24 v12, 81920, v12
    v_and_b32 v13, 3, v10
    v_lshl_add_u32 v12, v13, 5, v12
    v_lshrrev_b32 v13, 1, v11
    v_lshl_add_u32 v12, v13, 4, v12
    s_lshl_b32 s48, s10, 7
    v_add_u32 v203, s48, v12
    s_sub_u32 s48, s61, 96
    v_lshl_add_u32 v204, v1, 5, s48
    v_cmp_eq_u32 vcc, 34, v1
    s_add_u32 s48, s61, 1024
    v_lshl_add_u32 v206, v1, 3, s48
    v_cndmask_b32 v205, 0, 4, vcc
    v_sub_u32 v205, v204, v205
    v_cmp_eq_u32 vcc, 63, v1
    v_lshlrev_b32 v208, 4, v1
    v_add_u32 v211, s59, v208
    s_add_u32 s48, s60, 1072
    v_cndmask_b32 v207, 0, 4, vcc
    v_sub_u32 v207, v206, v207
    v_sub_u32 v208, s48, v208
    v_lshlrev_b32 v209, 3, v1
    s_add_u32 s48, s60, 1592
    v_sub_u32 v209, s48, v209
    v_lshlrev_b32 v210, 1, v1
    s_add_u32 s48, s60, 2880
    v_sub_u32 v210, s48, v210
    v_and_b32 v12, 1, v1
    v_mul_u32_u24 v12, 2754, v12
    v_sub_u32 v210, v210, v12
    s_lshl_b32 s48, s3, 2
    s_add_u32 s48, s48, 163776
    v_mov_b32 v3, s48
    s_waitcnt lgkmcnt(0)
    s_lshl_b32 s14, s74, 16
    s_and_b32 s13, s74, 0xffff0000
    s_bitcmp1_b32 s10, 0
    s_cselect_b32 s13, s13, s14
    v_mov_b32 v12, 0x3fb8aa3b
    v_mul_f32 v12, s13, v12
    v_exp_f32 v12, v12
    s_nop 0
    v_cvt_pk_bf16_f32 v12, 0, v12
    s_lshl_b32 s57, s58, 16
    s_and_b32 s58, s58, 0xffff0000
    s_bitcmp1_b32 s10, 0
    s_cselect_b32 s58, s58, s57
    s_waitcnt vmcnt(3)
    v_lshlrev_b32 v24, 16, v16
    v_and_b32 v44, 0xffff0000, v16
    v_lshlrev_b32 v25, 16, v18
    v_and_b32 v45, 0xffff0000, v18
    v_lshlrev_b32 v32, 16, v20
    v_and_b32 v52, 0xffff0000, v20
    v_lshlrev_b32 v33, 16, v22
    v_and_b32 v53, 0xffff0000, v22
    v_lshlrev_b32 v21, 16, v21
    v_lshlrev_b32 v23, 16, v23
    v_mul_f32 v24, 0x3fb8aa3b, v24
    v_mul_f32 v44, 0x3fb8aa3b, v44
    v_exp_f32 v24, v24
    v_exp_f32 v44, v44
    v_max3_f32 v13, abs(v32), abs(v33), abs(v52)
    v_max3_f32 v14, abs(v53), abs(v21), abs(v23)
    v_max_u32 v13, v13, v14
    v_cvt_pk_bf16_f32 v24, 0, v24
    v_cvt_pk_bf16_f32 v44, 0, v44
    v_max_u32_dpp v13, v13, v13 row_ror:8 row_mask:0xf bank_mask:0xf
    v_pk_mul_f32 v[24:25], v[24:25], v[12:13] op_sel:[0,0] op_sel_hi:[1,0]
    v_pk_mul_f32 v[44:45], v[44:45], v[12:13] op_sel:[0,0] op_sel_hi:[1,0]
    v_max_u32_dpp v13, v13, v13 row_ror:4 row_mask:0xf bank_mask:0xf
    v_mul_f32 v24, 0xbfb8aa3b, v24
    v_mul_f32 v44, 0xbfb8aa3b, v44
    v_max_u32_dpp v13, v13, v13 row_ror:2 row_mask:0xf bank_mask:0xf
    v_mul_f32 v25, 0x3e22f983, v25
    v_mul_f32 v45, 0x3e22f983, v45
    v_max_u32_dpp v13, v13, v13 row_ror:1 row_mask:0xf bank_mask:0xf
    v_exp_f32 v40, v24
    v_fract_f32 v43, v25
    v_exp_f32 v60, v44
    v_fract_f32 v63, v45
    v_cos_f32 v26, v43
    v_sin_f32 v27, v43
    v_cos_f32 v46, v63
    v_sin_f32 v47, v63
    v_pk_mul_f32 v[26:27], v[26:27], v[40:41] op_sel:[0,0] op_sel_hi:[1,0]
    v_pk_mul_f32 v[46:47], v[46:47], v[60:61] op_sel:[0,0] op_sel_hi:[1,0]
    v_readlane_b32 s48, v13, 0
    v_readlane_b32 s49, v13, 16
    v_readlane_b32 s50, v13, 32
    v_readlane_b32 s51, v13, 48
    v_mul_f32 v42, 0x43800000, v24
    v_mul_f32 v43, 0x43800000, v25
    v_mul_f32 v62, 0x43800000, v44
    v_mul_f32 v63, 0x43800000, v45
    v_exp_f32 v40, v42
    v_fract_f32 v43, v43
    v_exp_f32 v60, v62
    v_fract_f32 v63, v63
    v_cos_f32 v30, v43
    v_sin_f32 v31, v43
    v_cos_f32 v50, v63
    v_sin_f32 v51, v63
    v_pk_mul_f32 v[30:31], v[30:31], v[40:41] op_sel:[0,0] op_sel_hi:[1,0]
    v_pk_mul_f32 v[50:51], v[50:51], v[60:61] op_sel:[0,0] op_sel_hi:[1,0]
    s_max_u32 s48, s48, s49
    s_max_u32 s50, s50, s51
    s_max_u32 s48, s48, s50
    s_and_b32 s48, s48, 0x7f800000
    s_max_u32 s48, s48, 0x01000000
    s_min_u32 s48, s48, 0x7e000000
    s_sub_u32 s49, 0x7f000000, s48
    v_mul_f32 v42, 0x41000000, v24
    v_mul_f32 v43, 0x41000000, v25
    v_mul_f32 v62, 0x41000000, v44
    v_mul_f32 v63, 0x41000000, v45
    v_exp_f32 v40, v42
    v_fract_f32 v43, v43
    v_exp_f32 v60, v62
    v_fract_f32 v63, v63
    v_cos_f32 v28, v43
    v_sin_f32 v29, v43
    v_cos_f32 v48, v63
    v_sin_f32 v49, v63
    v_pk_mul_f32 v[28:29], v[28:29], v[40:41] op_sel:[0,0] op_sel_hi:[1,0] neg_hi:[1,0]
    v_pk_mul_f32 v[48:49], v[48:49], v[60:61] op_sel:[0,0] op_sel_hi:[1,0] neg_hi:[1,0]
    v_mul_f32 v32, s49, v32
    v_mul_f32 v33, s49, -v33
    v_mul_f32 v52, s49, v52
    v_mul_f32 v53, s49, -v53
    v_mov_b32 v64, 0x3c00
    v_mov_b32 v65, 0x3c00
    ds_write_b64 v2, v[64:65] offset:0
    v_cvt_pk_f16_f32 v66, v26, v27
    v_cvt_pk_f16_f32 v67, v46, v47
    ds_write_b64 v2, v[66:67] offset:528
    v_pk_mul_f32 v[42:43], v[26:27], v[26:27] op_sel:[0,0] op_sel_hi:[0,1]
    v_pk_mul_f32 v[62:63], v[46:47], v[46:47] op_sel:[0,0] op_sel_hi:[0,1]
    v_pk_fma_f32 v[34:35], v[26:27], v[26:27], v[42:43] op_sel:[1,1,0] op_sel_hi:[1,0,1] neg_lo:[1,0,0]
    v_pk_fma_f32 v[54:55], v[46:47], v[46:47], v[62:63] op_sel:[1,1,0] op_sel_hi:[1,0,1] neg_lo:[1,0,0]
    v_cvt_pk_f16_f32 v64, v34, v35
    v_cvt_pk_f16_f32 v65, v54, v55
    ds_write_b64 v2, v[64:65] offset:1056
    v_pk_mul_f32 v[42:43], v[34:35], v[26:27] op_sel:[0,0] op_sel_hi:[0,1]
    v_pk_mul_f32 v[62:63], v[54:55], v[46:47] op_sel:[0,0] op_sel_hi:[0,1]
    v_pk_fma_f32 v[24:25], v[34:35], v[26:27], v[42:43] op_sel:[1,1,0] op_sel_hi:[1,0,1] neg_lo:[1,0,0]
    v_pk_fma_f32 v[44:45], v[54:55], v[46:47], v[62:63] op_sel:[1,1,0] op_sel_hi:[1,0,1] neg_lo:[1,0,0]
    v_cvt_pk_f16_f32 v66, v24, v25
    v_cvt_pk_f16_f32 v67, v44, v45
    ds_write_b64 v2, v[66:67] offset:1584
    v_pk_mul_f32 v[42:43], v[34:35], v[34:35] op_sel:[0,0] op_sel_hi:[0,1]
    v_pk_mul_f32 v[62:63], v[54:55], v[54:55] op_sel:[0,0] op_sel_hi:[0,1]
    v_pk_fma_f32 v[36:37], v[34:35], v[34:35], v[42:43] op_sel:[1,1,0] op_sel_hi:[1,0,1] neg_lo:[1,0,0]
    v_pk_fma_f32 v[56:57], v[54:55], v[54:55], v[62:63] op_sel:[1,1,0] op_sel_hi:[1,0,1] neg_lo:[1,0,0]
    v_cvt_pk_f16_f32 v64, v36, v37
    v_cvt_pk_f16_f32 v65, v56, v57
    ds_write_b64 v2, v[64:65] offset:2112
    v_pk_mul_f32 v[42:43], v[36:37], v[26:27] op_sel:[0,0] op_sel_hi:[0,1]
    v_pk_mul_f32 v[62:63], v[56:57], v[46:47] op_sel:[0,0] op_sel_hi:[0,1]
    v_pk_fma_f32 v[24:25], v[36:37], v[26:27], v[42:43] op_sel:[1,1,0] op_sel_hi:[1,0,1] neg_lo:[1,0,0]
    v_pk_fma_f32 v[44:45], v[56:57], v[46:47], v[62:63] op_sel:[1,1,0] op_sel_hi:[1,0,1] neg_lo:[1,0,0]
    v_cvt_pk_f16_f32 v66, v24, v25
    v_cvt_pk_f16_f32 v67, v44, v45
    ds_write_b64 v2, v[66:67] offset:2640
    v_pk_mul_f32 v[42:43], v[36:37], v[34:35] op_sel:[0,0] op_sel_hi:[0,1]
    v_pk_mul_f32 v[62:63], v[56:57], v[54:55] op_sel:[0,0] op_sel_hi:[0,1]
    v_pk_fma_f32 v[38:39], v[36:37], v[34:35], v[42:43] op_sel:[1,1,0] op_sel_hi:[1,0,1] neg_lo:[1,0,0]
    v_pk_fma_f32 v[58:59], v[56:57], v[54:55], v[62:63] op_sel:[1,1,0] op_sel_hi:[1,0,1] neg_lo:[1,0,0]
    v_cvt_pk_f16_f32 v64, v38, v39
    v_cvt_pk_f16_f32 v65, v58, v59
    ds_write_b64 v2, v[64:65] offset:3168
    v_pk_mul_f32 v[42:43], v[38:39], v[26:27] op_sel:[0,0] op_sel_hi:[0,1]
    v_pk_mul_f32 v[62:63], v[58:59], v[46:47] op_sel:[0,0] op_sel_hi:[0,1]
    v_pk_fma_f32 v[24:25], v[38:39], v[26:27], v[42:43] op_sel:[1,1,0] op_sel_hi:[1,0,1] neg_lo:[1,0,0]
    v_pk_fma_f32 v[44:45], v[58:59], v[46:47], v[62:63] op_sel:[1,1,0] op_sel_hi:[1,0,1] neg_lo:[1,0,0]
    v_cvt_pk_f16_f32 v66, v24, v25
    v_cvt_pk_f16_f32 v67, v44, v45
    ds_write_b64 v2, v[66:67] offset:3696
    v_cvt_pk_f16_f32 v64, v30, v31
    v_cvt_pk_f16_f32 v65, v50, v51
    ds_write_b64 v2, v[64:65] offset:4224
    v_pk_mul_f32 v[42:43], v[30:31], v[34:35] op_sel:[0,0] op_sel_hi:[0,1]
    v_pk_mul_f32 v[62:63], v[50:51], v[54:55] op_sel:[0,0] op_sel_hi:[0,1]
    v_pk_fma_f32 v[24:25], v[30:31], v[34:35], v[42:43] op_sel:[1,1,0] op_sel_hi:[1,0,1] neg_lo:[1,0,0]
    v_pk_fma_f32 v[44:45], v[50:51], v[54:55], v[62:63] op_sel:[1,1,0] op_sel_hi:[1,0,1] neg_lo:[1,0,0]
    v_cvt_pk_f16_f32 v66, v24, v25
    v_cvt_pk_f16_f32 v67, v44, v45
    ds_write_b64 v2, v[66:67] offset:4752
    v_pk_mul_f32 v[42:43], v[30:31], v[36:37] op_sel:[0,0] op_sel_hi:[0,1]
    v_pk_mul_f32 v[62:63], v[50:51], v[56:57] op_sel:[0,0] op_sel_hi:[0,1]
    v_pk_fma_f32 v[24:25], v[30:31], v[36:37], v[42:43] op_sel:[1,1,0] op_sel_hi:[1,0,1] neg_lo:[1,0,0]
    v_pk_fma_f32 v[44:45], v[50:51], v[56:57], v[62:63] op_sel:[1,1,0] op_sel_hi:[1,0,1] neg_lo:[1,0,0]
    v_cvt_pk_f16_f32 v64, v24, v25
    v_cvt_pk_f16_f32 v65, v44, v45
    ds_write_b64 v2, v[64:65] offset:5280
    v_pk_mul_f32 v[42:43], v[30:31], v[38:39] op_sel:[0,0] op_sel_hi:[0,1]
    v_pk_mul_f32 v[62:63], v[50:51], v[58:59] op_sel:[0,0] op_sel_hi:[0,1]
    v_pk_fma_f32 v[24:25], v[30:31], v[38:39], v[42:43] op_sel:[1,1,0] op_sel_hi:[1,0,1] neg_lo:[1,0,0]
    v_pk_fma_f32 v[44:45], v[50:51], v[58:59], v[62:63] op_sel:[1,1,0] op_sel_hi:[1,0,1] neg_lo:[1,0,0]
    v_cvt_pk_f16_f32 v66, v24, v25
    v_cvt_pk_f16_f32 v67, v44, v45
    ds_write_b64 v2, v[66:67] offset:5808
    v_pk_mul_f32 v[42:43], v[30:31], v[30:31] op_sel:[0,0] op_sel_hi:[0,1]
    v_pk_mul_f32 v[62:63], v[50:51], v[50:51] op_sel:[0,0] op_sel_hi:[0,1]
    v_pk_fma_f32 v[40:41], v[30:31], v[30:31], v[42:43] op_sel:[1,1,0] op_sel_hi:[1,0,1] neg_lo:[1,0,0]
    v_pk_fma_f32 v[60:61], v[50:51], v[50:51], v[62:63] op_sel:[1,1,0] op_sel_hi:[1,0,1] neg_lo:[1,0,0]
    v_cvt_pk_f16_f32 v64, v40, v41
    v_cvt_pk_f16_f32 v65, v60, v61
    ds_write_b64 v2, v[64:65] offset:6336
    v_pk_mul_f32 v[42:43], v[40:41], v[36:37] op_sel:[0,0] op_sel_hi:[0,1]
    v_pk_mul_f32 v[62:63], v[60:61], v[56:57] op_sel:[0,0] op_sel_hi:[0,1]
    v_pk_fma_f32 v[24:25], v[40:41], v[36:37], v[42:43] op_sel:[1,1,0] op_sel_hi:[1,0,1] neg_lo:[1,0,0]
    v_pk_fma_f32 v[44:45], v[60:61], v[56:57], v[62:63] op_sel:[1,1,0] op_sel_hi:[1,0,1] neg_lo:[1,0,0]
    v_cvt_pk_f16_f32 v66, v24, v25
    v_cvt_pk_f16_f32 v67, v44, v45
    ds_write_b64 v2, v[66:67] offset:6864
    v_pk_mul_f32 v[42:43], v[40:41], v[30:31] op_sel:[0,0] op_sel_hi:[0,1]
    v_pk_mul_f32 v[62:63], v[60:61], v[50:51] op_sel:[0,0] op_sel_hi:[0,1]
    v_pk_fma_f32 v[40:41], v[40:41], v[30:31], v[42:43] op_sel:[1,1,0] op_sel_hi:[1,0,1] neg_lo:[1,0,0]
    v_pk_fma_f32 v[60:61], v[60:61], v[50:51], v[62:63] op_sel:[1,1,0] op_sel_hi:[1,0,1] neg_lo:[1,0,0]
    v_cvt_pk_f16_f32 v64, v40, v41
    v_cvt_pk_f16_f32 v65, v60, v61
    ds_write_b64 v2, v[64:65] offset:7392
    v_pk_mul_f32 v[42:43], v[40:41], v[36:37] op_sel:[0,0] op_sel_hi:[0,1]
    v_pk_mul_f32 v[62:63], v[60:61], v[56:57] op_sel:[0,0] op_sel_hi:[0,1]
    v_pk_fma_f32 v[24:25], v[40:41], v[36:37], v[42:43] op_sel:[1,1,0] op_sel_hi:[1,0,1] neg_lo:[1,0,0]
    v_pk_fma_f32 v[44:45], v[60:61], v[56:57], v[62:63] op_sel:[1,1,0] op_sel_hi:[1,0,1] neg_lo:[1,0,0]
    v_cvt_pk_f16_f32 v66, v24, v25
    v_cvt_pk_f16_f32 v67, v44, v45
    ds_write_b64 v2, v[66:67] offset:7920
    ds_read_b128 v[84:87], v4 offset:0
    ds_read_b128 v[88:91], v4 offset:64
    ds_read_b128 v[92:95], v4 offset:128
    ds_read_b128 v[96:99], v4 offset:192
    ds_read_b128 v[100:103], v4 offset:256
    ds_read_b128 v[104:107], v4 offset:320
    ds_read_b128 v[108:111], v4 offset:384
    ds_read_b128 v[112:115], v4 offset:448
    v_pk_mul_f32 v[42:43], v[40:41], v[30:31] op_sel:[0,0] op_sel_hi:[0,1]
    v_pk_mul_f32 v[62:63], v[60:61], v[50:51] op_sel:[0,0] op_sel_hi:[0,1]
    v_pk_fma_f32 v[40:41], v[40:41], v[30:31], v[42:43] op_sel:[1,1,0] op_sel_hi:[1,0,1] neg_lo:[1,0,0]
    v_pk_fma_f32 v[60:61], v[60:61], v[50:51], v[62:63] op_sel:[1,1,0] op_sel_hi:[1,0,1] neg_lo:[1,0,0]
    v_cvt_pk_f16_f32 v64, v40, v41
    v_cvt_pk_f16_f32 v65, v60, v61
    ds_write_b64 v2, v[64:65] offset:0
    v_pk_mul_f32 v[42:43], v[40:41], v[30:31] op_sel:[0,0] op_sel_hi:[0,1]
    v_pk_mul_f32 v[62:63], v[60:61], v[50:51] op_sel:[0,0] op_sel_hi:[0,1]
    v_pk_fma_f32 v[40:41], v[40:41], v[30:31], v[42:43] op_sel:[1,1,0] op_sel_hi:[1,0,1] neg_lo:[1,0,0]
    v_pk_fma_f32 v[60:61], v[60:61], v[50:51], v[62:63] op_sel:[1,1,0] op_sel_hi:[1,0,1] neg_lo:[1,0,0]
    v_cvt_pk_f16_f32 v66, v40, v41
    v_cvt_pk_f16_f32 v67, v60, v61
    ds_write_b64 v2, v[66:67] offset:528
    v_pk_mul_f32 v[42:43], v[40:41], v[30:31] op_sel:[0,0] op_sel_hi:[0,1]
    v_pk_mul_f32 v[62:63], v[60:61], v[50:51] op_sel:[0,0] op_sel_hi:[0,1]
    v_pk_fma_f32 v[40:41], v[40:41], v[30:31], v[42:43] op_sel:[1,1,0] op_sel_hi:[1,0,1] neg_lo:[1,0,0]
    v_pk_fma_f32 v[60:61], v[60:61], v[50:51], v[62:63] op_sel:[1,1,0] op_sel_hi:[1,0,1] neg_lo:[1,0,0]
    v_cvt_pk_f16_f32 v64, v40, v41
    v_cvt_pk_f16_f32 v65, v60, v61
    ds_write_b64 v2, v[64:65] offset:1056
    v_pk_mul_f32 v[42:43], v[40:41], v[30:31] op_sel:[0,0] op_sel_hi:[0,1]
    v_pk_mul_f32 v[62:63], v[60:61], v[50:51] op_sel:[0,0] op_sel_hi:[0,1]
    v_pk_fma_f32 v[40:41], v[40:41], v[30:31], v[42:43] op_sel:[1,1,0] op_sel_hi:[1,0,1] neg_lo:[1,0,0]
    v_pk_fma_f32 v[60:61], v[60:61], v[50:51], v[62:63] op_sel:[1,1,0] op_sel_hi:[1,0,1] neg_lo:[1,0,0]
    v_cvt_pk_f16_f32 v66, v40, v41
    v_cvt_pk_f16_f32 v67, v60, v61
    ds_write_b64 v2, v[66:67] offset:1584
    v_pk_mul_f32 v[42:43], v[40:41], v[30:31] op_sel:[0,0] op_sel_hi:[0,1]
    v_pk_mul_f32 v[62:63], v[60:61], v[50:51] op_sel:[0,0] op_sel_hi:[0,1]
    v_pk_fma_f32 v[40:41], v[40:41], v[30:31], v[42:43] op_sel:[1,1,0] op_sel_hi:[1,0,1] neg_lo:[1,0,0]
    v_pk_fma_f32 v[60:61], v[60:61], v[50:51], v[62:63] op_sel:[1,1,0] op_sel_hi:[1,0,1] neg_lo:[1,0,0]
    v_cvt_pk_f16_f32 v64, v40, v41
    v_cvt_pk_f16_f32 v65, v60, v61
    ds_write_b64 v2, v[64:65] offset:2112
    ds_read_b128 v[116:119], v4 offset:0
    ds_read_b128 v[120:123], v4 offset:64
    ds_read_b128 v[124:127], v4 offset:128
    ds_read_b128 v[128:131], v4 offset:192
    ds_read_b128 v[132:135], v4 offset:256
    ds_read_b128 v[136:139], v4 offset:320
    ds_read_b128 v[140:143], v4 offset:384
    ds_read_b128 v[144:147], v4 offset:448
    v_cvt_pk_f16_f32 v66, v32, v33
    v_cvt_pk_f16_f32 v67, v52, v53
    ds_write_b64 v2, v[66:67] offset:0
    v_pk_mul_f32 v[42:43], v[32:33], v[28:29] op_sel:[0,0] op_sel_hi:[0,1]
    v_pk_mul_f32 v[62:63], v[52:53], v[48:49] op_sel:[0,0] op_sel_hi:[0,1]
    v_pk_fma_f32 v[32:33], v[32:33], v[28:29], v[42:43] op_sel:[1,1,0] op_sel_hi:[1,0,1] neg_lo:[1,0,0]
    v_pk_fma_f32 v[52:53], v[52:53], v[48:49], v[62:63] op_sel:[1,1,0] op_sel_hi:[1,0,1] neg_lo:[1,0,0]
    v_cvt_pk_f16_f32 v64, v32, v33
    v_cvt_pk_f16_f32 v65, v52, v53
    ds_write_b64 v2, v[64:65] offset:528
    v_pk_mul_f32 v[42:43], v[32:33], v[28:29] op_sel:[0,0] op_sel_hi:[0,1]
    v_pk_mul_f32 v[62:63], v[52:53], v[48:49] op_sel:[0,0] op_sel_hi:[0,1]
    v_pk_fma_f32 v[32:33], v[32:33], v[28:29], v[42:43] op_sel:[1,1,0] op_sel_hi:[1,0,1] neg_lo:[1,0,0]
    v_pk_fma_f32 v[52:53], v[52:53], v[48:49], v[62:63] op_sel:[1,1,0] op_sel_hi:[1,0,1] neg_lo:[1,0,0]
    v_cvt_pk_f16_f32 v66, v32, v33
    v_cvt_pk_f16_f32 v67, v52, v53
    ds_write_b64 v2, v[66:67] offset:1056
    v_pk_mul_f32 v[42:43], v[32:33], v[28:29] op_sel:[0,0] op_sel_hi:[0,1]
    v_pk_mul_f32 v[62:63], v[52:53], v[48:49] op_sel:[0,0] op_sel_hi:[0,1]
    v_pk_fma_f32 v[32:33], v[32:33], v[28:29], v[42:43] op_sel:[1,1,0] op_sel_hi:[1,0,1] neg_lo:[1,0,0]
    v_pk_fma_f32 v[52:53], v[52:53], v[48:49], v[62:63] op_sel:[1,1,0] op_sel_hi:[1,0,1] neg_lo:[1,0,0]
    v_cvt_pk_f16_f32 v64, v32, v33
    v_cvt_pk_f16_f32 v65, v52, v53
    ds_write_b64 v2, v[64:65] offset:1584
    v_pk_mul_f32 v[42:43], v[32:33], v[28:29] op_sel:[0,0] op_sel_hi:[0,1]
    v_pk_mul_f32 v[62:63], v[52:53], v[48:49] op_sel:[0,0] op_sel_hi:[0,1]
    v_pk_fma_f32 v[32:33], v[32:33], v[28:29], v[42:43] op_sel:[1,1,0] op_sel_hi:[1,0,1] neg_lo:[1,0,0]
    v_pk_fma_f32 v[52:53], v[52:53], v[48:49], v[62:63] op_sel:[1,1,0] op_sel_hi:[1,0,1] neg_lo:[1,0,0]
    v_cvt_pk_f16_f32 v66, v32, v33
    v_cvt_pk_f16_f32 v67, v52, v53
    ds_write_b64 v2, v[66:67] offset:2112
    v_pk_mul_f32 v[42:43], v[32:33], v[28:29] op_sel:[0,0] op_sel_hi:[0,1]
    v_pk_mul_f32 v[62:63], v[52:53], v[48:49] op_sel:[0,0] op_sel_hi:[0,1]
    v_pk_fma_f32 v[32:33], v[32:33], v[28:29], v[42:43] op_sel:[1,1,0] op_sel_hi:[1,0,1] neg_lo:[1,0,0]
    v_pk_fma_f32 v[52:53], v[52:53], v[48:49], v[62:63] op_sel:[1,1,0] op_sel_hi:[1,0,1] neg_lo:[1,0,0]
    v_cvt_pk_f16_f32 v64, v32, v33
    v_cvt_pk_f16_f32 v65, v52, v53
    ds_write_b64 v2, v[64:65] offset:2640
    v_pk_mul_f32 v[42:43], v[32:33], v[28:29] op_sel:[0,0] op_sel_hi:[0,1]
    v_pk_mul_f32 v[62:63], v[52:53], v[48:49] op_sel:[0,0] op_sel_hi:[0,1]
    v_pk_fma_f32 v[32:33], v[32:33], v[28:29], v[42:43] op_sel:[1,1,0] op_sel_hi:[1,0,1] neg_lo:[1,0,0]
    v_pk_fma_f32 v[52:53], v[52:53], v[48:49], v[62:63] op_sel:[1,1,0] op_sel_hi:[1,0,1] neg_lo:[1,0,0]
    v_cvt_pk_f16_f32 v66, v32, v33
    v_cvt_pk_f16_f32 v67, v52, v53
    ds_write_b64 v2, v[66:67] offset:3168
    v_pk_mul_f32 v[42:43], v[32:33], v[28:29] op_sel:[0,0] op_sel_hi:[0,1]
    v_pk_mul_f32 v[62:63], v[52:53], v[48:49] op_sel:[0,0] op_sel_hi:[0,1]
    v_pk_fma_f32 v[32:33], v[32:33], v[28:29], v[42:43] op_sel:[1,1,0] op_sel_hi:[1,0,1] neg_lo:[1,0,0]
    v_pk_fma_f32 v[52:53], v[52:53], v[48:49], v[62:63] op_sel:[1,1,0] op_sel_hi:[1,0,1] neg_lo:[1,0,0]
    v_cvt_pk_f16_f32 v64, v32, v33
    v_cvt_pk_f16_f32 v65, v52, v53
    ds_write_b64 v2, v[64:65] offset:3696
    v_pk_mul_f32 v[42:43], v[32:33], v[28:29] op_sel:[0,0] op_sel_hi:[0,1]
    v_pk_mul_f32 v[62:63], v[52:53], v[48:49] op_sel:[0,0] op_sel_hi:[0,1]
    v_pk_fma_f32 v[32:33], v[32:33], v[28:29], v[42:43] op_sel:[1,1,0] op_sel_hi:[1,0,1] neg_lo:[1,0,0]
    v_pk_fma_f32 v[52:53], v[52:53], v[48:49], v[62:63] op_sel:[1,1,0] op_sel_hi:[1,0,1] neg_lo:[1,0,0]
    v_cvt_pk_f16_f32 v66, v32, v33
    v_cvt_pk_f16_f32 v67, v52, v53
    ds_write_b64 v2, v[66:67] offset:4224
    v_pk_mul_f32 v[42:43], v[32:33], v[28:29] op_sel:[0,0] op_sel_hi:[0,1]
    v_pk_mul_f32 v[62:63], v[52:53], v[48:49] op_sel:[0,0] op_sel_hi:[0,1]
    v_pk_fma_f32 v[32:33], v[32:33], v[28:29], v[42:43] op_sel:[1,1,0] op_sel_hi:[1,0,1] neg_lo:[1,0,0]
    v_pk_fma_f32 v[52:53], v[52:53], v[48:49], v[62:63] op_sel:[1,1,0] op_sel_hi:[1,0,1] neg_lo:[1,0,0]
    v_cvt_pk_f16_f32 v64, v32, v33
    v_cvt_pk_f16_f32 v65, v52, v53
    ds_write_b64 v2, v[64:65] offset:4752
    v_pk_mul_f32 v[42:43], v[32:33], v[28:29] op_sel:[0,0] op_sel_hi:[0,1]
    v_pk_mul_f32 v[62:63], v[52:53], v[48:49] op_sel:[0,0] op_sel_hi:[0,1]
    v_pk_fma_f32 v[32:33], v[32:33], v[28:29], v[42:43] op_sel:[1,1,0] op_sel_hi:[1,0,1] neg_lo:[1,0,0]
    v_pk_fma_f32 v[52:53], v[52:53], v[48:49], v[62:63] op_sel:[1,1,0] op_sel_hi:[1,0,1] neg_lo:[1,0,0]
    v_cvt_pk_f16_f32 v66, v32, v33
    v_cvt_pk_f16_f32 v67, v52, v53
    ds_write_b64 v2, v[66:67] offset:5280
    v_pk_mul_f32 v[42:43], v[32:33], v[28:29] op_sel:[0,0] op_sel_hi:[0,1]
    v_pk_mul_f32 v[62:63], v[52:53], v[48:49] op_sel:[0,0] op_sel_hi:[0,1]
    v_pk_fma_f32 v[32:33], v[32:33], v[28:29], v[42:43] op_sel:[1,1,0] op_sel_hi:[1,0,1] neg_lo:[1,0,0]
    v_pk_fma_f32 v[52:53], v[52:53], v[48:49], v[62:63] op_sel:[1,1,0] op_sel_hi:[1,0,1] neg_lo:[1,0,0]
    v_cvt_pk_f16_f32 v64, v32, v33
    v_cvt_pk_f16_f32 v65, v52, v53
    ds_write_b64 v2, v[64:65] offset:5808
    v_pk_mul_f32 v[42:43], v[32:33], v[28:29] op_sel:[0,0] op_sel_hi:[0,1]
    v_pk_mul_f32 v[62:63], v[52:53], v[48:49] op_sel:[0,0] op_sel_hi:[0,1]
    v_pk_fma_f32 v[32:33], v[32:33], v[28:29], v[42:43] op_sel:[1,1,0] op_sel_hi:[1,0,1] neg_lo:[1,0,0]
    v_pk_fma_f32 v[52:53], v[52:53], v[48:49], v[62:63] op_sel:[1,1,0] op_sel_hi:[1,0,1] neg_lo:[1,0,0]
    v_cvt_pk_f16_f32 v66, v32, v33
    v_cvt_pk_f16_f32 v67, v52, v53
    ds_write_b64 v2, v[66:67] offset:6336
    v_pk_mul_f32 v[42:43], v[32:33], v[28:29] op_sel:[0,0] op_sel_hi:[0,1]
    v_pk_mul_f32 v[62:63], v[52:53], v[48:49] op_sel:[0,0] op_sel_hi:[0,1]
    v_pk_fma_f32 v[32:33], v[32:33], v[28:29], v[42:43] op_sel:[1,1,0] op_sel_hi:[1,0,1] neg_lo:[1,0,0]
    v_pk_fma_f32 v[52:53], v[52:53], v[48:49], v[62:63] op_sel:[1,1,0] op_sel_hi:[1,0,1] neg_lo:[1,0,0]
    v_cvt_pk_f16_f32 v64, v32, v33
    v_cvt_pk_f16_f32 v65, v52, v53
    ds_write_b64 v2, v[64:65] offset:6864
    v_pk_mul_f32 v[42:43], v[32:33], v[28:29] op_sel:[0,0] op_sel_hi:[0,1]
    v_pk_mul_f32 v[62:63], v[52:53], v[48:49] op_sel:[0,0] op_sel_hi:[0,1]
    v_pk_fma_f32 v[32:33], v[32:33], v[28:29], v[42:43] op_sel:[1,1,0] op_sel_hi:[1,0,1] neg_lo:[1,0,0]
    v_pk_fma_f32 v[52:53], v[52:53], v[48:49], v[62:63] op_sel:[1,1,0] op_sel_hi:[1,0,1] neg_lo:[1,0,0]
    v_cvt_pk_f16_f32 v66, v32, v33
    v_cvt_pk_f16_f32 v67, v52, v53
    ds_write_b64 v2, v[66:67] offset:7392
    v_pk_mul_f32 v[42:43], v[32:33], v[28:29] op_sel:[0,0] op_sel_hi:[0,1]
    v_pk_mul_f32 v[62:63], v[52:53], v[48:49] op_sel:[0,0] op_sel_hi:[0,1]
    v_pk_fma_f32 v[32:33], v[32:33], v[28:29], v[42:43] op_sel:[1,1,0] op_sel_hi:[1,0,1] neg_lo:[1,0,0]
    v_pk_fma_f32 v[52:53], v[52:53], v[48:49], v[62:63] op_sel:[1,1,0] op_sel_hi:[1,0,1] neg_lo:[1,0,0]
    v_cvt_pk_f16_f32 v64, v32, v33
    v_cvt_pk_f16_f32 v65, v52, v53
    ds_write_b64 v2, v[64:65] offset:7920
    v_pk_mul_f32 v[42:43], v[32:33], v[28:29] op_sel:[0,0] op_sel_hi:[0,1]
    v_pk_mul_f32 v[62:63], v[52:53], v[48:49] op_sel:[0,0] op_sel_hi:[0,1]
    v_pk_fma_f32 v[32:33], v[32:33], v[28:29], v[42:43] op_sel:[1,1,0] op_sel_hi:[1,0,1] neg_lo:[1,0,0]
    v_pk_fma_f32 v[52:53], v[52:53], v[48:49], v[62:63] op_sel:[1,1,0] op_sel_hi:[1,0,1] neg_lo:[1,0,0]
    ds_read_b128 v[148:151], v4 offset:0
    ds_read_b128 v[152:155], v4 offset:64
    ds_read_b128 v[156:159], v4 offset:128
    ds_read_b128 v[160:163], v4 offset:192
    ds_read_b128 v[164:167], v4 offset:256
    ds_read_b128 v[168:171], v4 offset:320
    ds_read_b128 v[172:175], v4 offset:384
    ds_read_b128 v[176:179], v4 offset:448
    v_cvt_pk_f16_f32 v66, v32, v33
    v_cvt_pk_f16_f32 v67, v52, v53
    ds_write_b64 v2, v[66:67] offset:0
    v_pk_mul_f32 v[42:43], v[32:33], v[28:29] op_sel:[0,0] op_sel_hi:[0,1]
    v_pk_mul_f32 v[62:63], v[52:53], v[48:49] op_sel:[0,0] op_sel_hi:[0,1]
    v_pk_fma_f32 v[32:33], v[32:33], v[28:29], v[42:43] op_sel:[1,1,0] op_sel_hi:[1,0,1] neg_lo:[1,0,0]
    v_pk_fma_f32 v[52:53], v[52:53], v[48:49], v[62:63] op_sel:[1,1,0] op_sel_hi:[1,0,1] neg_lo:[1,0,0]
    v_cvt_pk_f16_f32 v64, v32, v33
    v_cvt_pk_f16_f32 v65, v52, v53
    ds_write_b64 v2, v[64:65] offset:528
    v_pk_mul_f32 v[42:43], v[32:33], v[28:29] op_sel:[0,0] op_sel_hi:[0,1]
    v_pk_mul_f32 v[62:63], v[52:53], v[48:49] op_sel:[0,0] op_sel_hi:[0,1]
    v_pk_fma_f32 v[32:33], v[32:33], v[28:29], v[42:43] op_sel:[1,1,0] op_sel_hi:[1,0,1] neg_lo:[1,0,0]
    v_pk_fma_f32 v[52:53], v[52:53], v[48:49], v[62:63] op_sel:[1,1,0] op_sel_hi:[1,0,1] neg_lo:[1,0,0]
    v_cvt_pk_f16_f32 v66, v32, v33
    v_cvt_pk_f16_f32 v67, v52, v53
    ds_write_b64 v2, v[66:67] offset:1056
    v_pk_mul_f32 v[42:43], v[32:33], v[28:29] op_sel:[0,0] op_sel_hi:[0,1]
    v_pk_mul_f32 v[62:63], v[52:53], v[48:49] op_sel:[0,0] op_sel_hi:[0,1]
    v_pk_fma_f32 v[32:33], v[32:33], v[28:29], v[42:43] op_sel:[1,1,0] op_sel_hi:[1,0,1] neg_lo:[1,0,0]
    v_pk_fma_f32 v[52:53], v[52:53], v[48:49], v[62:63] op_sel:[1,1,0] op_sel_hi:[1,0,1] neg_lo:[1,0,0]
    v_cvt_pk_f16_f32 v64, v32, v33
    v_cvt_pk_f16_f32 v65, v52, v53
    ds_write_b64 v2, v[64:65] offset:1584
    s_waitcnt lgkmcnt(4)
    v_mfma_f32_16x16x32_f16 v[68:71], v[84:87], v[148:151], 0
    v_mfma_f32_16x16x32_f16 v[72:75], v[116:119], v[148:151], 0
    v_pk_mul_f32 v[42:43], v[32:33], v[28:29] op_sel:[0,0] op_sel_hi:[0,1]
    v_pk_mul_f32 v[62:63], v[52:53], v[48:49] op_sel:[0,0] op_sel_hi:[0,1]
    v_pk_fma_f32 v[32:33], v[32:33], v[28:29], v[42:43] op_sel:[1,1,0] op_sel_hi:[1,0,1] neg_lo:[1,0,0]
    v_pk_fma_f32 v[52:53], v[52:53], v[48:49], v[62:63] op_sel:[1,1,0] op_sel_hi:[1,0,1] neg_lo:[1,0,0]
    v_cvt_pk_f16_f32 v66, v32, v33
    v_cvt_pk_f16_f32 v67, v52, v53
    ds_write_b64 v2, v[66:67] offset:2112
    v_mfma_f32_16x16x32_f16 v[68:71], v[88:91], v[152:155], v[68:71]
    v_mfma_f32_16x16x32_f16 v[72:75], v[120:123], v[152:155], v[72:75]
    v_pk_mul_f32 v[42:43], v[32:33], v[28:29] op_sel:[0,0] op_sel_hi:[0,1]
    v_pk_mul_f32 v[62:63], v[52:53], v[48:49] op_sel:[0,0] op_sel_hi:[0,1]
    v_pk_fma_f32 v[32:33], v[32:33], v[28:29], v[42:43] op_sel:[1,1,0] op_sel_hi:[1,0,1] neg_lo:[1,0,0]
    v_pk_fma_f32 v[52:53], v[52:53], v[48:49], v[62:63] op_sel:[1,1,0] op_sel_hi:[1,0,1] neg_lo:[1,0,0]
    v_cvt_pk_f16_f32 v64, v32, v33
    v_cvt_pk_f16_f32 v65, v52, v53
    ds_write_b64 v2, v[64:65] offset:2640
    v_mfma_f32_16x16x32_f16 v[68:71], v[92:95], v[156:159], v[68:71]
    v_mfma_f32_16x16x32_f16 v[72:75], v[124:127], v[156:159], v[72:75]
    v_pk_mul_f32 v[42:43], v[32:33], v[28:29] op_sel:[0,0] op_sel_hi:[0,1]
    v_pk_mul_f32 v[62:63], v[52:53], v[48:49] op_sel:[0,0] op_sel_hi:[0,1]
    v_pk_fma_f32 v[32:33], v[32:33], v[28:29], v[42:43] op_sel:[1,1,0] op_sel_hi:[1,0,1] neg_lo:[1,0,0]
    v_pk_fma_f32 v[52:53], v[52:53], v[48:49], v[62:63] op_sel:[1,1,0] op_sel_hi:[1,0,1] neg_lo:[1,0,0]
    v_cvt_pk_f16_f32 v66, v32, v33
    v_cvt_pk_f16_f32 v67, v52, v53
    ds_write_b64 v2, v[66:67] offset:3168
    v_mfma_f32_16x16x32_f16 v[68:71], v[96:99], v[160:163], v[68:71]
    v_mfma_f32_16x16x32_f16 v[72:75], v[128:131], v[160:163], v[72:75]
    v_pk_mul_f32 v[42:43], v[32:33], v[28:29] op_sel:[0,0] op_sel_hi:[0,1]
    v_pk_mul_f32 v[62:63], v[52:53], v[48:49] op_sel:[0,0] op_sel_hi:[0,1]
    v_pk_fma_f32 v[32:33], v[32:33], v[28:29], v[42:43] op_sel:[1,1,0] op_sel_hi:[1,0,1] neg_lo:[1,0,0]
    v_pk_fma_f32 v[52:53], v[52:53], v[48:49], v[62:63] op_sel:[1,1,0] op_sel_hi:[1,0,1] neg_lo:[1,0,0]
    v_cvt_pk_f16_f32 v64, v32, v33
    v_cvt_pk_f16_f32 v65, v52, v53
    ds_write_b64 v2, v[64:65] offset:3696
    v_mfma_f32_16x16x32_f16 v[68:71], v[100:103], v[164:167], v[68:71]
    v_mfma_f32_16x16x32_f16 v[72:75], v[132:135], v[164:167], v[72:75]
    v_pk_mul_f32 v[42:43], v[32:33], v[28:29] op_sel:[0,0] op_sel_hi:[0,1]
    v_pk_mul_f32 v[62:63], v[52:53], v[48:49] op_sel:[0,0] op_sel_hi:[0,1]
    v_pk_fma_f32 v[32:33], v[32:33], v[28:29], v[42:43] op_sel:[1,1,0] op_sel_hi:[1,0,1] neg_lo:[1,0,0]
    v_pk_fma_f32 v[52:53], v[52:53], v[48:49], v[62:63] op_sel:[1,1,0] op_sel_hi:[1,0,1] neg_lo:[1,0,0]
    v_cvt_pk_f16_f32 v66, v32, v33
    v_cvt_pk_f16_f32 v67, v52, v53
    ds_write_b64 v2, v[66:67] offset:4224
    v_mfma_f32_16x16x32_f16 v[68:71], v[104:107], v[168:171], v[68:71]
    v_mfma_f32_16x16x32_f16 v[72:75], v[136:139], v[168:171], v[72:75]
    v_pk_mul_f32 v[42:43], v[32:33], v[28:29] op_sel:[0,0] op_sel_hi:[0,1]
    v_pk_mul_f32 v[62:63], v[52:53], v[48:49] op_sel:[0,0] op_sel_hi:[0,1]
    v_pk_fma_f32 v[32:33], v[32:33], v[28:29], v[42:43] op_sel:[1,1,0] op_sel_hi:[1,0,1] neg_lo:[1,0,0]
    v_pk_fma_f32 v[52:53], v[52:53], v[48:49], v[62:63] op_sel:[1,1,0] op_sel_hi:[1,0,1] neg_lo:[1,0,0]
    v_cvt_pk_f16_f32 v64, v32, v33
    v_cvt_pk_f16_f32 v65, v52, v53
    ds_write_b64 v2, v[64:65] offset:4752
    v_mfma_f32_16x16x32_f16 v[68:71], v[108:111], v[172:175], v[68:71]
    v_mfma_f32_16x16x32_f16 v[72:75], v[140:143], v[172:175], v[72:75]
    v_pk_mul_f32 v[42:43], v[32:33], v[28:29] op_sel:[0,0] op_sel_hi:[0,1]
    v_pk_mul_f32 v[62:63], v[52:53], v[48:49] op_sel:[0,0] op_sel_hi:[0,1]
    v_pk_fma_f32 v[32:33], v[32:33], v[28:29], v[42:43] op_sel:[1,1,0] op_sel_hi:[1,0,1] neg_lo:[1,0,0]
    v_pk_fma_f32 v[52:53], v[52:53], v[48:49], v[62:63] op_sel:[1,1,0] op_sel_hi:[1,0,1] neg_lo:[1,0,0]
    v_cvt_pk_f16_f32 v66, v32, v33
    v_cvt_pk_f16_f32 v67, v52, v53
    ds_write_b64 v2, v[66:67] offset:5280
    v_mfma_f32_16x16x32_f16 v[68:71], v[112:115], v[176:179], v[68:71]
    v_mfma_f32_16x16x32_f16 v[72:75], v[144:147], v[176:179], v[72:75]
    v_pk_mul_f32 v[42:43], v[32:33], v[28:29] op_sel:[0,0] op_sel_hi:[0,1]
    v_pk_mul_f32 v[62:63], v[52:53], v[48:49] op_sel:[0,0] op_sel_hi:[0,1]
    v_pk_fma_f32 v[32:33], v[32:33], v[28:29], v[42:43] op_sel:[1,1,0] op_sel_hi:[1,0,1] neg_lo:[1,0,0]
    v_pk_fma_f32 v[52:53], v[52:53], v[48:49], v[62:63] op_sel:[1,1,0] op_sel_hi:[1,0,1] neg_lo:[1,0,0]
    v_cvt_pk_f16_f32 v64, v32, v33
    v_cvt_pk_f16_f32 v65, v52, v53
    ds_write_b64 v2, v[64:65] offset:5808
    v_pk_mul_f32 v[42:43], v[32:33], v[28:29] op_sel:[0,0] op_sel_hi:[0,1]
    v_pk_mul_f32 v[62:63], v[52:53], v[48:49] op_sel:[0,0] op_sel_hi:[0,1]
    v_pk_fma_f32 v[32:33], v[32:33], v[28:29], v[42:43] op_sel:[1,1,0] op_sel_hi:[1,0,1] neg_lo:[1,0,0]
    v_pk_fma_f32 v[52:53], v[52:53], v[48:49], v[62:63] op_sel:[1,1,0] op_sel_hi:[1,0,1] neg_lo:[1,0,0]
    v_cvt_pk_f16_f32 v66, v32, v33
    v_cvt_pk_f16_f32 v67, v52, v53
    ds_write_b64 v2, v[66:67] offset:6336
    ds_read_b32 v17, v3
    v_pk_mul_f32 v[42:43], v[32:33], v[28:29] op_sel:[0,0] op_sel_hi:[0,1]
    v_pk_mul_f32 v[62:63], v[52:53], v[48:49] op_sel:[0,0] op_sel_hi:[0,1]
    v_pk_fma_f32 v[32:33], v[32:33], v[28:29], v[42:43] op_sel:[1,1,0] op_sel_hi:[1,0,1] neg_lo:[1,0,0]
    v_pk_fma_f32 v[52:53], v[52:53], v[48:49], v[62:63] op_sel:[1,1,0] op_sel_hi:[1,0,1] neg_lo:[1,0,0]
    v_cvt_pk_f16_f32 v64, v32, v33
    v_cvt_pk_f16_f32 v65, v52, v53
    ds_write_b64 v2, v[64:65] offset:6864
    v_pk_mul_f32 v[42:43], v[32:33], v[28:29] op_sel:[0,0] op_sel_hi:[0,1]
    v_pk_mul_f32 v[62:63], v[52:53], v[48:49] op_sel:[0,0] op_sel_hi:[0,1]
    v_pk_fma_f32 v[32:33], v[32:33], v[28:29], v[42:43] op_sel:[1,1,0] op_sel_hi:[1,0,1] neg_lo:[1,0,0]
    v_pk_fma_f32 v[52:53], v[52:53], v[48:49], v[62:63] op_sel:[1,1,0] op_sel_hi:[1,0,1] neg_lo:[1,0,0]
    v_cvt_pk_f16_f32 v66, v32, v33
    v_cvt_pk_f16_f32 v67, v52, v53
    ds_write_b64 v2, v[66:67] offset:7392
    s_waitcnt lgkmcnt(2)
K1_PW:
    v_readfirstlane_b32 s50, v17
    s_nop 0
    s_cmp_lg_u32 s50, 0
    s_cbranch_scc1 K1_PR
    ds_read_b32 v17, v3
    s_waitcnt lgkmcnt(0)
    s_branch K1_PW
K1_PR:
    ds_read_b128 v[180:183], v211 offset:0
    ds_read_b128 v[184:187], v211 offset:1024
    ds_read_b128 v[76:79], v211 offset:2048
    ds_read_b128 v[80:83], v211 offset:3072
    v_pk_mul_f32 v[42:43], v[32:33], v[28:29] op_sel:[0,0] op_sel_hi:[0,1]
    v_pk_mul_f32 v[62:63], v[52:53], v[48:49] op_sel:[0,0] op_sel_hi:[0,1]
    v_pk_fma_f32 v[32:33], v[32:33], v[28:29], v[42:43] op_sel:[1,1,0] op_sel_hi:[1,0,1] neg_lo:[1,0,0]
    v_pk_fma_f32 v[52:53], v[52:53], v[48:49], v[62:63] op_sel:[1,1,0] op_sel_hi:[1,0,1] neg_lo:[1,0,0]
    v_cvt_pk_f16_f32 v64, v32, v33
    v_cvt_pk_f16_f32 v65, v52, v53
    ds_write_b64 v2, v[64:65] offset:7920
    ds_read_b128 v[148:151], v4 offset:0
    ds_read_b128 v[152:155], v4 offset:64
    ds_read_b128 v[156:159], v4 offset:128
    ds_read_b128 v[160:163], v4 offset:192
    ds_read_b128 v[164:167], v4 offset:256
    ds_read_b128 v[168:171], v4 offset:320
    ds_read_b128 v[172:175], v4 offset:384
    ds_read_b128 v[176:179], v4 offset:448
    s_waitcnt lgkmcnt(7)
    v_mfma_f32_16x16x32_f16 v[76:79], v[84:87], v[148:151], v[76:79]
    v_mfma_f32_16x16x32_f16 v[80:83], v[116:119], v[148:151], v[80:83]
    v_add_f32 v68, v68, v180
    v_add_f32 v69, v69, v181
    v_add_f32 v70, v70, v182
    v_add_f32 v71, v71, v183
    s_waitcnt lgkmcnt(6)
    v_mfma_f32_16x16x32_f16 v[76:79], v[88:91], v[152:155], v[76:79]
    v_mfma_f32_16x16x32_f16 v[80:83], v[120:123], v[152:155], v[80:83]
    v_add_f32 v72, v72, v184
    v_add_f32 v73, v73, v185
    v_add_f32 v74, v74, v186
    v_add_f32 v75, v75, v187
    s_waitcnt lgkmcnt(5)
    v_mfma_f32_16x16x32_f16 v[76:79], v[92:95], v[156:159], v[76:79]
    v_mfma_f32_16x16x32_f16 v[80:83], v[124:127], v[156:159], v[80:83]
    ds_write_b64 v5, v[68:69]
    s_waitcnt lgkmcnt(5)
    v_mfma_f32_16x16x32_f16 v[76:79], v[96:99], v[160:163], v[76:79]
    v_mfma_f32_16x16x32_f16 v[80:83], v[128:131], v[160:163], v[80:83]
    ds_write_b64 v6, v[70:71]
    s_waitcnt lgkmcnt(5)
    v_mfma_f32_16x16x32_f16 v[76:79], v[100:103], v[164:167], v[76:79]
    v_mfma_f32_16x16x32_f16 v[80:83], v[132:135], v[164:167], v[80:83]
    ds_write2_b32 v9, v72, v73 offset0:0 offset1:32
    s_waitcnt lgkmcnt(5)
    v_mfma_f32_16x16x32_f16 v[76:79], v[104:107], v[168:171], v[76:79]
    v_mfma_f32_16x16x32_f16 v[80:83], v[136:139], v[168:171], v[80:83]
    ds_write2_b32 v9, v74, v75 offset0:64 offset1:96
    s_waitcnt lgkmcnt(5)
    v_mfma_f32_16x16x32_f16 v[76:79], v[108:111], v[172:175], v[76:79]
    v_mfma_f32_16x16x32_f16 v[80:83], v[140:143], v[172:175], v[80:83]
    v_mul_f32 v15, s48, v12
    v_add_f32 v15, v15, v15
    s_waitcnt lgkmcnt(4)
    v_mfma_f32_16x16x32_f16 v[76:79], v[112:115], v[176:179], v[76:79]
    v_mfma_f32_16x16x32_f16 v[80:83], v[144:147], v[176:179], v[80:83]
    s_nop 6
    ds_write_b64 v7, v[76:77]
    ds_write_b64 v8, v[78:79]
    ds_write2_b32 v9, v80, v81 offset0:16 offset1:48
    ds_write2_b32 v9, v82, v83 offset0:80 offset1:112
    ds_read_b64 v[44:45], v206 offset:512
    ds_read_b32 v46, v206 offset:520
    ds_read_b64 v[48:49], v206
    ds_read_b32 v50, v206 offset:8
    ds_read_b32 v51, v207 offset:12
    ds_read_b128 v[24:27], v204
    ds_read_b128 v[28:31], v204 offset:16
    ds_read_b32 v32, v204 offset:32
    ds_read2_b32 v[34:35], v205 offset0:9 offset1:10
    ds_read2_b64 v[36:39], v206 offset0:127 offset1:128
    ds_read_b32 v42, v206 offset:1032
    s_waitcnt lgkmcnt(9)
    v_mov_b32 v47, v46
    v_writelane_b32 v47, 0, 63
    v_cvt_pk_f16_f32 v92, v46, v46
    v_cvt_pk_f16_f32 v93, v45, v45
    v_cvt_pk_f16_f32 v94, v45, v44
    v_cvt_pk_f16_f32 v95, v44, v44
    ds_write_b128 v208, v[92:95] offset:0
    v_cvt_pk_f16_f32 v92, v47, v46
    v_cvt_pk_f16_f32 v93, v46, v45
    v_cvt_pk_f16_f32 v94, v45, v45
    ds_write_b128 v208, v[92:95] offset:2752
    v_cvt_pk_f16_f32 v92, v47, v47
    v_cvt_pk_f16_f32 v93, v46, v46
    v_cvt_pk_f16_f32 v95, v45, v44
    ds_write_b128 v208, v[92:95] offset:5504
    v_cvt_pk_f16_f32 v93, v47, v46
    v_cvt_pk_f16_f32 v94, v46, v45
    v_cvt_pk_f16_f32 v95, v45, v45
    ds_write_b128 v208, v[92:95] offset:8256
    s_waitcnt lgkmcnt(10)
    v_cvt_pk_f16_f32 v96, v50, v49
    v_cvt_pk_f16_f32 v97, v48, v48
    ds_write_b64 v209, v[96:97] offset:0
    v_cvt_pk_f16_f32 v96, v50, v50
    v_cvt_pk_f16_f32 v97, v49, v48
    ds_write_b64 v209, v[96:97] offset:2752
    v_cvt_pk_f16_f32 v97, v50, v49
    ds_write_b64 v209, v[96:97] offset:5504
    v_cvt_pk_f16_f32 v96, v51, v50
    v_cvt_pk_f16_f32 v97, v50, v50
    ds_write_b64 v209, v[96:97] offset:8256
    s_waitcnt lgkmcnt(8)
    s_mov_b32 exec_hi, 7
    v_cvt_pk_f16_f32 v100, v31, v30
    v_cvt_pk_f16_f32 v101, v29, v28
    v_cvt_pk_f16_f32 v102, v27, v26
    v_cvt_pk_f16_f32 v103, v25, v24
    ds_write_b128 v208, v[100:103] offset:1072
    v_cvt_pk_f16_f32 v104, v32, v31
    v_cvt_pk_f16_f32 v105, v30, v29
    v_cvt_pk_f16_f32 v106, v28, v27
    v_cvt_pk_f16_f32 v107, v26, v25
    ds_write_b128 v208, v[104:107] offset:3824
    v_cvt_pk_f16_f32 v108, v34, v32
    v_cvt_pk_f16_f32 v109, v31, v30
    v_cvt_pk_f16_f32 v110, v29, v28
    v_cvt_pk_f16_f32 v111, v27, v26
    ds_write_b128 v208, v[108:111] offset:6576
    v_cvt_pk_f16_f32 v112, v35, v34
    v_cvt_pk_f16_f32 v113, v32, v31
    v_cvt_pk_f16_f32 v114, v30, v29
    v_cvt_pk_f16_f32 v115, v28, v27
    ds_write_b128 v208, v[112:115] offset:9328
    s_mov_b64 exec, -1
    v_mov_b32 v40, v38
    v_writelane_b32 v36, 0, 0
    v_writelane_b32 v37, 0, 0
    v_writelane_b32 v40, 0, 0
    v_cvt_pk_f16_f32 v226, v38, v36
    v_cvt_pk_f16_f32 v227, v39, v37
    v_cvt_pk_f16_f32 v211, v42, v40
    ds_write_b32 v210, v226 offset:2176
    ds_write_b32 v210, v226 offset:7684
    ds_write_b32 v210, v227 offset:2352
    ds_write_b32 v210, v227 offset:7860
    ds_write_b32 v210, v211 offset:2528
    ds_write_b32 v210, v211 offset:8036
    s_waitcnt vmcnt(0)
    s_setprio 2
    ds_read_b64 v[252:253], v200 offset:0
    ds_read_b64 v[254:255], v200 offset:8
    ds_read_b64 v[68:69], v200 offset:512
    ds_read_b64 v[70:71], v200 offset:520
    ds_read_b64 v[64:65], v200 offset:1024
    ds_read_b64 v[66:67], v200 offset:1032
    ds_read_b64 v[60:61], v200 offset:1536
    ds_read_b64 v[62:63], v200 offset:1544
    ds_read_b64 v[56:57], v200 offset:2048
    ds_read_b64 v[58:59], v200 offset:2056
    s_barrier
    ds_read_b128 v[88:91], v201 offset:448
    ds_read_b128 v[92:95], v201 offset:960
    ds_read_b128 v[96:99], v201 offset:1472
    ds_read_b128 v[100:103], v201 offset:1984
    s_waitcnt lgkmcnt(3)
    v_mfma_f32_16x16x32_f16 v[152:155], v[88:91], v[212:215], 0
    ds_read_b128 v[104:107], v201 offset:2496
    v_mfma_f32_16x16x32_f16 v[168:171], v[88:91], v[216:219], 0
    ds_read_b128 v[108:111], v201 offset:3008
    v_mfma_f32_16x16x32_f16 v[184:187], v[88:91], v[220:223], 0
    ds_read_b128 v[112:115], v201 offset:3520
    s_waitcnt lgkmcnt(5)
    v_mfma_f32_16x16x32_f16 v[156:159], v[92:95], v[212:215], 0
    ds_read_b128 v[116:119], v201 offset:4032
    v_mfma_f32_16x16x32_f16 v[172:175], v[92:95], v[216:219], 0
    ds_read_b64 v[84:85], v200 offset:448
    v_mfma_f32_16x16x32_f16 v[188:191], v[92:95], v[220:223], 0
    ds_read_b64 v[86:87], v200 offset:456
    s_waitcnt lgkmcnt(7)
    v_mfma_f32_16x16x32_f16 v[160:163], v[96:99], v[212:215], 0
    ds_read_b128 v[120:123], v201 offset:384
    v_mfma_f32_16x16x32_f16 v[176:179], v[96:99], v[216:219], 0
    ds_read_b128 v[124:127], v201 offset:896
    v_mfma_f32_16x16x32_f16 v[192:195], v[96:99], v[220:223], 0
    ds_read_b128 v[128:131], v201 offset:1408
    s_waitcnt lgkmcnt(9)
    v_mfma_f32_16x16x32_f16 v[164:167], v[100:103], v[212:215], 0
    ds_read_b128 v[132:135], v201 offset:1920
    v_mfma_f32_16x16x32_f16 v[180:183], v[100:103], v[216:219], 0
    ds_read_b128 v[136:139], v201 offset:2432
    v_mfma_f32_16x16x32_f16 v[196:199], v[100:103], v[220:223], 0
    ds_read_b64 v[80:81], v200 offset:960
    v_mfma_f32_16x16x32_f16 v[40:43], v[252:255], v[88:91], 0
    ds_read_b64 v[82:83], v200 offset:968
    v_mfma_f32_16x16x32_f16 v[44:47], v[252:255], v[92:95], 0
    ds_read_b128 v[140:143], v201 offset:2944
    v_mfma_f32_16x16x32_f16 v[48:51], v[252:255], v[96:99], 0
    ds_read_b64 v[76:77], v200 offset:1472
    v_mfma_f32_16x16x32_f16 v[52:55], v[252:255], v[100:103], 0
    ds_read_b64 v[78:79], v200 offset:1480
    s_waitcnt lgkmcnt(12)
    v_mfma_f32_16x16x32_f16 v[36:39], v[68:71], v[88:91], 0
    ds_read_b128 v[144:147], v201 offset:3456
    v_mfma_f32_16x16x32_f16 v[40:43], v[68:71], v[92:95], v[40:43]
    ds_read_b64 v[72:73], v200 offset:1984
    v_mfma_f32_16x16x32_f16 v[44:47], v[68:71], v[96:99], v[44:47]
    ds_read_b64 v[74:75], v200 offset:1992
    v_mfma_f32_16x16x32_f16 v[48:51], v[68:71], v[100:103], v[48:51]
    ds_read_b128 v[148:151], v201 offset:3968
    v_mfma_f32_16x16x32_f16 v[52:55], v[68:71], v[104:107], v[52:55]
    v_cvt_pk_f16_f32 v228, v152, v153
    v_cvt_pk_f16_f32 v229, v154, v155
    v_mfma_f32_16x16x32_f16 v[32:35], v[64:67], v[88:91], 0
    v_cvt_pk_f16_f32 v230, v156, v157
    v_cvt_pk_f16_f32 v231, v158, v159
    v_mfma_f32_16x16x32_f16 v[36:39], v[64:67], v[92:95], v[36:39]
    v_cvt_pk_f16_f32 v232, v160, v161
    v_cvt_pk_f16_f32 v233, v162, v163
    v_mfma_f32_16x16x32_f16 v[40:43], v[64:67], v[96:99], v[40:43]
    v_cvt_pk_f16_f32 v234, v164, v165
    v_cvt_pk_f16_f32 v235, v166, v167
    v_mfma_f32_16x16x32_f16 v[44:47], v[64:67], v[100:103], v[44:47]
    v_cvt_pk_f16_f32 v236, v168, v169
    v_cvt_pk_f16_f32 v237, v170, v171
    v_mfma_f32_16x16x32_f16 v[48:51], v[64:67], v[104:107], v[48:51]
    v_cvt_pk_f16_f32 v238, v172, v173
    v_cvt_pk_f16_f32 v239, v174, v175
    v_mfma_f32_16x16x32_f16 v[52:55], v[64:67], v[108:111], v[52:55]
    v_cvt_pk_f16_f32 v240, v176, v177
    v_cvt_pk_f16_f32 v241, v178, v179
    v_mfma_f32_16x16x32_f16 v[28:31], v[60:63], v[88:91], 0
    v_cvt_pk_f16_f32 v242, v180, v181
    v_cvt_pk_f16_f32 v243, v182, v183
    v_mfma_f32_16x16x32_f16 v[32:35], v[60:63], v[92:95], v[32:35]
    v_cvt_pk_f16_f32 v244, v184, v185
    v_cvt_pk_f16_f32 v245, v186, v187
    v_mfma_f32_16x16x32_f16 v[36:39], v[60:63], v[96:99], v[36:39]
    v_cvt_pk_f16_f32 v246, v188, v189
    v_cvt_pk_f16_f32 v247, v190, v191
    v_mfma_f32_16x16x32_f16 v[40:43], v[60:63], v[100:103], v[40:43]
    v_cvt_pk_f16_f32 v248, v192, v193
    v_cvt_pk_f16_f32 v249, v194, v195
    v_mfma_f32_16x16x32_f16 v[44:47], v[60:63], v[104:107], v[44:47]
    v_cvt_pk_f16_f32 v250, v196, v197
    v_cvt_pk_f16_f32 v251, v198, v199
    v_mfma_f32_16x16x32_f16 v[48:51], v[60:63], v[108:111], v[48:51]
    ds_read_b64 v[158:159], v224 offset:2272
    v_mfma_f32_16x16x32_f16 v[52:55], v[60:63], v[112:115], v[52:55]
    ds_read_b64 v[156:157], v224 offset:2240
    v_mfma_f32_16x16x32_f16 v[24:27], v[56:59], v[88:91], 0
    ds_read_b64 v[154:155], v224 offset:2208
    v_mfma_f32_16x16x32_f16 v[28:31], v[56:59], v[92:95], v[28:31]
    ds_read_b64 v[152:153], v224 offset:2176
    v_mfma_f32_16x16x32_f16 v[32:35], v[56:59], v[96:99], v[32:35]
    ds_read_b64 v[168:169], v224 offset:2448
    v_mfma_f32_16x16x32_f16 v[36:39], v[56:59], v[100:103], v[36:39]
    ds_read_b64 v[166:167], v224 offset:2416
    v_mfma_f32_16x16x32_f16 v[40:43], v[56:59], v[104:107], v[40:43]
    ds_read_b64 v[164:165], v224 offset:2384
    v_mfma_f32_16x16x32_f16 v[44:47], v[56:59], v[108:111], v[44:47]
    ds_read_b64 v[162:163], v224 offset:2352
    v_mfma_f32_16x16x32_f16 v[48:51], v[56:59], v[112:115], v[48:51]
    ds_read_b64 v[178:179], v224 offset:2624
    v_mfma_f32_16x16x32_f16 v[52:55], v[56:59], v[116:119], v[52:55]
    ds_read_b64 v[176:177], v224 offset:2592
    s_waitcnt lgkmcnt(10)
    v_mfma_f32_16x16x32_f16 v[36:39], v[84:87], v[120:123], v[36:39]
    ds_read_b64 v[68:69], v200 offset:384
    v_mfma_f32_16x16x32_f16 v[40:43], v[84:87], v[124:127], v[40:43]
    ds_read_b64 v[70:71], v200 offset:392
    v_mfma_f32_16x16x32_f16 v[44:47], v[84:87], v[128:131], v[44:47]
    ds_read_b128 v[88:91], v201 offset:320
    v_mfma_f32_16x16x32_f16 v[48:51], v[84:87], v[132:135], v[48:51]
    ds_read_b128 v[92:95], v201 offset:832
    v_mfma_f32_16x16x32_f16 v[52:55], v[84:87], v[136:139], v[52:55]
    ds_read_b128 v[96:99], v201 offset:1344
    v_mfma_f32_16x16x32_f16 v[32:35], v[80:83], v[120:123], v[32:35]
    ds_read_b128 v[100:103], v201 offset:1856
    v_mfma_f32_16x16x32_f16 v[36:39], v[80:83], v[124:127], v[36:39]
    ds_read_b128 v[104:107], v201 offset:2368
    v_mfma_f32_16x16x32_f16 v[40:43], v[80:83], v[128:131], v[40:43]
    ds_read_b64 v[64:65], v200 offset:896
    v_mfma_f32_16x16x32_f16 v[44:47], v[80:83], v[132:135], v[44:47]
    ds_read_b64 v[66:67], v200 offset:904
    v_mfma_f32_16x16x32_f16 v[48:51], v[80:83], v[136:139], v[48:51]
    ds_read_b128 v[108:111], v201 offset:2880
    v_mfma_f32_16x16x32_f16 v[52:55], v[80:83], v[140:143], v[52:55]
    ds_read_b64 v[60:61], v200 offset:1408
    v_mfma_f32_16x16x32_f16 v[28:31], v[76:79], v[120:123], v[28:31]
    ds_read_b64 v[62:63], v200 offset:1416
    v_mfma_f32_16x16x32_f16 v[32:35], v[76:79], v[124:127], v[32:35]
    ds_read_b128 v[112:115], v201 offset:3392
    v_mfma_f32_16x16x32_f16 v[36:39], v[76:79], v[128:131], v[36:39]
    ds_read_b64 v[56:57], v200 offset:1920
    v_mfma_f32_16x16x32_f16 v[40:43], v[76:79], v[132:135], v[40:43]
    ds_read_b64 v[58:59], v200 offset:1928
    v_mfma_f32_16x16x32_f16 v[44:47], v[76:79], v[136:139], v[44:47]
    ds_read_b128 v[116:119], v201 offset:3904
    v_mfma_f32_16x16x32_f16 v[48:51], v[76:79], v[140:143], v[48:51]
    ds_read_b64 v[174:175], v224 offset:2560
    v_mfma_f32_16x16x32_f16 v[52:55], v[76:79], v[144:147], v[52:55]
    ds_read_b64 v[172:173], v224 offset:2528
    v_mfma_f32_16x16x32_f16 v[24:27], v[72:75], v[120:123], v[24:27]
    v_mov_b32 v160, 0
    v_mov_b32 v161, 0
    v_mfma_f32_16x16x32_f16 v[28:31], v[72:75], v[124:127], v[28:31]
    v_mov_b32 v170, 0
    v_mov_b32 v171, 0
    v_mfma_f32_16x16x32_f16 v[32:35], v[72:75], v[128:131], v[32:35]
    v_mov_b32 v180, 0
    v_mov_b32 v181, 0
    v_mfma_f32_16x16x32_f16 v[36:39], v[72:75], v[132:135], v[36:39]
    v_mfma_f32_16x16x32_f16 v[40:43], v[72:75], v[136:139], v[40:43]
    v_mfma_f32_16x16x32_f16 v[44:47], v[72:75], v[140:143], v[44:47]
    v_mfma_f32_16x16x32_f16 v[48:51], v[72:75], v[144:147], v[48:51]
    v_mfma_f32_16x16x32_f16 v[52:55], v[72:75], v[148:151], v[52:55]
    s_waitcnt lgkmcnt(2)
    v_mfma_f32_16x16x32_f16 v[36:39], v[68:71], v[88:91], v[36:39]
    ds_read_b64 v[84:85], v200 offset:320
    v_mfma_f32_16x16x32_f16 v[40:43], v[68:71], v[92:95], v[40:43]
    ds_read_b64 v[86:87], v200 offset:328
    v_mfma_f32_16x16x32_f16 v[44:47], v[68:71], v[96:99], v[44:47]
    ds_read_b128 v[120:123], v201 offset:256
    v_mfma_f32_16x16x32_f16 v[48:51], v[68:71], v[100:103], v[48:51]
    ds_read_b128 v[124:127], v201 offset:768
    v_mfma_f32_16x16x32_f16 v[52:55], v[68:71], v[104:107], v[52:55]
    ds_read_b128 v[128:131], v201 offset:1280
    v_mfma_f32_16x16x32_f16 v[32:35], v[64:67], v[88:91], v[32:35]
    ds_read_b128 v[132:135], v201 offset:1792
    v_mfma_f32_16x16x32_f16 v[36:39], v[64:67], v[92:95], v[36:39]
    ds_read_b128 v[136:139], v201 offset:2304
    v_mfma_f32_16x16x32_f16 v[40:43], v[64:67], v[96:99], v[40:43]
    ds_read_b64 v[80:81], v200 offset:832
    v_mfma_f32_16x16x32_f16 v[44:47], v[64:67], v[100:103], v[44:47]
    ds_read_b64 v[82:83], v200 offset:840
    v_mfma_f32_16x16x32_f16 v[48:51], v[64:67], v[104:107], v[48:51]
    ds_read_b128 v[140:143], v201 offset:2816
    v_mfma_f32_16x16x32_f16 v[52:55], v[64:67], v[108:111], v[52:55]
    ds_read_b64 v[76:77], v200 offset:1344
    v_mfma_f32_16x16x32_f16 v[28:31], v[60:63], v[88:91], v[28:31]
    ds_read_b64 v[78:79], v200 offset:1352
    v_mfma_f32_16x16x32_f16 v[32:35], v[60:63], v[92:95], v[32:35]
    ds_read_b128 v[144:147], v201 offset:3328
    v_mfma_f32_16x16x32_f16 v[36:39], v[60:63], v[96:99], v[36:39]
    ds_read_b64 v[72:73], v200 offset:1856
    v_mfma_f32_16x16x32_f16 v[40:43], v[60:63], v[100:103], v[40:43]
    ds_read_b64 v[74:75], v200 offset:1864
    v_mfma_f32_16x16x32_f16 v[44:47], v[60:63], v[104:107], v[44:47]
    ds_read_b128 v[148:151], v201 offset:3840
    v_mfma_f32_16x16x32_f16 v[48:51], v[60:63], v[108:111], v[48:51]
    v_mfma_f32_16x16x32_f16 v[52:55], v[60:63], v[112:115], v[52:55]
    v_mfma_f32_16x16x32_f16 v[24:27], v[56:59], v[88:91], v[24:27]
    v_mfma_f32_16x16x32_f16 v[28:31], v[56:59], v[92:95], v[28:31]
    v_mfma_f32_16x16x32_f16 v[32:35], v[56:59], v[96:99], v[32:35]
    v_mfma_f32_16x16x32_f16 v[36:39], v[56:59], v[100:103], v[36:39]
    v_mfma_f32_16x16x32_f16 v[40:43], v[56:59], v[104:107], v[40:43]
    v_mfma_f32_16x16x32_f16 v[44:47], v[56:59], v[108:111], v[44:47]
    v_mfma_f32_16x16x32_f16 v[48:51], v[56:59], v[112:115], v[48:51]
    v_mfma_f32_16x16x32_f16 v[52:55], v[56:59], v[116:119], v[52:55]
    s_waitcnt lgkmcnt(0)
    v_mfma_f32_16x16x32_f16 v[36:39], v[84:87], v[120:123], v[36:39]
    ds_read_b64 v[68:69], v200 offset:256
    v_mfma_f32_16x16x32_f16 v[40:43], v[84:87], v[124:127], v[40:43]
    ds_read_b64 v[70:71], v200 offset:264
    v_mfma_f32_16x16x32_f16 v[44:47], v[84:87], v[128:131], v[44:47]
    ds_read_b128 v[88:91], v201 offset:192
    v_mfma_f32_16x16x32_f16 v[48:51], v[84:87], v[132:135], v[48:51]
    ds_read_b128 v[92:95], v201 offset:704
    v_mfma_f32_16x16x32_f16 v[52:55], v[84:87], v[136:139], v[52:55]
    ds_read_b128 v[96:99], v201 offset:1216
    v_mfma_f32_16x16x32_f16 v[32:35], v[80:83], v[120:123], v[32:35]
    ds_read_b128 v[100:103], v201 offset:1728
    v_mfma_f32_16x16x32_f16 v[36:39], v[80:83], v[124:127], v[36:39]
    ds_read_b128 v[104:107], v201 offset:2240
    v_mfma_f32_16x16x32_f16 v[40:43], v[80:83], v[128:131], v[40:43]
    ds_read_b64 v[64:65], v200 offset:768
    v_mfma_f32_16x16x32_f16 v[44:47], v[80:83], v[132:135], v[44:47]
    ds_read_b64 v[66:67], v200 offset:776
    v_mfma_f32_16x16x32_f16 v[48:51], v[80:83], v[136:139], v[48:51]
    ds_read_b128 v[108:111], v201 offset:2752
    v_mfma_f32_16x16x32_f16 v[52:55], v[80:83], v[140:143], v[52:55]
    ds_read_b64 v[60:61], v200 offset:1280
    v_mfma_f32_16x16x32_f16 v[28:31], v[76:79], v[120:123], v[28:31]
    ds_read_b64 v[62:63], v200 offset:1288
    v_mfma_f32_16x16x32_f16 v[32:35], v[76:79], v[124:127], v[32:35]
    ds_read_b128 v[112:115], v201 offset:3264
    v_mfma_f32_16x16x32_f16 v[36:39], v[76:79], v[128:131], v[36:39]
    ds_read_b64 v[56:57], v200 offset:1792
    v_mfma_f32_16x16x32_f16 v[40:43], v[76:79], v[132:135], v[40:43]
    ds_read_b64 v[58:59], v200 offset:1800
    v_mfma_f32_16x16x32_f16 v[44:47], v[76:79], v[136:139], v[44:47]
    ds_read_b128 v[116:119], v201 offset:3776
    v_mfma_f32_16x16x32_f16 v[48:51], v[76:79], v[140:143], v[48:51]
    v_mfma_f32_16x16x32_f16 v[52:55], v[76:79], v[144:147], v[52:55]
    v_mfma_f32_16x16x32_f16 v[24:27], v[72:75], v[120:123], v[24:27]
    v_mfma_f32_16x16x32_f16 v[28:31], v[72:75], v[124:127], v[28:31]
    v_mfma_f32_16x16x32_f16 v[32:35], v[72:75], v[128:131], v[32:35]
    v_mfma_f32_16x16x32_f16 v[36:39], v[72:75], v[132:135], v[36:39]
    v_mfma_f32_16x16x32_f16 v[40:43], v[72:75], v[136:139], v[40:43]
    v_mfma_f32_16x16x32_f16 v[44:47], v[72:75], v[140:143], v[44:47]
    v_mfma_f32_16x16x32_f16 v[48:51], v[72:75], v[144:147], v[48:51]
    v_mfma_f32_16x16x32_f16 v[52:55], v[72:75], v[148:151], v[52:55]
    v_mfma_f32_16x16x32_f16 v[40:43], v[228:231], v[158:161], v[40:43]
    v_mfma_f32_16x16x32_f16 v[44:47], v[228:231], v[156:159], v[44:47]
    v_mfma_f32_16x16x32_f16 v[48:51], v[228:231], v[154:157], v[48:51]
    v_mfma_f32_16x16x32_f16 v[48:51], v[232:235], v[158:161], v[48:51]
    v_mfma_f32_16x16x32_f16 v[52:55], v[228:231], v[152:155], v[52:55]
    v_mfma_f32_16x16x32_f16 v[52:55], v[232:235], v[156:159], v[52:55]
    v_mfma_f32_16x16x32_f16 v[40:43], v[236:239], v[168:171], v[40:43]
    v_mfma_f32_16x16x32_f16 v[44:47], v[236:239], v[166:169], v[44:47]
    v_mfma_f32_16x16x32_f16 v[48:51], v[236:239], v[164:167], v[48:51]
    v_mfma_f32_16x16x32_f16 v[48:51], v[240:243], v[168:171], v[48:51]
    v_mfma_f32_16x16x32_f16 v[52:55], v[236:239], v[162:165], v[52:55]
    v_mfma_f32_16x16x32_f16 v[52:55], v[240:243], v[166:169], v[52:55]
    v_mfma_f32_16x16x32_f16 v[40:43], v[244:247], v[178:181], v[40:43]
    v_mfma_f32_16x16x32_f16 v[44:47], v[244:247], v[176:179], v[44:47]
    v_mfma_f32_16x16x32_f16 v[48:51], v[244:247], v[174:177], v[48:51]
    v_mfma_f32_16x16x32_f16 v[48:51], v[248:251], v[178:181], v[48:51]
    v_mfma_f32_16x16x32_f16 v[52:55], v[244:247], v[172:175], v[52:55]
    v_mfma_f32_16x16x32_f16 v[52:55], v[248:251], v[176:179], v[52:55]
    s_waitcnt lgkmcnt(0)
    v_mfma_f32_16x16x32_f16 v[36:39], v[68:71], v[88:91], v[36:39]
    ds_read_b64 v[84:85], v200 offset:192
    v_mfma_f32_16x16x32_f16 v[40:43], v[68:71], v[92:95], v[40:43]
    ds_read_b64 v[86:87], v200 offset:200
    v_mfma_f32_16x16x32_f16 v[44:47], v[68:71], v[96:99], v[44:47]
    ds_read_b128 v[120:123], v201 offset:128
    v_mfma_f32_16x16x32_f16 v[48:51], v[68:71], v[100:103], v[48:51]
    ds_read_b128 v[124:127], v201 offset:640
    v_mfma_f32_16x16x32_f16 v[52:55], v[68:71], v[104:107], v[52:55]
    ds_read_b128 v[128:131], v201 offset:1152
    v_mfma_f32_16x16x32_f16 v[32:35], v[64:67], v[88:91], v[32:35]
    ds_read_b128 v[132:135], v201 offset:1664
    v_mfma_f32_16x16x32_f16 v[36:39], v[64:67], v[92:95], v[36:39]
    ds_read_b128 v[136:139], v201 offset:2176
    v_mfma_f32_16x16x32_f16 v[40:43], v[64:67], v[96:99], v[40:43]
    ds_read_b64 v[80:81], v200 offset:704
    v_mfma_f32_16x16x32_f16 v[44:47], v[64:67], v[100:103], v[44:47]
    ds_read_b64 v[82:83], v200 offset:712
    v_mfma_f32_16x16x32_f16 v[48:51], v[64:67], v[104:107], v[48:51]
    ds_read_b128 v[140:143], v201 offset:2688
    v_mfma_f32_16x16x32_f16 v[52:55], v[64:67], v[108:111], v[52:55]
    ds_read_b64 v[76:77], v200 offset:1216
    v_mfma_f32_16x16x32_f16 v[28:31], v[60:63], v[88:91], v[28:31]
    ds_read_b64 v[78:79], v200 offset:1224
    v_mfma_f32_16x16x32_f16 v[32:35], v[60:63], v[92:95], v[32:35]
    ds_read_b128 v[144:147], v201 offset:3200
    v_mfma_f32_16x16x32_f16 v[36:39], v[60:63], v[96:99], v[36:39]
    ds_read_b64 v[72:73], v200 offset:1728
    v_mfma_f32_16x16x32_f16 v[40:43], v[60:63], v[100:103], v[40:43]
    ds_read_b64 v[74:75], v200 offset:1736
    v_mfma_f32_16x16x32_f16 v[44:47], v[60:63], v[104:107], v[44:47]
    ds_read_b128 v[148:151], v201 offset:3712
    v_mfma_f32_16x16x32_f16 v[48:51], v[60:63], v[108:111], v[48:51]
    ds_read_b64 v[154:155], v225 offset:0
    v_mfma_f32_16x16x32_f16 v[52:55], v[60:63], v[112:115], v[52:55]
    ds_read_b64 v[186:187], v202 offset:0
    v_mfma_f32_16x16x32_f16 v[24:27], v[56:59], v[88:91], v[24:27]
    ds_read_b64 v[158:159], v225 offset:512
    v_mfma_f32_16x16x32_f16 v[28:31], v[56:59], v[92:95], v[28:31]
    ds_read_b64 v[190:191], v202 offset:512
    v_mfma_f32_16x16x32_f16 v[32:35], v[56:59], v[96:99], v[32:35]
    ds_read_b64 v[162:163], v225 offset:1024
    v_mfma_f32_16x16x32_f16 v[36:39], v[56:59], v[100:103], v[36:39]
    ds_read_b64 v[194:195], v202 offset:1024
    v_mfma_f32_16x16x32_f16 v[40:43], v[56:59], v[104:107], v[40:43]
    ds_read_b64 v[166:167], v225 offset:1536
    v_mfma_f32_16x16x32_f16 v[44:47], v[56:59], v[108:111], v[44:47]
    ds_read_b64 v[198:199], v202 offset:1536
    v_mfma_f32_16x16x32_f16 v[48:51], v[56:59], v[112:115], v[48:51]
    ds_read_b64 v[170:171], v225 offset:2048
    v_mfma_f32_16x16x32_f16 v[52:55], v[56:59], v[116:119], v[52:55]
    ds_read_b64 v[230:231], v202 offset:2048
    s_waitcnt lgkmcnt(10)
    v_mfma_f32_16x16x32_f16 v[36:39], v[84:87], v[120:123], v[36:39]
    ds_read_b64 v[68:69], v200 offset:128
    v_mfma_f32_16x16x32_f16 v[40:43], v[84:87], v[124:127], v[40:43]
    ds_read_b64 v[70:71], v200 offset:136
    v_mfma_f32_16x16x32_f16 v[44:47], v[84:87], v[128:131], v[44:47]
    ds_read_b128 v[88:91], v201 offset:64
    v_mfma_f32_16x16x32_f16 v[48:51], v[84:87], v[132:135], v[48:51]
    ds_read_b128 v[92:95], v201 offset:576
    v_mfma_f32_16x16x32_f16 v[52:55], v[84:87], v[136:139], v[52:55]
    ds_read_b128 v[96:99], v201 offset:1088
    v_mfma_f32_16x16x32_f16 v[32:35], v[80:83], v[120:123], v[32:35]
    ds_read_b128 v[100:103], v201 offset:1600
    v_mfma_f32_16x16x32_f16 v[36:39], v[80:83], v[124:127], v[36:39]
    ds_read_b128 v[104:107], v201 offset:2112
    v_mfma_f32_16x16x32_f16 v[40:43], v[80:83], v[128:131], v[40:43]
    ds_read_b64 v[64:65], v200 offset:640
    v_mfma_f32_16x16x32_f16 v[44:47], v[80:83], v[132:135], v[44:47]
    ds_read_b64 v[66:67], v200 offset:648
    v_mfma_f32_16x16x32_f16 v[48:51], v[80:83], v[136:139], v[48:51]
    ds_read_b128 v[108:111], v201 offset:2624
    v_mfma_f32_16x16x32_f16 v[52:55], v[80:83], v[140:143], v[52:55]
    ds_read_b64 v[60:61], v200 offset:1152
    v_mfma_f32_16x16x32_f16 v[28:31], v[76:79], v[120:123], v[28:31]
    ds_read_b64 v[62:63], v200 offset:1160
    v_mfma_f32_16x16x32_f16 v[32:35], v[76:79], v[124:127], v[32:35]
    ds_read_b128 v[112:115], v201 offset:3136
    v_mfma_f32_16x16x32_f16 v[36:39], v[76:79], v[128:131], v[36:39]
    ds_read_b64 v[56:57], v200 offset:1664
    v_mfma_f32_16x16x32_f16 v[40:43], v[76:79], v[132:135], v[40:43]
    ds_read_b64 v[58:59], v200 offset:1672
    v_mfma_f32_16x16x32_f16 v[44:47], v[76:79], v[136:139], v[44:47]
    ds_read_b128 v[116:119], v201 offset:3648
    v_mfma_f32_16x16x32_f16 v[48:51], v[76:79], v[140:143], v[48:51]
    ds_read_b64 v[174:175], v225 offset:2560
    v_mfma_f32_16x16x32_f16 v[52:55], v[76:79], v[144:147], v[52:55]
    ds_read_b64 v[234:235], v202 offset:2560
    v_mfma_f32_16x16x32_f16 v[24:27], v[72:75], v[120:123], v[24:27]
    ds_read_b64 v[178:179], v225 offset:3072
    v_mfma_f32_16x16x32_f16 v[28:31], v[72:75], v[124:127], v[28:31]
    ds_read_b64 v[238:239], v202 offset:3072
    v_mfma_f32_16x16x32_f16 v[32:35], v[72:75], v[128:131], v[32:35]
    ds_read_b64 v[182:183], v225 offset:3584
    v_mfma_f32_16x16x32_f16 v[36:39], v[72:75], v[132:135], v[36:39]
    ds_read_b64 v[242:243], v202 offset:3584
    v_mfma_f32_16x16x32_f16 v[40:43], v[72:75], v[136:139], v[40:43]
    s_waitcnt lgkmcnt(15)
    v_lshlrev_b32 v184, 16, v186
    v_and_b32 v185, 0xffff0000, v186
    v_mfma_f32_16x16x32_f16 v[44:47], v[72:75], v[140:143], v[44:47]
    v_lshlrev_b32 v186, 16, v187
    v_and_b32 v187, 0xffff0000, v187
    v_mfma_f32_16x16x32_f16 v[48:51], v[72:75], v[144:147], v[48:51]
    v_fma_mix_f32 v184, v154, s58, v184 op_sel:[0,0,0] op_sel_hi:[1,0,0]
    v_fma_mix_f32 v185, v154, s58, v185 op_sel:[1,0,0] op_sel_hi:[1,0,0]
    v_mfma_f32_16x16x32_f16 v[52:55], v[72:75], v[148:151], v[52:55]
    v_fma_mix_f32 v186, v155, s58, v186 op_sel:[0,0,0] op_sel_hi:[1,0,0]
    v_fma_mix_f32 v187, v155, s58, v187 op_sel:[1,0,0] op_sel_hi:[1,0,0]
    s_waitcnt lgkmcnt(6)
    v_mfma_f32_16x16x32_f16 v[36:39], v[68:71], v[88:91], v[36:39]
    ds_read_b64 v[84:85], v200 offset:64
    v_mfma_f32_16x16x32_f16 v[40:43], v[68:71], v[92:95], v[40:43]
    ds_read_b64 v[86:87], v200 offset:72
    v_mfma_f32_16x16x32_f16 v[44:47], v[68:71], v[96:99], v[44:47]
    ds_read_b128 v[120:123], v201 offset:0
    v_mfma_f32_16x16x32_f16 v[48:51], v[68:71], v[100:103], v[48:51]
    ds_read_b128 v[124:127], v201 offset:512
    v_mfma_f32_16x16x32_f16 v[52:55], v[68:71], v[104:107], v[52:55]
    ds_read_b128 v[128:131], v201 offset:1024
    v_mfma_f32_16x16x32_f16 v[32:35], v[64:67], v[88:91], v[32:35]
    ds_read_b128 v[132:135], v201 offset:1536
    v_mfma_f32_16x16x32_f16 v[36:39], v[64:67], v[92:95], v[36:39]
    ds_read_b128 v[136:139], v201 offset:2048
    v_mfma_f32_16x16x32_f16 v[40:43], v[64:67], v[96:99], v[40:43]
    ds_read_b64 v[80:81], v200 offset:576
    v_mfma_f32_16x16x32_f16 v[44:47], v[64:67], v[100:103], v[44:47]
    ds_read_b64 v[82:83], v200 offset:584
    v_mfma_f32_16x16x32_f16 v[48:51], v[64:67], v[104:107], v[48:51]
    ds_read_b128 v[140:143], v201 offset:2560
    v_mfma_f32_16x16x32_f16 v[52:55], v[64:67], v[108:111], v[52:55]
    ds_read_b64 v[76:77], v200 offset:1088
    v_mfma_f32_16x16x32_f16 v[28:31], v[60:63], v[88:91], v[28:31]
    ds_read_b64 v[78:79], v200 offset:1096
    v_mfma_f32_16x16x32_f16 v[32:35], v[60:63], v[92:95], v[32:35]
    ds_read_b128 v[144:147], v201 offset:3072
    v_mfma_f32_16x16x32_f16 v[36:39], v[60:63], v[96:99], v[36:39]
    ds_read_b64 v[72:73], v200 offset:1600
    v_mfma_f32_16x16x32_f16 v[40:43], v[60:63], v[100:103], v[40:43]
    ds_read_b64 v[74:75], v200 offset:1608
    v_mfma_f32_16x16x32_f16 v[44:47], v[60:63], v[104:107], v[44:47]
    ds_read_b128 v[148:151], v201 offset:3584
    v_mfma_f32_16x16x32_f16 v[48:51], v[60:63], v[108:111], v[48:51]
    v_lshlrev_b32 v188, 16, v190
    v_and_b32 v189, 0xffff0000, v190
    v_mfma_f32_16x16x32_f16 v[52:55], v[60:63], v[112:115], v[52:55]
    v_lshlrev_b32 v190, 16, v191
    v_and_b32 v191, 0xffff0000, v191
    v_mfma_f32_16x16x32_f16 v[24:27], v[56:59], v[88:91], v[24:27]
    v_fma_mix_f32 v188, v158, s58, v188 op_sel:[0,0,0] op_sel_hi:[1,0,0]
    v_fma_mix_f32 v189, v158, s58, v189 op_sel:[1,0,0] op_sel_hi:[1,0,0]
    v_mfma_f32_16x16x32_f16 v[28:31], v[56:59], v[92:95], v[28:31]
    v_fma_mix_f32 v190, v159, s58, v190 op_sel:[0,0,0] op_sel_hi:[1,0,0]
    v_fma_mix_f32 v191, v159, s58, v191 op_sel:[1,0,0] op_sel_hi:[1,0,0]
    v_mfma_f32_16x16x32_f16 v[32:35], v[56:59], v[96:99], v[32:35]
    v_lshlrev_b32 v192, 16, v194
    v_and_b32 v193, 0xffff0000, v194
    v_mfma_f32_16x16x32_f16 v[36:39], v[56:59], v[100:103], v[36:39]
    v_lshlrev_b32 v194, 16, v195
    v_and_b32 v195, 0xffff0000, v195
    v_mfma_f32_16x16x32_f16 v[40:43], v[56:59], v[104:107], v[40:43]
    v_fma_mix_f32 v192, v162, s58, v192 op_sel:[0,0,0] op_sel_hi:[1,0,0]
    v_fma_mix_f32 v193, v162, s58, v193 op_sel:[1,0,0] op_sel_hi:[1,0,0]
    v_mfma_f32_16x16x32_f16 v[44:47], v[56:59], v[108:111], v[44:47]
    v_fma_mix_f32 v194, v163, s58, v194 op_sel:[0,0,0] op_sel_hi:[1,0,0]
    v_fma_mix_f32 v195, v163, s58, v195 op_sel:[1,0,0] op_sel_hi:[1,0,0]
    v_mfma_f32_16x16x32_f16 v[48:51], v[56:59], v[112:115], v[48:51]
    v_lshlrev_b32 v196, 16, v198
    v_and_b32 v197, 0xffff0000, v198
    v_mfma_f32_16x16x32_f16 v[52:55], v[56:59], v[116:119], v[52:55]
    v_lshlrev_b32 v198, 16, v199
    v_and_b32 v199, 0xffff0000, v199
    s_waitcnt lgkmcnt(0)
    v_mfma_f32_16x16x32_f16 v[36:39], v[84:87], v[120:123], v[36:39]
    v_fma_mix_f32 v196, v166, s58, v196 op_sel:[0,0,0] op_sel_hi:[1,0,0]
    v_fma_mix_f32 v197, v166, s58, v197 op_sel:[1,0,0] op_sel_hi:[1,0,0]
    v_mfma_f32_16x16x32_f16 v[40:43], v[84:87], v[124:127], v[40:43]
    v_fma_mix_f32 v198, v167, s58, v198 op_sel:[0,0,0] op_sel_hi:[1,0,0]
    v_fma_mix_f32 v199, v167, s58, v199 op_sel:[1,0,0] op_sel_hi:[1,0,0]
    v_mfma_f32_16x16x32_f16 v[44:47], v[84:87], v[128:131], v[44:47]
    v_lshlrev_b32 v228, 16, v230
    v_and_b32 v229, 0xffff0000, v230
    v_mfma_f32_16x16x32_f16 v[48:51], v[84:87], v[132:135], v[48:51]
    v_lshlrev_b32 v230, 16, v231
    v_and_b32 v231, 0xffff0000, v231
    v_mfma_f32_16x16x32_f16 v[52:55], v[84:87], v[136:139], v[52:55]
    v_fma_mix_f32 v228, v170, s58, v228 op_sel:[0,0,0] op_sel_hi:[1,0,0]
    v_fma_mix_f32 v229, v170, s58, v229 op_sel:[1,0,0] op_sel_hi:[1,0,0]
    v_mfma_f32_16x16x32_f16 v[32:35], v[80:83], v[120:123], v[32:35]
    v_fma_mix_f32 v230, v171, s58, v230 op_sel:[0,0,0] op_sel_hi:[1,0,0]
    v_fma_mix_f32 v231, v171, s58, v231 op_sel:[1,0,0] op_sel_hi:[1,0,0]
    v_mfma_f32_16x16x32_f16 v[36:39], v[80:83], v[124:127], v[36:39]
    v_lshlrev_b32 v232, 16, v234
    v_and_b32 v233, 0xffff0000, v234
    v_mfma_f32_16x16x32_f16 v[40:43], v[80:83], v[128:131], v[40:43]
    v_lshlrev_b32 v234, 16, v235
    v_and_b32 v235, 0xffff0000, v235
    v_mfma_f32_16x16x32_f16 v[44:47], v[80:83], v[132:135], v[44:47]
    v_fma_mix_f32 v232, v174, s58, v232 op_sel:[0,0,0] op_sel_hi:[1,0,0]
    v_fma_mix_f32 v233, v174, s58, v233 op_sel:[1,0,0] op_sel_hi:[1,0,0]
    v_mfma_f32_16x16x32_f16 v[48:51], v[80:83], v[136:139], v[48:51]
    v_fma_mix_f32 v234, v175, s58, v234 op_sel:[0,0,0] op_sel_hi:[1,0,0]
    v_fma_mix_f32 v235, v175, s58, v235 op_sel:[1,0,0] op_sel_hi:[1,0,0]
    v_mfma_f32_16x16x32_f16 v[52:55], v[80:83], v[140:143], v[52:55]
    v_lshlrev_b32 v236, 16, v238
    v_and_b32 v237, 0xffff0000, v238
    v_mfma_f32_16x16x32_f16 v[28:31], v[76:79], v[120:123], v[28:31]
    v_lshlrev_b32 v238, 16, v239
    v_and_b32 v239, 0xffff0000, v239
    v_mfma_f32_16x16x32_f16 v[32:35], v[76:79], v[124:127], v[32:35]
    v_fma_mix_f32 v236, v178, s58, v236 op_sel:[0,0,0] op_sel_hi:[1,0,0]
    v_fma_mix_f32 v237, v178, s58, v237 op_sel:[1,0,0] op_sel_hi:[1,0,0]
    v_mfma_f32_16x16x32_f16 v[36:39], v[76:79], v[128:131], v[36:39]
    v_fma_mix_f32 v238, v179, s58, v238 op_sel:[0,0,0] op_sel_hi:[1,0,0]
    v_fma_mix_f32 v239, v179, s58, v239 op_sel:[1,0,0] op_sel_hi:[1,0,0]
    v_mfma_f32_16x16x32_f16 v[40:43], v[76:79], v[132:135], v[40:43]
    v_lshlrev_b32 v240, 16, v242
    v_and_b32 v241, 0xffff0000, v242
    v_mfma_f32_16x16x32_f16 v[44:47], v[76:79], v[136:139], v[44:47]
    v_lshlrev_b32 v242, 16, v243
    v_and_b32 v243, 0xffff0000, v243
    v_mfma_f32_16x16x32_f16 v[48:51], v[76:79], v[140:143], v[48:51]
    v_fma_mix_f32 v240, v182, s58, v240 op_sel:[0,0,0] op_sel_hi:[1,0,0]
    v_fma_mix_f32 v241, v182, s58, v241 op_sel:[1,0,0] op_sel_hi:[1,0,0]
    v_mfma_f32_16x16x32_f16 v[52:55], v[76:79], v[144:147], v[52:55]
    v_fma_mix_f32 v242, v183, s58, v242 op_sel:[0,0,0] op_sel_hi:[1,0,0]
    v_fma_mix_f32 v243, v183, s58, v243 op_sel:[1,0,0] op_sel_hi:[1,0,0]
    v_mfma_f32_16x16x32_f16 v[24:27], v[72:75], v[120:123], v[24:27]
    v_mfma_f32_16x16x32_f16 v[28:31], v[72:75], v[124:127], v[28:31]
    v_mfma_f32_16x16x32_f16 v[32:35], v[72:75], v[128:131], v[32:35]
    v_mfma_f32_16x16x32_f16 v[36:39], v[72:75], v[132:135], v[36:39]
    v_mfma_f32_16x16x32_f16 v[40:43], v[72:75], v[136:139], v[40:43]
    v_mfma_f32_16x16x32_f16 v[44:47], v[72:75], v[140:143], v[44:47]
    v_mfma_f32_16x16x32_f16 v[48:51], v[72:75], v[144:147], v[48:51]
    v_mfma_f32_16x16x32_f16 v[52:55], v[72:75], v[148:151], v[52:55]
    v_mov_b32 v14, v15
    v_pk_fma_f32 v[24:25], v[24:25], v[14:15], v[184:185]
    v_pk_fma_f32 v[26:27], v[26:27], v[14:15], v[186:187]
    v_cvt_pk_bf16_f32 v56, v24, v25
    v_cvt_pk_bf16_f32 v57, v26, v27
    v_pk_fma_f32 v[28:29], v[28:29], v[14:15], v[188:189]
    v_pk_fma_f32 v[30:31], v[30:31], v[14:15], v[190:191]
    v_cvt_pk_bf16_f32 v58, v28, v29
    v_cvt_pk_bf16_f32 v59, v30, v31
    s_nop 0
    v_permlane16_swap_b32 v56, v58
    v_permlane16_swap_b32 v57, v59
    global_store_dwordx4 v203, v[56:59], s[42:43] sc1
    v_add_u32 v203, 655360, v203
    v_pk_fma_f32 v[32:33], v[32:33], v[14:15], v[192:193]
    v_pk_fma_f32 v[34:35], v[34:35], v[14:15], v[194:195]
    v_cvt_pk_bf16_f32 v60, v32, v33
    v_cvt_pk_bf16_f32 v61, v34, v35
    v_pk_fma_f32 v[36:37], v[36:37], v[14:15], v[196:197]
    v_pk_fma_f32 v[38:39], v[38:39], v[14:15], v[198:199]
    v_cvt_pk_bf16_f32 v62, v36, v37
    v_cvt_pk_bf16_f32 v63, v38, v39
    s_nop 0
    v_permlane16_swap_b32 v60, v62
    v_permlane16_swap_b32 v61, v63
    global_store_dwordx4 v203, v[60:63], s[42:43] sc1
    v_add_u32 v203, 655360, v203
    v_pk_fma_f32 v[40:41], v[40:41], v[14:15], v[228:229]
    v_pk_fma_f32 v[42:43], v[42:43], v[14:15], v[230:231]
    v_cvt_pk_bf16_f32 v64, v40, v41
    v_cvt_pk_bf16_f32 v65, v42, v43
    v_pk_fma_f32 v[44:45], v[44:45], v[14:15], v[232:233]
    v_pk_fma_f32 v[46:47], v[46:47], v[14:15], v[234:235]
    v_cvt_pk_bf16_f32 v66, v44, v45
    v_cvt_pk_bf16_f32 v67, v46, v47
    s_nop 0
    v_permlane16_swap_b32 v64, v66
    v_permlane16_swap_b32 v65, v67
    global_store_dwordx4 v203, v[64:67], s[42:43] sc1
    v_add_u32 v203, 655360, v203
    v_pk_fma_f32 v[48:49], v[48:49], v[14:15], v[236:237]
    v_pk_fma_f32 v[50:51], v[50:51], v[14:15], v[238:239]
    v_cvt_pk_bf16_f32 v68, v48, v49
    v_cvt_pk_bf16_f32 v69, v50, v51
    v_pk_fma_f32 v[52:53], v[52:53], v[14:15], v[240:241]
    v_pk_fma_f32 v[54:55], v[54:55], v[14:15], v[242:243]
    v_cvt_pk_bf16_f32 v70, v52, v53
    v_cvt_pk_bf16_f32 v71, v54, v55
    s_nop 0
    v_permlane16_swap_b32 v68, v70
    v_permlane16_swap_b32 v69, v71
    global_store_dwordx4 v203, v[68:71], s[42:43] sc1
    s_setprio 0
    s_lshl_b32 s73, s46, 1
    s_lshr_b32 s13, s3, 1
    s_add_u32 s73, s73, s13
    s_lshl_b32 s73, s73, 17
    s_lshr_b32 s13, s8, 2
    s_lshl_b32 s13, s13, 1
    s_and_b32 s9, s8, 1
    s_add_u32 s13, s13, s9
    s_lshl_b32 s13, s13, 10
    s_add_u32 s73, s73, s13
    s_lshl_b32 s9, s9, 16
    s_add_u32 s73, s73, s9
    s_xor_b32 s75, s73, 0x10000
    s_mul_i32 s72, s3, 16384
    s_add_u32 s72, s72, 97792
    v_lshrrev_b32 v112, 3, v1
    v_lshrrev_b32 v113, 4, v1
    v_and_b32 v114, 7, v1
    v_xor_b32 v113, v113, v114
    v_lshlrev_b32 v112, 12, v112
    v_lshl_add_u32 v112, v113, 4, v112
    v_xor_b32 v113, 64, v112
    v_add_u32 v113, 31744, v113
    v_and_b32 v115, 15, v1
    v_lshrrev_b32 v114, 1, v115
    v_lshlrev_b32 v114, 4, v114
    v_lshl_add_u32 v114, v115, 7, v114
    v_and_b32 v115, 48, v1
    v_xor_b32 v114, v114, v115
    v_add_u32 v114, s72, v114
    v_xor_b32 v115, 64, v114
    s_mov_b32 s68, s34
    s_mov_b32 s69, s35
    s_mov_b32 s70, 8388608
    s_mov_b32 s71, 0x20000
    s_barrier
    ds_read_b128 v[128:131], v114 offset:0
    ds_read_b128 v[192:195], v114 offset:2048
    ds_read_b128 v[132:135], v115 offset:0
    ds_read_b128 v[196:199], v115 offset:2048
    ds_read_b128 v[136:139], v114 offset:4096
    ds_read_b128 v[200:203], v114 offset:6144
    ds_read_b128 v[140:143], v115 offset:4096
    ds_read_b128 v[204:207], v115 offset:6144
    ds_read_b128 v[144:147], v114 offset:8192
    ds_read_b128 v[208:211], v114 offset:10240
    ds_read_b128 v[148:151], v115 offset:8192
    ds_read_b128 v[212:215], v115 offset:10240
    ds_read_b128 v[152:155], v114 offset:12288
    ds_read_b128 v[216:219], v114 offset:14336
    ds_read_b128 v[156:159], v115 offset:12288
    ds_read_b128 v[220:223], v115 offset:14336
    s_branch PH3X
K1_BW:
    s_mov_b32 s60, s59
    s_sub_u32 m0, s60, 32768
    v_mul_u32_u24 v4, 272, v10
    v_lshl_add_u32 v4, v11, 4, v4
    v_add_u32 v4, s60, v4
    v_lshl_add_u32 v9, v1, 4, s60
    v_lshlrev_b32 v6, 5, v2
    v_add_u32 v7, 2621440, v6
    v_lshlrev_b32 v8, 4, v2
    v_add_u32 v6, 62464, v8
    v_add_u32 v8, 44544, v8
    s_lshl_b32 s12, s63, 4
    v_add_u32 v7, s12, v7
    v_xor_b32 v120, 16, v7
    s_lshl_b32 s12, s63, 3
    v_add_u32 v6, s12, v6
    v_xor_b32 v121, 8, v6
    v_add_u32 v8, s12, v8
    v_xor_b32 v122, 8, v8
    s_lshl_b32 s73, s46, 1
    s_lshr_b32 s13, s3, 1
    s_add_u32 s73, s73, s13
    s_lshl_b32 s73, s73, 17
    s_lshr_b32 s13, s8, 2
    s_lshl_b32 s13, s13, 1
    s_and_b32 s9, s8, 1
    s_add_u32 s13, s13, s9
    s_lshl_b32 s13, s13, 10
    s_add_u32 s73, s73, s13
    s_lshl_b32 s9, s9, 16
    s_add_u32 s73, s73, s9
    s_xor_b32 s75, s73, 0x10000
    s_mul_i32 s72, s3, 16384
    s_add_u32 s72, s72, 97792
    v_lshrrev_b32 v112, 3, v1
    v_lshrrev_b32 v113, 4, v1
    v_and_b32 v114, 7, v1
    v_xor_b32 v113, v113, v114
    v_lshlrev_b32 v112, 12, v112
    v_lshl_add_u32 v112, v113, 4, v112
    v_xor_b32 v113, 64, v112
    v_add_u32 v113, 31744, v113
    v_and_b32 v115, 15, v1
    v_lshrrev_b32 v114, 1, v115
    v_lshlrev_b32 v114, 4, v114
    v_lshl_add_u32 v114, v115, 7, v114
    v_and_b32 v115, 48, v1
    v_xor_b32 v114, v114, v115
    v_add_u32 v114, s72, v114
    v_xor_b32 v115, 64, v114
    s_mov_b32 s68, s34
    s_mov_b32 s69, s35
    s_mov_b32 s70, 8388608
    s_mov_b32 s71, 0x20000
    v_mov_b32 v119, 0
    global_load_dwordx2 v[162:163], v3, s[16:17] offset:1280
    global_load_dwordx2 v[164:165], v3, s[16:17] offset:2560
    s_setprio 3
    s_waitcnt lgkmcnt(0)
    s_lshl_b32 s14, s74, 16
    s_and_b32 s13, s74, 0xffff0000
    s_bitcmp1_b32 s10, 0
    s_cselect_b32 s13, s13, s14
    v_mov_b32 v12, 0x3fb8aa3b
    v_mul_f32 v12, s13, v12
    v_exp_f32 v12, v12
    s_nop 0
    v_cvt_pk_bf16_f32 v12, 0, v12
    s_waitcnt vmcnt(3)
    v_lshlrev_b32 v24, 16, v17
    v_lshlrev_b32 v25, 16, v19
    v_lshlrev_b32 v32, 16, v21
    v_lshlrev_b32 v33, 16, v23
    v_lshlrev_b32 v17, 16, v20
    v_lshlrev_b32 v19, 16, v22
    v_mul_f32 v24, 0x3fb8aa3b, v24
    v_exp_f32 v24, v24
    v_max3_f32 v13, abs(v32), abs(v33), abs(v17)
    v_max3_f32 v14, abs(v19), abs(v20), abs(v22)
    v_max_u32 v13, v13, v14
    v_cvt_pk_bf16_f32 v24, 0, v24
    s_nop 0
    v_max_u32_dpp v13, v13, v13 row_ror:8 row_mask:0xf bank_mask:0xf
    v_pk_mul_f32 v[24:25], v[24:25], v[12:13] op_sel:[0,0] op_sel_hi:[1,0]
    s_nop 0
    v_max_u32_dpp v13, v13, v13 row_ror:4 row_mask:0xf bank_mask:0xf
    v_mul_f32 v24, 0xbfb8aa3b, v24
    s_nop 0
    v_max_u32_dpp v13, v13, v13 row_ror:2 row_mask:0xf bank_mask:0xf
    v_mul_f32 v25, 0x3e22f983, v25
    s_nop 0
    v_max_u32_dpp v13, v13, v13 row_ror:1 row_mask:0xf bank_mask:0xf
    v_exp_f32 v40, v24
    v_fract_f32 v43, v25
    v_cos_f32 v26, v43
    v_sin_f32 v27, v43
    s_nop 0
    v_pk_mul_f32 v[26:27], v[26:27], v[40:41] op_sel:[0,0] op_sel_hi:[1,0]
    v_readlane_b32 s48, v13, 0
    v_readlane_b32 s49, v13, 16
    v_readlane_b32 s50, v13, 32
    v_readlane_b32 s51, v13, 48
    v_mul_f32 v42, 0x43800000, v24
    v_mul_f32 v43, 0x43800000, v25
    v_exp_f32 v40, v42
    v_fract_f32 v43, v43
    v_cos_f32 v30, v43
    v_sin_f32 v31, v43
    s_nop 0
    v_pk_mul_f32 v[30:31], v[30:31], v[40:41] op_sel:[0,0] op_sel_hi:[1,0]
    s_max_u32 s48, s48, s49
    s_max_u32 s50, s50, s51
    s_max_u32 s48, s48, s50
    s_and_b32 s48, s48, 0x7f800000
    s_max_u32 s48, s48, 0x01000000
    s_min_u32 s48, s48, 0x7e000000
    s_sub_u32 s49, 0x7f000000, s48
    v_mul_f32 v42, 0x41000000, v24
    v_mul_f32 v43, 0x41000000, v25
    v_exp_f32 v40, v42
    v_fract_f32 v43, v43
    v_cos_f32 v28, v43
    v_sin_f32 v29, v43
    s_nop 0
    v_pk_mul_f32 v[28:29], v[28:29], v[40:41] op_sel:[0,0] op_sel_hi:[1,0] neg_hi:[1,0]
    v_mul_f32 v32, s49, v32
    v_mul_f32 v33, s49, -v33
    v_mov_b32 v44, 0x3c00
    ds_write_addtid_b32 v44 offset:32768
    global_load_dwordx2 v[166:167], v3, s[16:17] offset:3840
    v_cvt_pk_f16_f32 v45, v26, v27
    ds_write_addtid_b32 v45 offset:33040
    v_pk_mul_f32 v[42:43], v[26:27], v[26:27] op_sel:[0,0] op_sel_hi:[0,1]
    v_pk_fma_f32 v[34:35], v[26:27], v[26:27], v[42:43] op_sel:[1,1,0] op_sel_hi:[1,0,1] neg_lo:[1,0,0]
    v_cvt_pk_f16_f32 v44, v34, v35
    ds_write_addtid_b32 v44 offset:33312
    v_pk_mul_f32 v[42:43], v[34:35], v[26:27] op_sel:[0,0] op_sel_hi:[0,1]
    v_pk_fma_f32 v[24:25], v[34:35], v[26:27], v[42:43] op_sel:[1,1,0] op_sel_hi:[1,0,1] neg_lo:[1,0,0]
    v_cvt_pk_f16_f32 v45, v24, v25
    ds_write_addtid_b32 v45 offset:33584
    v_pk_mul_f32 v[42:43], v[34:35], v[34:35] op_sel:[0,0] op_sel_hi:[0,1]
    v_pk_fma_f32 v[36:37], v[34:35], v[34:35], v[42:43] op_sel:[1,1,0] op_sel_hi:[1,0,1] neg_lo:[1,0,0]
    v_cvt_pk_f16_f32 v44, v36, v37
    ds_write_addtid_b32 v44 offset:33856
    v_pk_mul_f32 v[42:43], v[36:37], v[26:27] op_sel:[0,0] op_sel_hi:[0,1]
    v_pk_fma_f32 v[24:25], v[36:37], v[26:27], v[42:43] op_sel:[1,1,0] op_sel_hi:[1,0,1] neg_lo:[1,0,0]
    v_cvt_pk_f16_f32 v45, v24, v25
    ds_write_addtid_b32 v45 offset:34128
    v_pk_mul_f32 v[42:43], v[36:37], v[34:35] op_sel:[0,0] op_sel_hi:[0,1]
    v_pk_fma_f32 v[38:39], v[36:37], v[34:35], v[42:43] op_sel:[1,1,0] op_sel_hi:[1,0,1] neg_lo:[1,0,0]
    v_cvt_pk_f16_f32 v44, v38, v39
    ds_write_addtid_b32 v44 offset:34400
    v_pk_mul_f32 v[42:43], v[38:39], v[26:27] op_sel:[0,0] op_sel_hi:[0,1]
    v_pk_fma_f32 v[24:25], v[38:39], v[26:27], v[42:43] op_sel:[1,1,0] op_sel_hi:[1,0,1] neg_lo:[1,0,0]
    v_cvt_pk_f16_f32 v45, v24, v25
    ds_write_addtid_b32 v45 offset:34672
    v_cvt_pk_f16_f32 v44, v30, v31
    ds_write_addtid_b32 v44 offset:34944
    v_pk_mul_f32 v[42:43], v[30:31], v[34:35] op_sel:[0,0] op_sel_hi:[0,1]
    v_pk_fma_f32 v[24:25], v[30:31], v[34:35], v[42:43] op_sel:[1,1,0] op_sel_hi:[1,0,1] neg_lo:[1,0,0]
    v_cvt_pk_f16_f32 v45, v24, v25
    ds_write_addtid_b32 v45 offset:35216
    v_pk_mul_f32 v[42:43], v[30:31], v[36:37] op_sel:[0,0] op_sel_hi:[0,1]
    v_pk_fma_f32 v[24:25], v[30:31], v[36:37], v[42:43] op_sel:[1,1,0] op_sel_hi:[1,0,1] neg_lo:[1,0,0]
    v_cvt_pk_f16_f32 v44, v24, v25
    ds_write_addtid_b32 v44 offset:35488
    v_pk_mul_f32 v[42:43], v[30:31], v[38:39] op_sel:[0,0] op_sel_hi:[0,1]
    v_pk_fma_f32 v[24:25], v[30:31], v[38:39], v[42:43] op_sel:[1,1,0] op_sel_hi:[1,0,1] neg_lo:[1,0,0]
    v_cvt_pk_f16_f32 v45, v24, v25
    ds_write_addtid_b32 v45 offset:35760
    v_pk_mul_f32 v[42:43], v[30:31], v[30:31] op_sel:[0,0] op_sel_hi:[0,1]
    v_pk_fma_f32 v[40:41], v[30:31], v[30:31], v[42:43] op_sel:[1,1,0] op_sel_hi:[1,0,1] neg_lo:[1,0,0]
    v_cvt_pk_f16_f32 v44, v40, v41
    ds_write_addtid_b32 v44 offset:36032
    global_load_dwordx2 v[168:169], v5, s[16:17] offset:0
    v_pk_mul_f32 v[42:43], v[40:41], v[36:37] op_sel:[0,0] op_sel_hi:[0,1]
    v_pk_fma_f32 v[24:25], v[40:41], v[36:37], v[42:43] op_sel:[1,1,0] op_sel_hi:[1,0,1] neg_lo:[1,0,0]
    v_cvt_pk_f16_f32 v45, v24, v25
    ds_write_addtid_b32 v45 offset:36304
    v_pk_mul_f32 v[42:43], v[40:41], v[30:31] op_sel:[0,0] op_sel_hi:[0,1]
    v_pk_fma_f32 v[40:41], v[40:41], v[30:31], v[42:43] op_sel:[1,1,0] op_sel_hi:[1,0,1] neg_lo:[1,0,0]
    v_cvt_pk_f16_f32 v44, v40, v41
    ds_write_addtid_b32 v44 offset:36576
    v_pk_mul_f32 v[42:43], v[40:41], v[36:37] op_sel:[0,0] op_sel_hi:[0,1]
    v_pk_fma_f32 v[24:25], v[40:41], v[36:37], v[42:43] op_sel:[1,1,0] op_sel_hi:[1,0,1] neg_lo:[1,0,0]
    v_cvt_pk_f16_f32 v45, v24, v25
    ds_write_addtid_b32 v45 offset:36848
    ds_read_b128 v[64:67], v4 offset:0
    ds_read_b128 v[68:71], v4 offset:64
    ds_read_b128 v[72:75], v4 offset:128
    ds_read_b128 v[76:79], v4 offset:192
    v_pk_mul_f32 v[42:43], v[40:41], v[30:31] op_sel:[0,0] op_sel_hi:[0,1]
    v_pk_fma_f32 v[40:41], v[40:41], v[30:31], v[42:43] op_sel:[1,1,0] op_sel_hi:[1,0,1] neg_lo:[1,0,0]
    v_cvt_pk_f16_f32 v44, v40, v41
    ds_write_addtid_b32 v44 offset:32768
    v_pk_mul_f32 v[42:43], v[40:41], v[30:31] op_sel:[0,0] op_sel_hi:[0,1]
    v_pk_fma_f32 v[40:41], v[40:41], v[30:31], v[42:43] op_sel:[1,1,0] op_sel_hi:[1,0,1] neg_lo:[1,0,0]
    v_cvt_pk_f16_f32 v45, v40, v41
    ds_write_addtid_b32 v45 offset:33040
    v_pk_mul_f32 v[42:43], v[40:41], v[30:31] op_sel:[0,0] op_sel_hi:[0,1]
    v_pk_fma_f32 v[40:41], v[40:41], v[30:31], v[42:43] op_sel:[1,1,0] op_sel_hi:[1,0,1] neg_lo:[1,0,0]
    v_cvt_pk_f16_f32 v44, v40, v41
    ds_write_addtid_b32 v44 offset:33312
    v_pk_mul_f32 v[42:43], v[40:41], v[30:31] op_sel:[0,0] op_sel_hi:[0,1]
    v_pk_fma_f32 v[40:41], v[40:41], v[30:31], v[42:43] op_sel:[1,1,0] op_sel_hi:[1,0,1] neg_lo:[1,0,0]
    v_cvt_pk_f16_f32 v45, v40, v41
    ds_write_addtid_b32 v45 offset:33584
    v_pk_mul_f32 v[42:43], v[40:41], v[30:31] op_sel:[0,0] op_sel_hi:[0,1]
    v_pk_fma_f32 v[40:41], v[40:41], v[30:31], v[42:43] op_sel:[1,1,0] op_sel_hi:[1,0,1] neg_lo:[1,0,0]
    v_cvt_pk_f16_f32 v44, v40, v41
    ds_write_addtid_b32 v44 offset:33856
    ds_read_b128 v[80:83], v4 offset:0
    ds_read_b128 v[84:87], v4 offset:64
    ds_read_b128 v[88:91], v4 offset:128
    ds_read_b128 v[92:95], v4 offset:192
    v_cvt_pk_f16_f32 v45, v32, v33
    ds_write_addtid_b32 v45 offset:32768
    v_pk_mul_f32 v[42:43], v[32:33], v[28:29] op_sel:[0,0] op_sel_hi:[0,1]
    v_pk_fma_f32 v[32:33], v[32:33], v[28:29], v[42:43] op_sel:[1,1,0] op_sel_hi:[1,0,1] neg_lo:[1,0,0]
    v_cvt_pk_f16_f32 v44, v32, v33
    ds_write_addtid_b32 v44 offset:33040
    v_pk_mul_f32 v[42:43], v[32:33], v[28:29] op_sel:[0,0] op_sel_hi:[0,1]
    v_pk_fma_f32 v[32:33], v[32:33], v[28:29], v[42:43] op_sel:[1,1,0] op_sel_hi:[1,0,1] neg_lo:[1,0,0]
    v_cvt_pk_f16_f32 v45, v32, v33
    ds_write_addtid_b32 v45 offset:33312
    v_pk_mul_f32 v[42:43], v[32:33], v[28:29] op_sel:[0,0] op_sel_hi:[0,1]
    v_pk_fma_f32 v[32:33], v[32:33], v[28:29], v[42:43] op_sel:[1,1,0] op_sel_hi:[1,0,1] neg_lo:[1,0,0]
    v_cvt_pk_f16_f32 v44, v32, v33
    ds_write_addtid_b32 v44 offset:33584
    global_load_dwordx2 v[170:171], v5, s[16:17] offset:1280
    global_load_dword v118, v119, s[40:41] sc1
    v_pk_mul_f32 v[42:43], v[32:33], v[28:29] op_sel:[0,0] op_sel_hi:[0,1]
    v_pk_fma_f32 v[32:33], v[32:33], v[28:29], v[42:43] op_sel:[1,1,0] op_sel_hi:[1,0,1] neg_lo:[1,0,0]
    v_cvt_pk_f16_f32 v45, v32, v33
    ds_write_addtid_b32 v45 offset:33856
    v_pk_mul_f32 v[42:43], v[32:33], v[28:29] op_sel:[0,0] op_sel_hi:[0,1]
    v_pk_fma_f32 v[32:33], v[32:33], v[28:29], v[42:43] op_sel:[1,1,0] op_sel_hi:[1,0,1] neg_lo:[1,0,0]
    v_cvt_pk_f16_f32 v44, v32, v33
    ds_write_addtid_b32 v44 offset:34128
    v_pk_mul_f32 v[42:43], v[32:33], v[28:29] op_sel:[0,0] op_sel_hi:[0,1]
    v_pk_fma_f32 v[32:33], v[32:33], v[28:29], v[42:43] op_sel:[1,1,0] op_sel_hi:[1,0,1] neg_lo:[1,0,0]
    v_cvt_pk_f16_f32 v45, v32, v33
    ds_write_addtid_b32 v45 offset:34400
    v_pk_mul_f32 v[42:43], v[32:33], v[28:29] op_sel:[0,0] op_sel_hi:[0,1]
    v_pk_fma_f32 v[32:33], v[32:33], v[28:29], v[42:43] op_sel:[1,1,0] op_sel_hi:[1,0,1] neg_lo:[1,0,0]
    v_cvt_pk_f16_f32 v44, v32, v33
    ds_write_addtid_b32 v44 offset:34672
    v_pk_mul_f32 v[42:43], v[32:33], v[28:29] op_sel:[0,0] op_sel_hi:[0,1]
    v_pk_fma_f32 v[32:33], v[32:33], v[28:29], v[42:43] op_sel:[1,1,0] op_sel_hi:[1,0,1] neg_lo:[1,0,0]
    v_cvt_pk_f16_f32 v45, v32, v33
    ds_write_addtid_b32 v45 offset:34944
    v_pk_mul_f32 v[42:43], v[32:33], v[28:29] op_sel:[0,0] op_sel_hi:[0,1]
    v_pk_fma_f32 v[32:33], v[32:33], v[28:29], v[42:43] op_sel:[1,1,0] op_sel_hi:[1,0,1] neg_lo:[1,0,0]
    v_cvt_pk_f16_f32 v44, v32, v33
    ds_write_addtid_b32 v44 offset:35216
    v_pk_mul_f32 v[42:43], v[32:33], v[28:29] op_sel:[0,0] op_sel_hi:[0,1]
    v_pk_fma_f32 v[32:33], v[32:33], v[28:29], v[42:43] op_sel:[1,1,0] op_sel_hi:[1,0,1] neg_lo:[1,0,0]
    v_cvt_pk_f16_f32 v45, v32, v33
    ds_write_addtid_b32 v45 offset:35488
    v_pk_mul_f32 v[42:43], v[32:33], v[28:29] op_sel:[0,0] op_sel_hi:[0,1]
    v_pk_fma_f32 v[32:33], v[32:33], v[28:29], v[42:43] op_sel:[1,1,0] op_sel_hi:[1,0,1] neg_lo:[1,0,0]
    v_cvt_pk_f16_f32 v44, v32, v33
    ds_write_addtid_b32 v44 offset:35760
    v_pk_mul_f32 v[42:43], v[32:33], v[28:29] op_sel:[0,0] op_sel_hi:[0,1]
    v_pk_fma_f32 v[32:33], v[32:33], v[28:29], v[42:43] op_sel:[1,1,0] op_sel_hi:[1,0,1] neg_lo:[1,0,0]
    v_cvt_pk_f16_f32 v45, v32, v33
    ds_write_addtid_b32 v45 offset:36032
    v_pk_mul_f32 v[42:43], v[32:33], v[28:29] op_sel:[0,0] op_sel_hi:[0,1]
    v_pk_fma_f32 v[32:33], v[32:33], v[28:29], v[42:43] op_sel:[1,1,0] op_sel_hi:[1,0,1] neg_lo:[1,0,0]
    v_cvt_pk_f16_f32 v44, v32, v33
    ds_write_addtid_b32 v44 offset:36304
    v_pk_mul_f32 v[42:43], v[32:33], v[28:29] op_sel:[0,0] op_sel_hi:[0,1]
    v_pk_fma_f32 v[32:33], v[32:33], v[28:29], v[42:43] op_sel:[1,1,0] op_sel_hi:[1,0,1] neg_lo:[1,0,0]
    v_cvt_pk_f16_f32 v45, v32, v33
    ds_write_addtid_b32 v45 offset:36576
    v_pk_mul_f32 v[42:43], v[32:33], v[28:29] op_sel:[0,0] op_sel_hi:[0,1]
    v_pk_fma_f32 v[32:33], v[32:33], v[28:29], v[42:43] op_sel:[1,1,0] op_sel_hi:[1,0,1] neg_lo:[1,0,0]
    v_cvt_pk_f16_f32 v44, v32, v33
    ds_write_addtid_b32 v44 offset:36848
    global_load_dwordx2 v[172:173], v5, s[16:17] offset:2560
    v_pk_mul_f32 v[42:43], v[32:33], v[28:29] op_sel:[0,0] op_sel_hi:[0,1]
    v_pk_fma_f32 v[32:33], v[32:33], v[28:29], v[42:43] op_sel:[1,1,0] op_sel_hi:[1,0,1] neg_lo:[1,0,0]
    ds_read_b128 v[96:99], v4 offset:0
    ds_read_b128 v[100:103], v4 offset:64
    ds_read_b128 v[104:107], v4 offset:128
    ds_read_b128 v[108:111], v4 offset:192
    v_cvt_pk_f16_f32 v45, v32, v33
    ds_write_addtid_b32 v45 offset:32768
    v_pk_mul_f32 v[42:43], v[32:33], v[28:29] op_sel:[0,0] op_sel_hi:[0,1]
    v_pk_fma_f32 v[32:33], v[32:33], v[28:29], v[42:43] op_sel:[1,1,0] op_sel_hi:[1,0,1] neg_lo:[1,0,0]
    v_cvt_pk_f16_f32 v44, v32, v33
    ds_write_addtid_b32 v44 offset:33040
    v_pk_mul_f32 v[42:43], v[32:33], v[28:29] op_sel:[0,0] op_sel_hi:[0,1]
    v_pk_fma_f32 v[32:33], v[32:33], v[28:29], v[42:43] op_sel:[1,1,0] op_sel_hi:[1,0,1] neg_lo:[1,0,0]
    v_cvt_pk_f16_f32 v45, v32, v33
    ds_write_addtid_b32 v45 offset:33312
    v_pk_mul_f32 v[42:43], v[32:33], v[28:29] op_sel:[0,0] op_sel_hi:[0,1]
    v_pk_fma_f32 v[32:33], v[32:33], v[28:29], v[42:43] op_sel:[1,1,0] op_sel_hi:[1,0,1] neg_lo:[1,0,0]
    v_cvt_pk_f16_f32 v44, v32, v33
    ds_write_addtid_b32 v44 offset:33584
    s_waitcnt lgkmcnt(4)
    v_mfma_f32_16x16x32_f16 v[48:51], v[64:67], v[96:99], 0
    v_mfma_f32_16x16x32_f16 v[52:55], v[80:83], v[96:99], 0
    v_pk_mul_f32 v[42:43], v[32:33], v[28:29] op_sel:[0,0] op_sel_hi:[0,1]
    v_pk_fma_f32 v[32:33], v[32:33], v[28:29], v[42:43] op_sel:[1,1,0] op_sel_hi:[1,0,1] neg_lo:[1,0,0]
    v_cvt_pk_f16_f32 v45, v32, v33
    ds_write_addtid_b32 v45 offset:33856
    v_mfma_f32_16x16x32_f16 v[48:51], v[68:71], v[100:103], v[48:51]
    v_mfma_f32_16x16x32_f16 v[52:55], v[84:87], v[100:103], v[52:55]
    v_pk_mul_f32 v[42:43], v[32:33], v[28:29] op_sel:[0,0] op_sel_hi:[0,1]
    v_pk_fma_f32 v[32:33], v[32:33], v[28:29], v[42:43] op_sel:[1,1,0] op_sel_hi:[1,0,1] neg_lo:[1,0,0]
    v_cvt_pk_f16_f32 v44, v32, v33
    ds_write_addtid_b32 v44 offset:34128
    v_mfma_f32_16x16x32_f16 v[48:51], v[72:75], v[104:107], v[48:51]
    v_mfma_f32_16x16x32_f16 v[52:55], v[88:91], v[104:107], v[52:55]
    v_pk_mul_f32 v[42:43], v[32:33], v[28:29] op_sel:[0,0] op_sel_hi:[0,1]
    v_pk_fma_f32 v[32:33], v[32:33], v[28:29], v[42:43] op_sel:[1,1,0] op_sel_hi:[1,0,1] neg_lo:[1,0,0]
    v_cvt_pk_f16_f32 v45, v32, v33
    ds_write_addtid_b32 v45 offset:34400
    v_mfma_f32_16x16x32_f16 v[48:51], v[76:79], v[108:111], v[48:51]
    v_mfma_f32_16x16x32_f16 v[52:55], v[92:95], v[108:111], v[52:55]
    v_pk_mul_f32 v[42:43], v[32:33], v[28:29] op_sel:[0,0] op_sel_hi:[0,1]
    v_pk_fma_f32 v[32:33], v[32:33], v[28:29], v[42:43] op_sel:[1,1,0] op_sel_hi:[1,0,1] neg_lo:[1,0,0]
    v_cvt_pk_f16_f32 v44, v32, v33
    ds_write_addtid_b32 v44 offset:34672
    v_pk_mul_f32 v[42:43], v[32:33], v[28:29] op_sel:[0,0] op_sel_hi:[0,1]
    v_pk_fma_f32 v[32:33], v[32:33], v[28:29], v[42:43] op_sel:[1,1,0] op_sel_hi:[1,0,1] neg_lo:[1,0,0]
    v_cvt_pk_f16_f32 v45, v32, v33
    ds_write_addtid_b32 v45 offset:34944
    v_pk_mul_f32 v[42:43], v[32:33], v[28:29] op_sel:[0,0] op_sel_hi:[0,1]
    v_pk_fma_f32 v[32:33], v[32:33], v[28:29], v[42:43] op_sel:[1,1,0] op_sel_hi:[1,0,1] neg_lo:[1,0,0]
    v_cvt_pk_f16_f32 v44, v32, v33
    ds_write_addtid_b32 v44 offset:35216
    v_pk_mul_f32 v[42:43], v[32:33], v[28:29] op_sel:[0,0] op_sel_hi:[0,1]
    v_pk_fma_f32 v[32:33], v[32:33], v[28:29], v[42:43] op_sel:[1,1,0] op_sel_hi:[1,0,1] neg_lo:[1,0,0]
    v_cvt_pk_f16_f32 v45, v32, v33
    ds_write_addtid_b32 v45 offset:35488
    v_pk_mul_f32 v[42:43], v[32:33], v[28:29] op_sel:[0,0] op_sel_hi:[0,1]
    v_pk_fma_f32 v[32:33], v[32:33], v[28:29], v[42:43] op_sel:[1,1,0] op_sel_hi:[1,0,1] neg_lo:[1,0,0]
    v_cvt_pk_f16_f32 v44, v32, v33
    ds_write_addtid_b32 v44 offset:35760
    global_load_dwordx2 v[174:175], v5, s[16:17] offset:3840
    v_pk_mul_f32 v[42:43], v[32:33], v[28:29] op_sel:[0,0] op_sel_hi:[0,1]
    v_pk_fma_f32 v[32:33], v[32:33], v[28:29], v[42:43] op_sel:[1,1,0] op_sel_hi:[1,0,1] neg_lo:[1,0,0]
    v_cvt_pk_f16_f32 v45, v32, v33
    ds_write_addtid_b32 v45 offset:36032
    v_pk_mul_f32 v[42:43], v[32:33], v[28:29] op_sel:[0,0] op_sel_hi:[0,1]
    v_pk_fma_f32 v[32:33], v[32:33], v[28:29], v[42:43] op_sel:[1,1,0] op_sel_hi:[1,0,1] neg_lo:[1,0,0]
    v_cvt_pk_f16_f32 v44, v32, v33
    ds_write_addtid_b32 v44 offset:36304
    v_pk_mul_f32 v[42:43], v[32:33], v[28:29] op_sel:[0,0] op_sel_hi:[0,1]
    v_pk_fma_f32 v[32:33], v[32:33], v[28:29], v[42:43] op_sel:[1,1,0] op_sel_hi:[1,0,1] neg_lo:[1,0,0]
    v_cvt_pk_f16_f32 v45, v32, v33
    ds_write_addtid_b32 v45 offset:36576
    v_pk_mul_f32 v[42:43], v[32:33], v[28:29] op_sel:[0,0] op_sel_hi:[0,1]
    v_pk_fma_f32 v[32:33], v[32:33], v[28:29], v[42:43] op_sel:[1,1,0] op_sel_hi:[1,0,1] neg_lo:[1,0,0]
    v_cvt_pk_f16_f32 v44, v32, v33
    ds_write_addtid_b32 v44 offset:36848
    ds_read_b128 v[96:99], v4 offset:0
    ds_read_b128 v[100:103], v4 offset:64
    ds_read_b128 v[104:107], v4 offset:128
    ds_read_b128 v[108:111], v4 offset:192
    s_waitcnt lgkmcnt(3)
    v_mfma_f32_16x16x32_f16 v[56:59], v[64:67], v[96:99], 0
    v_mfma_f32_16x16x32_f16 v[60:63], v[80:83], v[96:99], 0
    s_waitcnt lgkmcnt(2)
    v_mfma_f32_16x16x32_f16 v[56:59], v[68:71], v[100:103], v[56:59]
    v_mfma_f32_16x16x32_f16 v[60:63], v[84:87], v[100:103], v[60:63]
    s_waitcnt lgkmcnt(1)
    v_mfma_f32_16x16x32_f16 v[56:59], v[72:75], v[104:107], v[56:59]
    v_mfma_f32_16x16x32_f16 v[60:63], v[88:91], v[104:107], v[60:63]
    s_waitcnt lgkmcnt(0)
    v_mfma_f32_16x16x32_f16 v[56:59], v[76:79], v[108:111], v[56:59]
    v_mfma_f32_16x16x32_f16 v[60:63], v[92:95], v[108:111], v[60:63]
    ds_write_b128 v9, v[48:51] offset:0
    ds_write_b128 v9, v[52:55] offset:1024
    s_nop 4
    ds_write_b128 v9, v[56:59] offset:2048
    ds_write_b128 v9, v[60:63] offset:3072
    s_lshl_b32 s48, s3, 2
    s_add_u32 s48, s48, 163776
    v_mov_b32 v3, s48
    v_mov_b32 v5, 1
    ds_write_b32 v3, v5
    s_mov_b32 s64, 0x05040100
    s_mov_b32 s65, 0x07060302
    s_setprio 0
    s_waitcnt vmcnt(2)
    v_cmp_eq_u32 vcc, 0, v118
    s_nop 0
    s_cbranch_vccz K1BI_OK
    v_mov_b32 v10, 0
    s_mov_b32 s15, 0
K1BI_PL:
    global_load_dword v11, v10, s[40:41] sc1
    s_waitcnt vmcnt(0)
    v_cmp_gt_u32 vcc, 1, v11
    s_add_u32 s15, s15, 1
    s_cbranch_vccz K1BI_OK
    s_sleep 1
    s_cmp_lt_u32 s15, 0x20000
    s_cbranch_scc1 K1BI_PL
K1BI_OK:
    global_load_dwordx4 v[32:35], v7, s[42:43] sc1
    global_load_dwordx4 v[36:39], v120, s[42:43] sc1
    v_lshlrev_b32 v64, 16, v160
    v_and_b32 v65, 0xffff0000, v160
    v_lshlrev_b32 v66, 16, v161
    v_and_b32 v67, 0xffff0000, v161
    v_lshlrev_b32 v68, 16, v162
    v_and_b32 v69, 0xffff0000, v162
    v_lshlrev_b32 v70, 16, v163
    v_and_b32 v71, 0xffff0000, v163
    v_lshlrev_b32 v72, 16, v164
    v_and_b32 v73, 0xffff0000, v164
    v_lshlrev_b32 v74, 16, v165
    v_and_b32 v75, 0xffff0000, v165
    v_lshlrev_b32 v76, 16, v166
    v_and_b32 v77, 0xffff0000, v166
    v_lshlrev_b32 v78, 16, v167
    v_and_b32 v79, 0xffff0000, v167
    v_lshlrev_b32 v80, 16, v168
    v_and_b32 v81, 0xffff0000, v168
    v_lshlrev_b32 v82, 16, v169
    v_and_b32 v83, 0xffff0000, v169
    v_lshlrev_b32 v84, 16, v170
    v_and_b32 v85, 0xffff0000, v170
    v_lshlrev_b32 v86, 16, v171
    v_and_b32 v87, 0xffff0000, v171
    s_waitcnt vmcnt(3)
    v_lshlrev_b32 v88, 16, v172
    v_and_b32 v89, 0xffff0000, v172
    v_lshlrev_b32 v90, 16, v173
    v_and_b32 v91, 0xffff0000, v173
    s_waitcnt vmcnt(2)
    v_lshlrev_b32 v92, 16, v174
    v_and_b32 v93, 0xffff0000, v174
    v_lshlrev_b32 v94, 16, v175
    v_and_b32 v95, 0xffff0000, v175
    v_perm_b32 v16, v162, v160, s64
    v_perm_b32 v17, v166, v164, s64
    v_perm_b32 v18, v170, v168, s64
    v_perm_b32 v19, v174, v172, s64
    ds_write_b64 v6, v[16:17] offset:0
    ds_write_b64 v121, v[18:19] offset:0
    v_perm_b32 v20, v162, v160, s65
    v_perm_b32 v21, v166, v164, s65
    v_perm_b32 v22, v170, v168, s65
    v_perm_b32 v23, v174, v172, s65
    ds_write_b64 v6, v[20:21] offset:4096
    ds_write_b64 v121, v[22:23] offset:4096
    v_perm_b32 v24, v163, v161, s64
    v_perm_b32 v25, v167, v165, s64
    v_perm_b32 v26, v171, v169, s64
    v_perm_b32 v27, v175, v173, s64
    ds_write_b64 v6, v[24:25] offset:8192
    ds_write_b64 v121, v[26:27] offset:8192
    v_perm_b32 v28, v163, v161, s65
    v_perm_b32 v29, v167, v165, s65
    v_perm_b32 v30, v171, v169, s65
    v_perm_b32 v31, v175, v173, s65
    ds_write_b64 v6, v[28:29] offset:12288
    ds_write_b64 v121, v[30:31] offset:12288
    s_mov_b32 s15, 0
K1_POLL:
    s_waitcnt vmcnt(0)
    v_min3_u32 v10, v32, v33, v34
    v_min3_u32 v11, v35, v36, v37
    v_min3_u32 v10, v10, v38, v39
    v_min_u32 v10, v10, v11
    v_cmp_eq_u32 vcc, 0, v10
    s_add_u32 s15, s15, 1
    s_cbranch_vccz K1_READY
    s_cmp_ge_u32 s15, 0x20000
    s_cbranch_scc1 K1_READY
    s_sleep 4
    global_load_dwordx4 v[32:35], v7, s[42:43] sc1
    global_load_dwordx4 v[36:39], v120, s[42:43] sc1
    s_branch K1_POLL
K1_READY:
    v_lshlrev_b32 v41, 16, v32
    v_and_b32 v40, 0xffff0000, v32
    v_rcp_f32 v41, v41
    v_lshlrev_b32 v43, 16, v33
    v_and_b32 v42, 0xffff0000, v33
    v_rcp_f32 v43, v43
    v_lshlrev_b32 v45, 16, v34
    v_and_b32 v44, 0xffff0000, v34
    v_rcp_f32 v45, v45
    v_lshlrev_b32 v47, 16, v35
    v_and_b32 v46, 0xffff0000, v35
    v_rcp_f32 v47, v47
    v_lshlrev_b32 v49, 16, v36
    v_and_b32 v48, 0xffff0000, v36
    v_rcp_f32 v49, v49
    v_lshlrev_b32 v51, 16, v37
    v_and_b32 v50, 0xffff0000, v37
    v_rcp_f32 v51, v51
    v_lshlrev_b32 v53, 16, v38
    v_and_b32 v52, 0xffff0000, v38
    v_rcp_f32 v53, v53
    v_lshlrev_b32 v55, 16, v39
    v_and_b32 v54, 0xffff0000, v39
    v_rcp_f32 v55, v55
    v_mul_f32 v40, v40, -v41
    v_mul_f32 v42, v42, -v43
    v_mul_f32 v44, v44, -v45
    v_mul_f32 v46, v46, -v47
    v_mul_f32 v48, v48, -v49
    v_mul_f32 v50, v50, -v51
    v_mul_f32 v52, v52, -v53
    v_mul_f32 v54, v54, -v55
    v_pk_fma_f32 v[64:65], v[64:65], v[40:41], v[40:41] op_sel:[0,1,0] op_sel_hi:[1,1,0]
    v_pk_fma_f32 v[66:67], v[66:67], v[40:41], v[40:41] op_sel:[0,1,0] op_sel_hi:[1,1,0]
    v_pk_fma_f32 v[68:69], v[68:69], v[42:43], v[42:43] op_sel:[0,1,0] op_sel_hi:[1,1,0]
    v_pk_fma_f32 v[70:71], v[70:71], v[42:43], v[42:43] op_sel:[0,1,0] op_sel_hi:[1,1,0]
    v_pk_fma_f32 v[72:73], v[72:73], v[44:45], v[44:45] op_sel:[0,1,0] op_sel_hi:[1,1,0]
    v_pk_fma_f32 v[74:75], v[74:75], v[44:45], v[44:45] op_sel:[0,1,0] op_sel_hi:[1,1,0]
    v_pk_fma_f32 v[76:77], v[76:77], v[46:47], v[46:47] op_sel:[0,1,0] op_sel_hi:[1,1,0]
    v_pk_fma_f32 v[78:79], v[78:79], v[46:47], v[46:47] op_sel:[0,1,0] op_sel_hi:[1,1,0]
    v_pk_fma_f32 v[80:81], v[80:81], v[48:49], v[48:49] op_sel:[0,1,0] op_sel_hi:[1,1,0]
    v_pk_fma_f32 v[82:83], v[82:83], v[48:49], v[48:49] op_sel:[0,1,0] op_sel_hi:[1,1,0]
    v_pk_fma_f32 v[84:85], v[84:85], v[50:51], v[50:51] op_sel:[0,1,0] op_sel_hi:[1,1,0]
    v_pk_fma_f32 v[86:87], v[86:87], v[50:51], v[50:51] op_sel:[0,1,0] op_sel_hi:[1,1,0]
    v_pk_fma_f32 v[88:89], v[88:89], v[52:53], v[52:53] op_sel:[0,1,0] op_sel_hi:[1,1,0]
    v_pk_fma_f32 v[90:91], v[90:91], v[52:53], v[52:53] op_sel:[0,1,0] op_sel_hi:[1,1,0]
    v_pk_fma_f32 v[92:93], v[92:93], v[54:55], v[54:55] op_sel:[0,1,0] op_sel_hi:[1,1,0]
    v_pk_fma_f32 v[94:95], v[94:95], v[54:55], v[54:55] op_sel:[0,1,0] op_sel_hi:[1,1,0]
    v_cvt_pk_f16_f32 v16, v64, v68
    v_cvt_pk_f16_f32 v17, v72, v76
    v_cvt_pk_f16_f32 v18, v80, v84
    v_cvt_pk_f16_f32 v19, v88, v92
    ds_write_b64 v8, v[16:17] offset:0
    ds_write_b64 v122, v[18:19] offset:0
    v_cvt_pk_f16_f32 v20, v65, v69
    v_cvt_pk_f16_f32 v21, v73, v77
    v_cvt_pk_f16_f32 v22, v81, v85
    v_cvt_pk_f16_f32 v23, v89, v93
    ds_write_b64 v8, v[20:21] offset:4608
    ds_write_b64 v122, v[22:23] offset:4608
    v_cvt_pk_f16_f32 v24, v66, v70
    v_cvt_pk_f16_f32 v25, v74, v78
    v_cvt_pk_f16_f32 v26, v82, v86
    v_cvt_pk_f16_f32 v27, v90, v94
    ds_write_b64 v8, v[24:25] offset:9216
    ds_write_b64 v122, v[26:27] offset:9216
    v_cvt_pk_f16_f32 v28, v67, v71
    v_cvt_pk_f16_f32 v29, v75, v79
    v_cvt_pk_f16_f32 v30, v83, v87
    v_cvt_pk_f16_f32 v31, v91, v95
    ds_write_b64 v8, v[28:29] offset:13824
    ds_write_b64 v122, v[30:31] offset:13824
    s_waitcnt lgkmcnt(0)
    s_setprio 0
    s_barrier
    global_load_dword v118, v119, s[40:41] sc1
    s_add_u32 m0, s72, 0
    s_add_u32 s13, s73, 0
    buffer_load_dwordx4 v112, s[68:71], s13 offen lds
    buffer_load_dwordx4 v113, s[68:71], s13 offen offset:1024 lds
    s_add_u32 m0, s72, 2048
    s_add_u32 s13, s75, 0
    buffer_load_dwordx4 v112, s[68:71], s13 offen lds
    buffer_load_dwordx4 v113, s[68:71], s13 offen offset:1024 lds
    s_add_u32 m0, s72, 4096
    s_add_u32 s13, s73, 128
    buffer_load_dwordx4 v112, s[68:71], s13 offen lds
    buffer_load_dwordx4 v113, s[68:71], s13 offen offset:1024 lds
    s_add_u32 m0, s72, 6144
    s_add_u32 s13, s75, 128
    buffer_load_dwordx4 v112, s[68:71], s13 offen lds
    buffer_load_dwordx4 v113, s[68:71], s13 offen offset:1024 lds
    s_add_u32 m0, s72, 8192
    s_add_u32 s13, s73, 256
    buffer_load_dwordx4 v112, s[68:71], s13 offen lds
    buffer_load_dwordx4 v113, s[68:71], s13 offen offset:1024 lds
    s_add_u32 m0, s72, 10240
    s_add_u32 s13, s75, 256
    buffer_load_dwordx4 v112, s[68:71], s13 offen lds
    buffer_load_dwordx4 v113, s[68:71], s13 offen offset:1024 lds
    s_add_u32 m0, s72, 12288
    s_add_u32 s13, s73, 384
    buffer_load_dwordx4 v112, s[68:71], s13 offen lds
    buffer_load_dwordx4 v113, s[68:71], s13 offen offset:1024 lds
    s_add_u32 m0, s72, 14336
    s_add_u32 s13, s75, 384
    buffer_load_dwordx4 v112, s[68:71], s13 offen lds
    buffer_load_dwordx4 v113, s[68:71], s13 offen offset:1024 lds
    s_waitcnt vmcnt(12)
    ds_read_b128 v[128:131], v114 offset:0
    ds_read_b128 v[192:195], v114 offset:2048
    ds_read_b128 v[132:135], v115 offset:0
    ds_read_b128 v[196:199], v115 offset:2048
    s_waitcnt lgkmcnt(0)
    s_add_u32 m0, s72, 0
    s_add_u32 s13, s73, 512
    buffer_load_dwordx4 v112, s[68:71], s13 offen lds
    buffer_load_dwordx4 v113, s[68:71], s13 offen offset:1024 lds
    s_add_u32 m0, s72, 2048
    s_add_u32 s13, s75, 512
    buffer_load_dwordx4 v112, s[68:71], s13 offen lds
    buffer_load_dwordx4 v113, s[68:71], s13 offen offset:1024 lds
    s_waitcnt vmcnt(12)
    ds_read_b128 v[136:139], v114 offset:4096
    ds_read_b128 v[200:203], v114 offset:6144
    ds_read_b128 v[140:143], v115 offset:4096
    ds_read_b128 v[204:207], v115 offset:6144
    s_waitcnt lgkmcnt(0)
    s_add_u32 m0, s72, 4096
    s_add_u32 s13, s73, 640
    buffer_load_dwordx4 v112, s[68:71], s13 offen lds
    buffer_load_dwordx4 v113, s[68:71], s13 offen offset:1024 lds
    s_add_u32 m0, s72, 6144
    s_add_u32 s13, s75, 640
    buffer_load_dwordx4 v112, s[68:71], s13 offen lds
    buffer_load_dwordx4 v113, s[68:71], s13 offen offset:1024 lds
    s_waitcnt vmcnt(12)
    ds_read_b128 v[144:147], v114 offset:8192
    ds_read_b128 v[208:211], v114 offset:10240
    ds_read_b128 v[148:151], v115 offset:8192
    ds_read_b128 v[212:215], v115 offset:10240
    s_waitcnt lgkmcnt(0)
    s_add_u32 m0, s72, 8192
    s_add_u32 s13, s73, 768
    buffer_load_dwordx4 v112, s[68:71], s13 offen lds
    buffer_load_dwordx4 v113, s[68:71], s13 offen offset:1024 lds
    s_add_u32 m0, s72, 10240
    s_add_u32 s13, s75, 768
    buffer_load_dwordx4 v112, s[68:71], s13 offen lds
    buffer_load_dwordx4 v113, s[68:71], s13 offen offset:1024 lds
    s_waitcnt vmcnt(12)
    ds_read_b128 v[152:155], v114 offset:12288
    ds_read_b128 v[216:219], v114 offset:14336
    ds_read_b128 v[156:159], v115 offset:12288
    ds_read_b128 v[220:223], v115 offset:14336
    s_waitcnt lgkmcnt(0)
    s_add_u32 m0, s72, 12288
    s_add_u32 s13, s73, 896
    buffer_load_dwordx4 v112, s[68:71], s13 offen lds
    buffer_load_dwordx4 v113, s[68:71], s13 offen offset:1024 lds
    s_add_u32 m0, s72, 14336
    s_add_u32 s13, s75, 896
    buffer_load_dwordx4 v112, s[68:71], s13 offen lds
    buffer_load_dwordx4 v113, s[68:71], s13 offen offset:1024 lds
    s_waitcnt vmcnt(12)
    ds_read_b128 v[160:163], v114 offset:0
    ds_read_b128 v[224:227], v114 offset:2048
    ds_read_b128 v[164:167], v115 offset:0
    ds_read_b128 v[228:231], v115 offset:2048
    s_waitcnt lgkmcnt(0)
    s_add_u32 m0, s72, 0
    s_add_u32 s13, s73, -2048
    buffer_load_dwordx4 v112, s[68:71], s13 offen lds
    buffer_load_dwordx4 v113, s[68:71], s13 offen offset:1024 lds
    s_add_u32 m0, s72, 2048
    s_add_u32 s13, s75, -2048
    buffer_load_dwordx4 v112, s[68:71], s13 offen lds
    buffer_load_dwordx4 v113, s[68:71], s13 offen offset:1024 lds
    s_waitcnt vmcnt(12)
    ds_read_b128 v[168:171], v114 offset:4096
    ds_read_b128 v[232:235], v114 offset:6144
    ds_read_b128 v[172:175], v115 offset:4096
    ds_read_b128 v[236:239], v115 offset:6144
    s_waitcnt lgkmcnt(0)
    s_add_u32 m0, s72, 4096
    s_add_u32 s13, s73, -1920
    buffer_load_dwordx4 v112, s[68:71], s13 offen lds
    buffer_load_dwordx4 v113, s[68:71], s13 offen offset:1024 lds
    s_add_u32 m0, s72, 6144
    s_add_u32 s13, s75, -1920
    buffer_load_dwordx4 v112, s[68:71], s13 offen lds
    buffer_load_dwordx4 v113, s[68:71], s13 offen offset:1024 lds
    s_waitcnt vmcnt(12)
    ds_read_b128 v[176:179], v114 offset:8192
    ds_read_b128 v[240:243], v114 offset:10240
    ds_read_b128 v[180:183], v115 offset:8192
    ds_read_b128 v[244:247], v115 offset:10240
    s_waitcnt lgkmcnt(0)
    s_add_u32 m0, s72, 8192
    s_add_u32 s13, s73, -1792
    buffer_load_dwordx4 v112, s[68:71], s13 offen lds
    buffer_load_dwordx4 v113, s[68:71], s13 offen offset:1024 lds
    s_add_u32 m0, s72, 10240
    s_add_u32 s13, s75, -1792
    buffer_load_dwordx4 v112, s[68:71], s13 offen lds
    buffer_load_dwordx4 v113, s[68:71], s13 offen offset:1024 lds
    s_waitcnt vmcnt(12)
    ds_read_b128 v[184:187], v114 offset:12288
    ds_read_b128 v[248:251], v114 offset:14336
    ds_read_b128 v[188:191], v115 offset:12288
    ds_read_b128 v[252:255], v115 offset:14336
    s_waitcnt lgkmcnt(0)
    s_add_u32 m0, s72, 12288
    s_add_u32 s13, s73, -1664
    buffer_load_dwordx4 v112, s[68:71], s13 offen lds
    buffer_load_dwordx4 v113, s[68:71], s13 offen offset:1024 lds
    s_add_u32 m0, s72, 14336
    s_add_u32 s13, s75, -1664
    buffer_load_dwordx4 v112, s[68:71], s13 offen lds
    buffer_load_dwordx4 v113, s[68:71], s13 offen offset:1024 lds
    s_cmp_lg_u32 s8, 4
    s_cbranch_scc1 K1V_OK
    v_cmp_gt_u32 vcc, 2, v118
    s_nop 0
    s_cbranch_vccz K1CI_OK
    v_mov_b32 v14, 0
    s_mov_b32 s15, 0
K1CI_PL:
    global_load_dword v15, v14, s[40:41] sc1
    s_waitcnt vmcnt(0)
    v_cmp_gt_u32 vcc, 2, v15
    s_add_u32 s15, s15, 1
    s_cbranch_vccz K1CI_OK
    s_sleep 1
    s_cmp_lt_u32 s15, 0x20000
    s_cbranch_scc1 K1CI_PL
K1CI_OK:
    v_and_b32 v14, 7, v1
    v_lshlrev_b32 v14, 7, v14
    v_add_u32 v14, 2629632, v14
    s_mov_b32 s15, 0
K1V_PL:
    global_load_dword v15, v14, s[42:43] sc1
    s_waitcnt vmcnt(0)
    v_cmp_gt_u32 vcc, 4, v15
    s_add_u32 s15, s15, 1
    s_cbranch_vccz K1V_OK
    s_sleep 2
    s_cmp_lt_u32 s15, 0x20000
    s_cbranch_scc1 K1V_PL
K1V_OK:
    s_waitcnt vmcnt(0)
    s_barrier
    s_branch PH3Y
K1_HELPER:
    s_lshl_b32 s9, s7, 3
    s_add_u32 s9, s9, s6
    s_cmp_ge_u32 s7, 8
    s_cbranch_scc1 K1_H2
    v_lshrrev_b32 v2, 4, v0
    s_lshl_b32 s10, s9, 5
    v_add_u32 v3, s10, v2
    v_mul_u32_u24 v3, 1280, v3
    v_and_b32 v4, 15, v0
    v_lshl_add_u32 v3, v4, 4, v3
    s_waitcnt lgkmcnt(0)
    global_load_dwordx4 v[16:19], v3, s[16:17] offset:0
    global_load_dwordx4 v[20:23], v3, s[16:17] offset:256
    global_load_dwordx4 v[24:27], v3, s[16:17] offset:512
    global_load_dwordx4 v[28:31], v3, s[16:17] offset:768
    global_load_dwordx4 v[32:35], v3, s[16:17] offset:1024
    s_mov_b32 s11, 0x3f803f80
    v_lshlrev_b32 v2, 2, v2
    v_add_u32 v2, 0x18000, v2
    v_mov_b32 v10, 0
    v_mov_b32 v11, 0
    v_mov_b32 v12, 0
    v_mov_b32 v13, 0
    s_lshl_b32 s12, s7, 17
    s_lshl_b32 s13, s6, 20
    s_add_u32 s12, s12, s13
    v_lshrrev_b32 v5, 4, v0
    v_lshlrev_b32 v5, 12, v5
    v_lshl_add_u32 v5, v4, 7, v5
    v_add_u32 v5, s12, v5
    s_waitcnt vmcnt(4)
    v_dot2_f32_bf16 v10, v16, s11, v10
    v_dot2_f32_bf16 v12, v16, v16, v12
    v_dot2_f32_bf16 v11, v17, s11, v11
    v_dot2_f32_bf16 v13, v17, v17, v13
    v_dot2_f32_bf16 v10, v18, s11, v10
    v_dot2_f32_bf16 v12, v18, v18, v12
    v_dot2_f32_bf16 v11, v19, s11, v11
    v_dot2_f32_bf16 v13, v19, v19, v13
    s_waitcnt vmcnt(3)
    v_dot2_f32_bf16 v10, v20, s11, v10
    v_dot2_f32_bf16 v12, v20, v20, v12
    v_dot2_f32_bf16 v11, v21, s11, v11
    v_dot2_f32_bf16 v13, v21, v21, v13
    v_dot2_f32_bf16 v10, v22, s11, v10
    v_dot2_f32_bf16 v12, v22, v22, v12
    v_dot2_f32_bf16 v11, v23, s11, v11
    v_dot2_f32_bf16 v13, v23, v23, v13
    s_waitcnt vmcnt(2)
    v_dot2_f32_bf16 v10, v24, s11, v10
    v_dot2_f32_bf16 v12, v24, v24, v12
    v_dot2_f32_bf16 v11, v25, s11, v11
    v_dot2_f32_bf16 v13, v25, v25, v13
    v_dot2_f32_bf16 v10, v26, s11, v10
    v_dot2_f32_bf16 v12, v26, v26, v12
    v_dot2_f32_bf16 v11, v27, s11, v11
    v_dot2_f32_bf16 v13, v27, v27, v13
    s_waitcnt vmcnt(1)
    v_dot2_f32_bf16 v10, v28, s11, v10
    v_dot2_f32_bf16 v12, v28, v28, v12
    v_dot2_f32_bf16 v11, v29, s11, v11
    v_dot2_f32_bf16 v13, v29, v29, v13
    v_dot2_f32_bf16 v10, v30, s11, v10
    v_dot2_f32_bf16 v12, v30, v30, v12
    v_dot2_f32_bf16 v11, v31, s11, v11
    v_dot2_f32_bf16 v13, v31, v31, v13
    s_waitcnt vmcnt(0)
    v_dot2_f32_bf16 v10, v32, s11, v10
    v_dot2_f32_bf16 v12, v32, v32, v12
    v_dot2_f32_bf16 v11, v33, s11, v11
    v_dot2_f32_bf16 v13, v33, v33, v13
    v_dot2_f32_bf16 v10, v34, s11, v10
    v_dot2_f32_bf16 v12, v34, v34, v12
    v_dot2_f32_bf16 v11, v35, s11, v11
    v_dot2_f32_bf16 v13, v35, v35, v13
    s_nop 1
    v_add_f32 v10, v10, v11
    v_add_f32 v12, v12, v13
    s_nop 0
    v_add_f32_dpp v10, v10, v10 row_ror:8 row_mask:0xf bank_mask:0xf
    v_add_f32_dpp v12, v12, v12 row_ror:8 row_mask:0xf bank_mask:0xf
    s_nop 0
    v_add_f32_dpp v10, v10, v10 row_ror:4 row_mask:0xf bank_mask:0xf
    v_add_f32_dpp v12, v12, v12 row_ror:4 row_mask:0xf bank_mask:0xf
    s_nop 0
    v_add_f32_dpp v10, v10, v10 row_ror:2 row_mask:0xf bank_mask:0xf
    v_add_f32_dpp v12, v12, v12 row_ror:2 row_mask:0xf bank_mask:0xf
    s_nop 0
    v_add_f32_dpp v10, v10, v10 row_ror:1 row_mask:0xf bank_mask:0xf
    v_add_f32_dpp v12, v12, v12 row_ror:1 row_mask:0xf bank_mask:0xf
    v_mul_f32 v10, 0x3acccccd, v10
    v_mul_f32 v11, v10, v10
    v_mul_f32 v12, 0x3acccccd, v12
    v_sub_f32 v12, v12, v11
    v_max_f32 v12, 0, v12
    v_cvt_pk_bf16_f32 v12, 0, v12
    v_add_f32 v12, 0x3727c5ac, v12
    v_cvt_pk_bf16_f32 v12, 0, v12
    v_sqrt_f32 v12, v12
    s_nop 0
    v_cvt_pk_bf16_f32 v12, v12, v10
    ds_write_b32 v2, v12
    s_cmp_lg_u32 s8, 4
    s_cbranch_scc1 K1_NI
    v_mov_b32 v10, 0
    s_mov_b32 s15, 0
K1HI_PL:
    global_load_dword v11, v10, s[40:41] sc1
    s_waitcnt vmcnt(0)
    v_cmp_gt_u32 vcc, 1, v11
    s_add_u32 s15, s15, 1
    s_cbranch_vccz K1HI_OK
    s_sleep 1
    s_cmp_lt_u32 s15, 0x20000
    s_cbranch_scc1 K1HI_PL
K1HI_OK:
K1_NI:
    s_waitcnt lgkmcnt(0)
    s_barrier
    s_cmp_lg_u32 s8, 4
    s_cbranch_scc1 K1_WO
    v_lshlrev_b32 v2, 2, v1
    v_add_u32 v3, 0x18000, v2
    ds_read_b32 v12, v3
    s_lshl_b32 s12, s9, 7
    s_add_u32 s12, s12, 2621440
    v_add_u32 v2, s12, v2
    s_waitcnt lgkmcnt(0)
    s_mov_b32 exec_hi, 0
    global_store_dword v2, v12, s[42:43] sc1
    s_mov_b32 exec_hi, -1
K1_WO:
    s_barrier
    v_mov_b32 v2, v5
    global_load_dword v255, v2, s[34:35] offset:2048
    s_barrier
    v_and_b32 v3, 0xfffffdff, v2
    global_load_dword v255, v3, s[34:35]
    s_barrier
    v_mov_b32 v10, 0
    global_load_dword v11, v10, s[40:41] sc1
    v_or_b32 v2, 0x200, v2
    global_load_dword v255, v2, s[34:35]
    s_waitcnt vmcnt(1)
    v_cmp_gt_u32 vcc, 2, v11
    s_nop 0
    s_cbranch_vccz K1SI_OK
    v_mov_b32 v10, 0
    s_mov_b32 s15, 0
K1SI_PL:
    global_load_dword v11, v10, s[40:41] sc1
    s_waitcnt vmcnt(0)
    v_cmp_gt_u32 vcc, 2, v11
    s_add_u32 s15, s15, 1
    s_cbranch_vccz K1SI_OK
    s_sleep 1
    s_cmp_lt_u32 s15, 0x20000
    s_cbranch_scc1 K1SI_PL
K1SI_OK:
    s_barrier
    s_cmp_lt_u32 s8, 4
    s_cbranch_scc1 K1_HX
    s_branch K1_HW
K1_H2:
    s_waitcnt lgkmcnt(0)
    s_sub_u32 s10, s9, 64
    s_lshl_b32 s14, s10, 13
    s_lshl_b32 s10, s10, 3
    s_add_u32 s10, s10, s8
    s_cmp_ge_u32 s10, 240
    s_cbranch_scc1 K1_H3
    s_mul_i32 s52, s10, 171
    s_lshr_b32 s52, s52, 11
    s_mul_i32 s60, s52, 12
    s_sub_u32 s60, s10, s60
    s_mul_i32 s12, s52, 98304
    s_lshl_b32 s13, s60, 7
    s_add_u32 s12, s12, s13
    v_lshrrev_b32 v7, 3, v1
    v_mul_u32_u24 v7, 3072, v7
    v_and_b32 v8, 7, v1
    v_lshl_add_u32 v7, v8, 4, v7
    v_lshrrev_b32 v8, 2, v1
    v_lshlrev_b32 v8, 7, v8
    v_and_b32 v9, 3, v1
    v_lshl_add_u32 v8, v9, 3, v8
    s_mul_i32 s56, s8, 12288
    v_add_u32 v8, s56, v8
    v_lshlrev_b32 v9, 4, v1
    s_mov_b32 s68, s32
    s_mov_b32 s69, s33
    s_mov_b32 s70, 1966080
    s_mov_b32 s71, 0x20000
    s_add_u32 s64, s42, 9437184
    s_addc_u32 s65, s43, 0
    s_mov_b32 s66, 1966080
    s_mov_b32 s67, 0x20000
    s_add_u32 m0, s56, 0
    s_add_u32 s13, s12, 1536
    buffer_load_dwordx4 v7, s[68:71], s13 offen lds
    s_add_u32 m0, s56, 1024
    s_add_u32 s13, s12, 26112
    buffer_load_dwordx4 v7, s[68:71], s13 offen lds
    s_add_u32 m0, s56, 2048
    s_add_u32 s13, s12, 50688
    buffer_load_dwordx4 v7, s[68:71], s13 offen lds
    s_add_u32 m0, s56, 3072
    s_add_u32 s13, s12, 75264
    buffer_load_dwordx4 v7, s[68:71], s13 offen lds
    s_add_u32 m0, s56, 4096
    s_add_u32 s13, s12, 0
    buffer_load_dwordx4 v7, s[68:71], s13 offen lds
    s_add_u32 m0, s56, 5120
    s_add_u32 s13, s12, 24576
    buffer_load_dwordx4 v7, s[68:71], s13 offen lds
    s_add_u32 m0, s56, 6144
    s_add_u32 s13, s12, 49152
    buffer_load_dwordx4 v7, s[68:71], s13 offen lds
    s_add_u32 m0, s56, 7168
    s_add_u32 s13, s12, 73728
    buffer_load_dwordx4 v7, s[68:71], s13 offen lds
    s_mov_b32 s11, 0x3f803f80
    s_mul_i32 s12, s60, 5120
    s_lshl_b32 s13, s52, 4
    s_add_u32 s12, s12, s13
    s_add_u32 s12, s12, 2949120
    v_lshrrev_b32 v2, 2, v1
    v_mul_u32_u24 v2, 320, v2
    v_and_b32 v3, 3, v1
    v_lshl_add_u32 v2, v3, 2, v2
    v_add_u32 v2, s12, v2
    v_add_u32 v3, 61440, v2
    s_waitcnt vmcnt(4)
    s_lshl_b32 s57, s60, 2
    s_add_u32 s57, s57, 48
    ds_read_b64_tr_b16 v[16:17], v8 offset:0
    ds_read_b64_tr_b16 v[18:19], v8 offset:2048
    ds_read_b64_tr_b16 v[20:21], v8 offset:32
    ds_read_b64_tr_b16 v[22:23], v8 offset:2080
    ds_read_b64_tr_b16 v[24:25], v8 offset:64
    ds_read_b64_tr_b16 v[26:27], v8 offset:2112
    ds_read_b64_tr_b16 v[28:29], v8 offset:96
    ds_read_b64_tr_b16 v[30:31], v8 offset:2144
    s_add_u32 s53, s57, 0
    s_mul_i32 s54, s53, 43
    s_lshr_b32 s54, s54, 8
    s_mul_i32 s55, s54, 19
    s_add_u32 s55, s55, s52
    s_mul_i32 s55, s55, 6
    s_add_u32 s55, s55, s53
    s_lshl_b32 s55, s55, 10
    s_waitcnt lgkmcnt(6)
    buffer_store_dwordx4 v[16:19], v9, s[64:67], s55 offen sc1
    s_add_u32 s53, s57, 1
    s_mul_i32 s54, s53, 43
    s_lshr_b32 s54, s54, 8
    s_mul_i32 s55, s54, 19
    s_add_u32 s55, s55, s52
    s_mul_i32 s55, s55, 6
    s_add_u32 s55, s55, s53
    s_lshl_b32 s55, s55, 10
    s_waitcnt lgkmcnt(4)
    buffer_store_dwordx4 v[20:23], v9, s[64:67], s55 offen sc1
    s_add_u32 s53, s57, 2
    s_mul_i32 s54, s53, 43
    s_lshr_b32 s54, s54, 8
    s_mul_i32 s55, s54, 19
    s_add_u32 s55, s55, s52
    s_mul_i32 s55, s55, 6
    s_add_u32 s55, s55, s53
    s_lshl_b32 s55, s55, 10
    s_waitcnt lgkmcnt(2)
    buffer_store_dwordx4 v[24:27], v9, s[64:67], s55 offen sc1
    s_add_u32 s53, s57, 3
    s_mul_i32 s54, s53, 43
    s_lshr_b32 s54, s54, 8
    s_mul_i32 s55, s54, 19
    s_add_u32 s55, s55, s52
    s_mul_i32 s55, s55, 6
    s_add_u32 s55, s55, s53
    s_lshl_b32 s55, s55, 10
    s_waitcnt lgkmcnt(0)
    buffer_store_dwordx4 v[28:31], v9, s[64:67], s55 offen sc1
    v_dot2_f32_bf16 v48, v16, s11, 0
    v_dot2_f32_bf16 v49, v20, s11, 0
    v_dot2_f32_bf16 v50, v24, s11, 0
    v_dot2_f32_bf16 v51, v28, s11, 0
    v_dot2_f32_bf16 v48, v17, s11, v48
    v_dot2_f32_bf16 v49, v21, s11, v49
    v_dot2_f32_bf16 v50, v25, s11, v50
    v_dot2_f32_bf16 v51, v29, s11, v51
    v_dot2_f32_bf16 v48, v18, s11, v48
    v_dot2_f32_bf16 v49, v22, s11, v49
    v_dot2_f32_bf16 v50, v26, s11, v50
    v_dot2_f32_bf16 v51, v30, s11, v51
    v_dot2_f32_bf16 v48, v19, s11, v48
    v_dot2_f32_bf16 v49, v23, s11, v49
    v_dot2_f32_bf16 v50, v27, s11, v50
    v_dot2_f32_bf16 v51, v31, s11, v51
    s_nop 0
    v_permlane16_swap_b32 v48, v49
    s_nop 0
    v_permlane16_swap_b32 v50, v51
    v_add_f32 v48, v48, v49
    v_add_f32 v50, v50, v51
    s_nop 1
    v_permlane32_swap_b32 v48, v50
    v_add_f32 v48, v48, v50
    global_store_dword v3, v48, s[42:43] sc1
    s_waitcnt vmcnt(5)
    s_lshl_b32 s57, s60, 2
    s_add_u32 s57, s57, 0
    ds_read_b64_tr_b16 v[32:33], v8 offset:4096
    ds_read_b64_tr_b16 v[34:35], v8 offset:6144
    ds_read_b64_tr_b16 v[36:37], v8 offset:4128
    ds_read_b64_tr_b16 v[38:39], v8 offset:6176
    ds_read_b64_tr_b16 v[40:41], v8 offset:4160
    ds_read_b64_tr_b16 v[42:43], v8 offset:6208
    ds_read_b64_tr_b16 v[44:45], v8 offset:4192
    ds_read_b64_tr_b16 v[46:47], v8 offset:6240
    s_add_u32 s53, s57, 0
    s_mul_i32 s54, s53, 43
    s_lshr_b32 s54, s54, 8
    s_mul_i32 s55, s54, 19
    s_add_u32 s55, s55, s52
    s_mul_i32 s55, s55, 6
    s_add_u32 s55, s55, s53
    s_lshl_b32 s55, s55, 10
    s_waitcnt lgkmcnt(6)
    buffer_store_dwordx4 v[32:35], v9, s[64:67], s55 offen sc1
    s_add_u32 s53, s57, 1
    s_mul_i32 s54, s53, 43
    s_lshr_b32 s54, s54, 8
    s_mul_i32 s55, s54, 19
    s_add_u32 s55, s55, s52
    s_mul_i32 s55, s55, 6
    s_add_u32 s55, s55, s53
    s_lshl_b32 s55, s55, 10
    s_waitcnt lgkmcnt(4)
    buffer_store_dwordx4 v[36:39], v9, s[64:67], s55 offen sc1
    s_add_u32 s53, s57, 2
    s_mul_i32 s54, s53, 43
    s_lshr_b32 s54, s54, 8
    s_mul_i32 s55, s54, 19
    s_add_u32 s55, s55, s52
    s_mul_i32 s55, s55, 6
    s_add_u32 s55, s55, s53
    s_lshl_b32 s55, s55, 10
    s_waitcnt lgkmcnt(2)
    buffer_store_dwordx4 v[40:43], v9, s[64:67], s55 offen sc1
    s_add_u32 s53, s57, 3
    s_mul_i32 s54, s53, 43
    s_lshr_b32 s54, s54, 8
    s_mul_i32 s55, s54, 19
    s_add_u32 s55, s55, s52
    s_mul_i32 s55, s55, 6
    s_add_u32 s55, s55, s53
    s_lshl_b32 s55, s55, 10
    s_waitcnt lgkmcnt(0)
    buffer_store_dwordx4 v[44:47], v9, s[64:67], s55 offen sc1
    v_dot2_f32_bf16 v52, v32, s11, 0
    v_dot2_f32_bf16 v53, v36, s11, 0
    v_dot2_f32_bf16 v54, v40, s11, 0
    v_dot2_f32_bf16 v55, v44, s11, 0
    v_dot2_f32_bf16 v52, v33, s11, v52
    v_dot2_f32_bf16 v53, v37, s11, v53
    v_dot2_f32_bf16 v54, v41, s11, v54
    v_dot2_f32_bf16 v55, v45, s11, v55
    v_dot2_f32_bf16 v52, v34, s11, v52
    v_dot2_f32_bf16 v53, v38, s11, v53
    v_dot2_f32_bf16 v54, v42, s11, v54
    v_dot2_f32_bf16 v55, v46, s11, v55
    v_dot2_f32_bf16 v52, v35, s11, v52
    v_dot2_f32_bf16 v53, v39, s11, v53
    v_dot2_f32_bf16 v54, v43, s11, v54
    v_dot2_f32_bf16 v55, v47, s11, v55
    s_nop 0
    v_permlane16_swap_b32 v52, v53
    s_nop 0
    v_permlane16_swap_b32 v54, v55
    v_add_f32 v52, v52, v53
    v_add_f32 v54, v54, v55
    s_nop 1
    v_permlane32_swap_b32 v52, v54
    v_add_f32 v52, v52, v54
    global_store_dword v2, v52, s[42:43] sc1
K1_H3:
    s_add_u32 s14, s14, 2686976
    v_lshl_add_u32 v2, v0, 4, s14
    v_mov_b32 v4, -1
    v_mov_b32 v5, -1
    v_mov_b32 v6, -1
    v_mov_b32 v7, -1
    global_store_dwordx4 v2, v[4:7], s[42:43] sc1
K1_PF:
    s_cmp_lg_u32 s8, 4
    s_cbranch_scc1 K1_PG
    v_mov_b32 v10, 0
    s_mov_b32 s15, 0
K1PI_PL:
    global_load_dword v11, v10, s[40:41] sc1
    s_waitcnt vmcnt(0)
    v_cmp_gt_u32 vcc, 2, v11
    s_add_u32 s15, s15, 1
    s_cbranch_vccz K1PI_OK
    s_sleep 1
    s_cmp_lt_u32 s15, 0x20000
    s_cbranch_scc1 K1PI_PL
K1PI_OK:
K1_PG:
    s_waitcnt vmcnt(0)
    s_barrier
    s_cmp_lg_u32 s8, 4
    s_cbranch_scc1 K1_NA
    s_lshl_b32 s12, s6, 7
    s_add_u32 s9, s12, 2629632
    v_mov_b32 v10, s9
    v_mov_b32 v11, 1
    s_mov_b64 exec, 1
    global_atomic_add v10, v11, s[42:43] sc1
    s_mov_b64 exec, -1
K1_NA:
    s_cmp_ge_u32 s10, 240
    s_cbranch_scc1 K1_NS
    s_mul_i32 s61, s10, 205
    s_lshr_b32 s61, s61, 11
    s_mul_i32 s62, s61, 10
    s_sub_u32 s62, s10, s62
    s_mul_i32 s58, s61, 40960
    s_lshl_b32 s15, s62, 7
    s_add_u32 s58, s58, s15
    s_lshl_b32 s62, s62, 2
    v_lshrrev_b32 v7, 3, v1
    v_mul_u32_u24 v7, 1280, v7
    v_and_b32 v8, 7, v1
    v_lshl_add_u32 v7, v8, 4, v7
    v_lshrrev_b32 v8, 2, v1
    v_lshlrev_b32 v8, 7, v8
    v_and_b32 v9, 3, v1
    v_lshl_add_u32 v8, v9, 3, v8
    s_mul_i32 s56, s8, 12288
    v_add_u32 v8, s56, v8
    v_lshlrev_b32 v9, 4, v1
    s_mov_b32 s68, s38
    s_mov_b32 s69, s39
    s_mov_b32 s70, 983040
    s_mov_b32 s71, 0x20000
    s_add_u32 m0, s56, 0
    s_add_u32 s13, s58, 0
    buffer_load_dwordx4 v7, s[68:71], s13 offen lds
    s_add_u32 m0, s56, 1024
    s_add_u32 s13, s58, 10240
    buffer_load_dwordx4 v7, s[68:71], s13 offen lds
    s_add_u32 m0, s56, 2048
    s_add_u32 s13, s58, 20480
    buffer_load_dwordx4 v7, s[68:71], s13 offen lds
    s_add_u32 m0, s56, 3072
    s_add_u32 s13, s58, 30720
    buffer_load_dwordx4 v7, s[68:71], s13 offen lds
    s_add_u32 s64, s42, 11403264
    s_addc_u32 s65, s43, 0
    s_mov_b32 s66, 983040
    s_mov_b32 s67, 0x20000
    s_mov_b32 s52, s61
    s_waitcnt vmcnt(0)
    ds_read_b64_tr_b16 v[16:17], v8 offset:0
    ds_read_b64_tr_b16 v[18:19], v8 offset:2048
    ds_read_b64_tr_b16 v[20:21], v8 offset:32
    ds_read_b64_tr_b16 v[22:23], v8 offset:2080
    ds_read_b64_tr_b16 v[24:25], v8 offset:64
    ds_read_b64_tr_b16 v[26:27], v8 offset:2112
    ds_read_b64_tr_b16 v[28:29], v8 offset:96
    ds_read_b64_tr_b16 v[30:31], v8 offset:2144
    s_add_u32 s53, s62, 0
    s_mul_i32 s54, s53, 52
    s_lshr_b32 s54, s54, 8
    s_mul_i32 s55, s54, 23
    s_add_u32 s55, s55, s52
    s_mul_i32 s55, s55, 5
    s_add_u32 s55, s55, s53
    s_lshl_b32 s55, s55, 10
    s_waitcnt lgkmcnt(6)
    buffer_store_dwordx4 v[16:19], v9, s[64:67], s55 offen sc1
    s_add_u32 s53, s62, 1
    s_mul_i32 s54, s53, 52
    s_lshr_b32 s54, s54, 8
    s_mul_i32 s55, s54, 23
    s_add_u32 s55, s55, s52
    s_mul_i32 s55, s55, 5
    s_add_u32 s55, s55, s53
    s_lshl_b32 s55, s55, 10
    s_waitcnt lgkmcnt(4)
    buffer_store_dwordx4 v[20:23], v9, s[64:67], s55 offen sc1
    s_add_u32 s53, s62, 2
    s_mul_i32 s54, s53, 52
    s_lshr_b32 s54, s54, 8
    s_mul_i32 s55, s54, 23
    s_add_u32 s55, s55, s52
    s_mul_i32 s55, s55, 5
    s_add_u32 s55, s55, s53
    s_lshl_b32 s55, s55, 10
    s_waitcnt lgkmcnt(2)
    buffer_store_dwordx4 v[24:27], v9, s[64:67], s55 offen sc1
    s_add_u32 s53, s62, 3
    s_mul_i32 s54, s53, 52
    s_lshr_b32 s54, s54, 8
    s_mul_i32 s55, s54, 23
    s_add_u32 s55, s55, s52
    s_mul_i32 s55, s55, 5
    s_add_u32 s55, s55, s53
    s_lshl_b32 s55, s55, 10
    s_waitcnt lgkmcnt(0)
    buffer_store_dwordx4 v[28:31], v9, s[64:67], s55 offen sc1
K1_NS:
    s_barrier
    s_cmp_lt_u32 s8, 4
    s_cbranch_scc1 K1_HX
K1_HW:
    s_setprio 0
    s_lshl_b32 s12, s46, 7
    s_lshl_b32 s13, s3, 5
    s_add_u32 s12, s12, s13
    v_and_b32 v126, 15, v1
    v_lshl_add_u32 v126, v126, 1, s12
    global_load_ushort v126, v126, s[36:37]
    s_lshl_b32 s73, s46, 1
    s_lshr_b32 s13, s3, 1
    s_add_u32 s73, s73, s13
    s_lshl_b32 s73, s73, 17
    s_lshr_b32 s13, s8, 2
    s_lshl_b32 s13, s13, 1
    s_and_b32 s9, s8, 1
    s_add_u32 s13, s13, s9
    s_lshl_b32 s13, s13, 10
    s_add_u32 s73, s73, s13
    s_lshl_b32 s9, s9, 16
    s_add_u32 s73, s73, s9
    s_xor_b32 s75, s73, 0x10000
    s_mul_i32 s72, s3, 16384
    s_add_u32 s72, s72, 32768
    v_lshrrev_b32 v10, 3, v1
    v_lshrrev_b32 v11, 4, v1
    v_and_b32 v12, 7, v1
    v_xor_b32 v11, v11, v12
    v_lshlrev_b32 v10, 12, v10
    v_lshl_add_u32 v10, v11, 4, v10
    v_xor_b32 v11, 64, v10
    v_add_u32 v11, 31744, v11
    v_and_b32 v13, 15, v1
    v_lshrrev_b32 v12, 1, v13
    v_lshlrev_b32 v12, 4, v12
    v_lshl_add_u32 v12, v13, 7, v12
    v_and_b32 v13, 48, v1
    v_xor_b32 v12, v12, v13
    v_add_u32 v12, s72, v12
    v_xor_b32 v13, 64, v12
    s_mov_b32 s68, s34
    s_mov_b32 s69, s35
    s_mov_b32 s70, 8388608
    s_mov_b32 s71, 0x20000
    s_mul_i32 s59, s3, 3072
    s_mul_i32 s12, s47, 122880
    s_add_u32 s12, s12, s59
    v_lshl_add_u32 v6, v1, 4, s12
    s_add_u32 s59, s59, 101888
    s_add_u32 s52, s42, 9437184
    s_addc_u32 s53, s43, 0
    s_mov_b32 s54, 1966080
    s_mov_b32 s55, 0x20000
    v_and_b32 v14, 7, v1
    v_lshlrev_b32 v14, 7, v14
    v_add_u32 v14, 2629632, v14
    s_add_u32 m0, s72, 0
    s_add_u32 s13, s73, 0
    buffer_load_dwordx4 v10, s[68:71], s13 offen lds
    buffer_load_dwordx4 v11, s[68:71], s13 offen offset:1024 lds
    s_add_u32 m0, s72, 2048
    s_add_u32 s13, s75, 0
    buffer_load_dwordx4 v10, s[68:71], s13 offen lds
    buffer_load_dwordx4 v11, s[68:71], s13 offen offset:1024 lds
    s_add_u32 m0, s72, 4096
    s_add_u32 s13, s73, 128
    buffer_load_dwordx4 v10, s[68:71], s13 offen lds
    buffer_load_dwordx4 v11, s[68:71], s13 offen offset:1024 lds
    s_add_u32 m0, s72, 6144
    s_add_u32 s13, s75, 128
    buffer_load_dwordx4 v10, s[68:71], s13 offen lds
    buffer_load_dwordx4 v11, s[68:71], s13 offen offset:1024 lds
    global_load_dword v15, v14, s[42:43] sc1
    s_add_u32 m0, s72, 8192
    s_add_u32 s13, s73, 256
    buffer_load_dwordx4 v10, s[68:71], s13 offen lds
    buffer_load_dwordx4 v11, s[68:71], s13 offen offset:1024 lds
    s_add_u32 m0, s72, 10240
    s_add_u32 s13, s75, 256
    buffer_load_dwordx4 v10, s[68:71], s13 offen lds
    buffer_load_dwordx4 v11, s[68:71], s13 offen offset:1024 lds
    s_add_u32 m0, s72, 12288
    s_add_u32 s13, s73, 384
    buffer_load_dwordx4 v10, s[68:71], s13 offen lds
    buffer_load_dwordx4 v11, s[68:71], s13 offen offset:1024 lds
    s_add_u32 m0, s72, 14336
    s_add_u32 s13, s75, 384
    buffer_load_dwordx4 v10, s[68:71], s13 offen lds
    buffer_load_dwordx4 v11, s[68:71], s13 offen offset:1024 lds
    s_waitcnt vmcnt(8)
    v_cmp_gt_u32 vcc, 4, v15
    s_nop 0
    s_cbranch_vccz K1W_OK
    s_mov_b32 s15, 0
K1W_PL:
    global_load_dword v15, v14, s[42:43] sc1
    s_waitcnt vmcnt(0)
    v_cmp_gt_u32 vcc, 4, v15
    s_add_u32 s15, s15, 1
    s_cbranch_vccz K1W_OK
    s_sleep 2
    s_cmp_lt_u32 s15, 0x20000
    s_cbranch_scc1 K1W_PL
K1W_OK:
    s_add_u32 m0, s59, 24576
    s_mov_b32 s57, 983040
    buffer_load_dwordx4 v6, s[52:55], s57 offen offset:0 sc1 lds
    buffer_load_dwordx4 v6, s[52:55], s57 offen offset:1024 sc1 lds
    buffer_load_dwordx4 v6, s[52:55], s57 offen offset:2048 sc1 lds
    s_waitcnt vmcnt(15)
    ds_read_b128 v[128:131], v12 offset:0
    ds_read_b128 v[192:195], v12 offset:2048
    ds_read_b128 v[132:135], v13 offset:0
    ds_read_b128 v[196:199], v13 offset:2048
    s_add_u32 m0, s59, 36864
    s_mov_b32 s57, 995328
    buffer_load_dwordx4 v6, s[52:55], s57 offen offset:0 sc1 lds
    buffer_load_dwordx4 v6, s[52:55], s57 offen offset:1024 sc1 lds
    buffer_load_dwordx4 v6, s[52:55], s57 offen offset:2048 sc1 lds
    s_waitcnt vmcnt(14)
    ds_read_b128 v[136:139], v12 offset:4096
    ds_read_b128 v[200:203], v12 offset:6144
    ds_read_b128 v[140:143], v13 offset:4096
    ds_read_b128 v[204:207], v13 offset:6144
    s_waitcnt lgkmcnt(4)
    s_add_u32 m0, s72, 0
    s_add_u32 s13, s73, 512
    buffer_load_dwordx4 v10, s[68:71], s13 offen lds
    buffer_load_dwordx4 v11, s[68:71], s13 offen offset:1024 lds
    s_add_u32 m0, s72, 2048
    s_add_u32 s13, s75, 512
    buffer_load_dwordx4 v10, s[68:71], s13 offen lds
    buffer_load_dwordx4 v11, s[68:71], s13 offen offset:1024 lds
    s_add_u32 m0, s59, 49152
    s_mov_b32 s57, 1007616
    buffer_load_dwordx4 v6, s[52:55], s57 offen offset:0 sc1 lds
    buffer_load_dwordx4 v6, s[52:55], s57 offen offset:1024 sc1 lds
    buffer_load_dwordx4 v6, s[52:55], s57 offen offset:2048 sc1 lds
    s_waitcnt vmcnt(17)
    ds_read_b128 v[144:147], v12 offset:8192
    ds_read_b128 v[208:211], v12 offset:10240
    ds_read_b128 v[148:151], v13 offset:8192
    ds_read_b128 v[212:215], v13 offset:10240
    s_waitcnt lgkmcnt(4)
    s_add_u32 m0, s72, 4096
    s_add_u32 s13, s73, 640
    buffer_load_dwordx4 v10, s[68:71], s13 offen lds
    buffer_load_dwordx4 v11, s[68:71], s13 offen offset:1024 lds
    s_add_u32 m0, s72, 6144
    s_add_u32 s13, s75, 640
    buffer_load_dwordx4 v10, s[68:71], s13 offen lds
    buffer_load_dwordx4 v11, s[68:71], s13 offen offset:1024 lds
    s_add_u32 m0, s59, 0
    s_mov_b32 s57, 1019904
    buffer_load_dwordx4 v6, s[52:55], s57 offen offset:0 sc1 lds
    buffer_load_dwordx4 v6, s[52:55], s57 offen offset:1024 sc1 lds
    buffer_load_dwordx4 v6, s[52:55], s57 offen offset:2048 sc1 lds
    s_waitcnt vmcnt(20)
    ds_read_b128 v[152:155], v12 offset:12288
    ds_read_b128 v[216:219], v12 offset:14336
    ds_read_b128 v[156:159], v13 offset:12288
    ds_read_b128 v[220:223], v13 offset:14336
    s_waitcnt lgkmcnt(4)
    s_add_u32 m0, s72, 8192
    s_add_u32 s13, s73, 768
    buffer_load_dwordx4 v10, s[68:71], s13 offen lds
    buffer_load_dwordx4 v11, s[68:71], s13 offen offset:1024 lds
    s_add_u32 m0, s72, 10240
    s_add_u32 s13, s75, 768
    buffer_load_dwordx4 v10, s[68:71], s13 offen lds
    buffer_load_dwordx4 v11, s[68:71], s13 offen offset:1024 lds
    s_add_u32 m0, s59, 12288
    s_mov_b32 s57, 1032192
    buffer_load_dwordx4 v6, s[52:55], s57 offen offset:0 sc1 lds
    buffer_load_dwordx4 v6, s[52:55], s57 offen offset:1024 sc1 lds
    buffer_load_dwordx4 v6, s[52:55], s57 offen offset:2048 sc1 lds
    s_waitcnt lgkmcnt(0)
    s_add_u32 m0, s72, 12288
    s_add_u32 s13, s73, 896
    buffer_load_dwordx4 v10, s[68:71], s13 offen lds
    buffer_load_dwordx4 v11, s[68:71], s13 offen offset:1024 lds
    s_add_u32 m0, s72, 14336
    s_add_u32 s13, s75, 896
    buffer_load_dwordx4 v10, s[68:71], s13 offen lds
    buffer_load_dwordx4 v11, s[68:71], s13 offen offset:1024 lds
    s_waitcnt vmcnt(21)
    ds_read_b128 v[160:163], v12 offset:0
    ds_read_b128 v[224:227], v12 offset:2048
    ds_read_b128 v[164:167], v13 offset:0
    ds_read_b128 v[228:231], v13 offset:2048
    s_waitcnt vmcnt(14)
    ds_read_b128 v[168:171], v12 offset:4096
    ds_read_b128 v[232:235], v12 offset:6144
    ds_read_b128 v[172:175], v13 offset:4096
    ds_read_b128 v[236:239], v13 offset:6144
    s_waitcnt vmcnt(7)
    ds_read_b128 v[176:179], v12 offset:8192
    ds_read_b128 v[240:243], v12 offset:10240
    ds_read_b128 v[180:183], v13 offset:8192
    ds_read_b128 v[244:247], v13 offset:10240
    s_waitcnt vmcnt(0)
    ds_read_b128 v[184:187], v12 offset:12288
    ds_read_b128 v[248:251], v12 offset:14336
    ds_read_b128 v[188:191], v13 offset:12288
    ds_read_b128 v[252:255], v13 offset:14336
    s_waitcnt lgkmcnt(0)
    s_barrier
    s_cmp_lg_u32 s8, 4
    s_cbranch_scc1 PH3Y
    s_cmp_lt_u32 s7, 8
    s_cbranch_scc1 PH3Y
    s_lshl_b32 s12, s6, 7
    s_add_u32 s9, s12, 2630656
    v_mov_b32 v14, s9
    v_mov_b32 v15, 1
    s_mov_b64 exec, 1
    global_atomic_add v14, v15, s[42:43] sc1
    s_mov_b64 exec, -1
    s_branch PH3Y
K1_HX:
    s_lshl_b32 s73, s46, 1
    s_lshr_b32 s13, s3, 1
    s_add_u32 s73, s73, s13
    s_lshl_b32 s73, s73, 17
    s_lshr_b32 s13, s8, 2
    s_lshl_b32 s13, s13, 1
    s_and_b32 s9, s8, 1
    s_add_u32 s13, s13, s9
    s_lshl_b32 s13, s13, 10
    s_add_u32 s73, s73, s13
    s_lshl_b32 s9, s9, 16
    s_add_u32 s73, s73, s9
    s_xor_b32 s75, s73, 0x10000
    s_mul_i32 s72, s3, 8192
    s_add_u32 s72, s72, 0
    v_lshrrev_b32 v112, 3, v1
    v_lshrrev_b32 v113, 4, v1
    v_and_b32 v114, 7, v1
    v_xor_b32 v113, v113, v114
    v_lshlrev_b32 v112, 12, v112
    v_lshl_add_u32 v112, v113, 4, v112
    v_xor_b32 v113, 64, v112
    v_add_u32 v113, 31744, v113
    v_and_b32 v115, 15, v1
    v_lshrrev_b32 v114, 1, v115
    v_lshlrev_b32 v114, 4, v114
    v_lshl_add_u32 v114, v115, 7, v114
    v_and_b32 v115, 48, v1
    v_xor_b32 v114, v114, v115
    v_add_u32 v114, s72, v114
    v_xor_b32 v115, 64, v114
    s_mov_b32 s68, s34
    s_mov_b32 s69, s35
    s_mov_b32 s70, 8388608
    s_mov_b32 s71, 0x20000
    s_add_u32 m0, s72, 0
    s_add_u32 s13, s73, 0
    buffer_load_dwordx4 v112, s[68:71], s13 offen lds
    buffer_load_dwordx4 v113, s[68:71], s13 offen offset:1024 lds
    s_add_u32 m0, s72, 2048
    s_add_u32 s13, s75, 0
    buffer_load_dwordx4 v112, s[68:71], s13 offen lds
    buffer_load_dwordx4 v113, s[68:71], s13 offen offset:1024 lds
    s_add_u32 m0, s72, 4096
    s_add_u32 s13, s73, 128
    buffer_load_dwordx4 v112, s[68:71], s13 offen lds
    buffer_load_dwordx4 v113, s[68:71], s13 offen offset:1024 lds
    s_add_u32 m0, s72, 6144
    s_add_u32 s13, s75, 128
    buffer_load_dwordx4 v112, s[68:71], s13 offen lds
    buffer_load_dwordx4 v113, s[68:71], s13 offen offset:1024 lds
    s_waitcnt vmcnt(4)
    ds_read_b128 v[128:131], v114 offset:0
    ds_read_b128 v[192:195], v114 offset:2048
    ds_read_b128 v[132:135], v115 offset:0
    ds_read_b128 v[196:199], v115 offset:2048
    s_waitcnt lgkmcnt(0)
    s_add_u32 m0, s72, 0
    s_add_u32 s13, s73, 256
    buffer_load_dwordx4 v112, s[68:71], s13 offen lds
    buffer_load_dwordx4 v113, s[68:71], s13 offen offset:1024 lds
    s_add_u32 m0, s72, 2048
    s_add_u32 s13, s75, 256
    buffer_load_dwordx4 v112, s[68:71], s13 offen lds
    buffer_load_dwordx4 v113, s[68:71], s13 offen offset:1024 lds
    s_waitcnt vmcnt(4)
    ds_read_b128 v[136:139], v114 offset:4096
    ds_read_b128 v[200:203], v114 offset:6144
    ds_read_b128 v[140:143], v115 offset:4096
    ds_read_b128 v[204:207], v115 offset:6144
    s_waitcnt lgkmcnt(0)
    s_add_u32 m0, s72, 4096
    s_add_u32 s13, s73, 384
    buffer_load_dwordx4 v112, s[68:71], s13 offen lds
    buffer_load_dwordx4 v113, s[68:71], s13 offen offset:1024 lds
    s_add_u32 m0, s72, 6144
    s_add_u32 s13, s75, 384
    buffer_load_dwordx4 v112, s[68:71], s13 offen lds
    buffer_load_dwordx4 v113, s[68:71], s13 offen offset:1024 lds
    s_waitcnt vmcnt(4)
    ds_read_b128 v[144:147], v114 offset:0
    ds_read_b128 v[208:211], v114 offset:2048
    ds_read_b128 v[148:151], v115 offset:0
    ds_read_b128 v[212:215], v115 offset:2048
    s_waitcnt vmcnt(0)
    ds_read_b128 v[152:155], v114 offset:4096
    ds_read_b128 v[216:219], v114 offset:6144
    ds_read_b128 v[156:159], v115 offset:4096
    ds_read_b128 v[220:223], v115 offset:6144
    v_and_b32 v14, 7, v1
    v_lshlrev_b32 v14, 7, v14
    v_add_u32 v14, 2629632, v14
    s_mov_b32 s15, 0
K1X_PL:
    global_load_dword v15, v14, s[42:43] sc1
    s_waitcnt vmcnt(0)
    v_cmp_gt_u32 vcc, 4, v15
    s_add_u32 s15, s15, 1
    s_cbranch_vccz K1X_OK
    s_sleep 4
    s_cmp_lt_u32 s15, 0x20000
    s_cbranch_scc1 K1X_PL
K1X_OK:
PH3X:
    v_and_b32 v2, 15, v1
    v_lshrrev_b32 v3, 4, v1
    s_lshr_b32 s10, s3, 1
    s_and_b32 s11, s3, 1
    v_lshrrev_b32 v9, 3, v1
    v_and_b32 v10, 7, v1
    v_and_b32 v11, 6, v9
    v_xor_b32 v10, v10, v11
    v_lshlrev_b32 v9, 7, v9
    v_lshl_add_u32 v5, v10, 4, v9
    s_mul_i32 s12, s46, 81920
    v_add_u32 v5, s12, v5
    s_lshl_b32 s12, s3, 11
    v_add_u32 v4, s12, v5
    s_mul_i32 s59, s3, 3072
    s_mul_i32 s12, s47, 122880
    s_add_u32 s12, s12, s59
    v_lshl_add_u32 v6, v1, 4, s12
    s_lshl_b32 s14, s3, 11
    s_add_u32 s59, s59, 101888
    s_mov_b32 s48, s42
    s_mov_b32 s49, s43
    s_mov_b32 s50, 2621440
    s_mov_b32 s51, 0x20000
    s_add_u32 s52, s42, 9437184
    s_addc_u32 s53, s43, 0
    s_mov_b32 s54, 1966080
    s_mov_b32 s55, 0x20000
    v_lshrrev_b32 v9, 2, v1
    v_lshrrev_b32 v10, 1, v9
    v_and_b32 v10, 3, v10
    v_and_b32 v11, 3, v2
    v_lshlrev_b32 v11, 3, v11
    s_mov_b32 s63, s11
    s_lshl_b32 s12, s10, 1
    s_add_u32 s12, s12, s63
    v_xor_b32 v12, s12, v10
    v_xor_b32 v13, 1, v12
    v_lshl_add_u32 v19, v9, 7, v11
    v_lshl_add_u32 v12, v12, 5, v19
    v_lshl_add_u32 v13, v13, 5, v19
    v_add_u32 v14, 40960, v12
    v_add_u32 v15, 40960, v13
    s_mul_i32 s12, s11, 3072
    s_add_u32 s12, s12, 101888
    v_lshl_add_u32 v16, v1, 4, s12
    s_lshl_b32 s12, s10, 8
    s_lshl_b32 s13, s63, 7
    s_add_u32 s12, s12, s13
    s_add_u32 s12, s12, 96256
    v_lshl_add_u32 v17, v2, 3, s12
    v_xor_b32 v7, 0x80, v17
    v_mov_b32 v120, 0xc0135761
    v_mov_b32 v121, 0xbdd2d3e8
    s_cmp_lt_u32 s7, 12
    s_cbranch_scc1 K3_NA
    s_lshl_b32 s9, s6, 7
    s_add_u32 s9, s9, 2643968
    s_waitcnt vmcnt(0)
    v_mov_b32 v20, 163792
    v_mov_b32 v21, 1
    s_mov_b64 exec, 1
    ds_add_rtn_u32 v22, v20, v21
    s_mov_b64 exec, 0xff
    v_lshl_add_u32 v20, v1, 10, s9
    s_waitcnt lgkmcnt(0)
    v_readfirstlane_b32 s15, v22
    s_nop 0
    s_cmp_lg_u32 s15, 3
    s_cbranch_scc1 K1A_NL
    global_atomic_add v20, v21, s[42:43] sc1
K1A_NL:
    s_mov_b64 exec, -1
    s_waitcnt lgkmcnt(0)
    s_barrier
K3_NA:
    s_mul_i32 s12, s47, 7680
    s_mul_i32 s13, s11, 3840
    s_add_u32 s12, s12, s13
    s_mul_i32 s13, s10, 61440
    s_add_u32 s12, s12, s13
    s_add_u32 s12, s12, 2949120
    v_mul_u32_u24 v9, 320, v3
    v_lshl_add_u32 v9, v2, 4, v9
    v_add_u32 v9, s12, v9
    v_mov_b32 v72, 0
    v_mov_b32 v73, 0
    v_mov_b32 v74, 0
    v_mov_b32 v75, 0
    v_mov_b32 v76, 0
    v_mov_b32 v77, 0
    v_mov_b32 v78, 0
    v_mov_b32 v79, 0
    v_mov_b32 v80, 0
    v_mov_b32 v81, 0
    v_mov_b32 v82, 0
    v_mov_b32 v83, 0
    global_load_dwordx4 v[60:63], v9, s[42:43] offset:0 sc1
    global_load_dwordx4 v[64:67], v9, s[42:43] offset:1280 sc1
    global_load_dwordx4 v[68:71], v9, s[42:43] offset:2560 sc1
    s_mov_b32 exec_lo, 0x000f000f
    s_mov_b32 exec_hi, 0x000f000f
    global_load_dwordx4 v[72:75], v9, s[42:43] offset:256 sc1
    global_load_dwordx4 v[76:79], v9, s[42:43] offset:1536 sc1
    global_load_dwordx4 v[80:83], v9, s[42:43] offset:2816 sc1
    s_mov_b64 exec, -1
    s_waitcnt vmcnt(0)
    v_add_f32 v60, v60, v72
    v_add_f32 v61, v61, v73
    v_add_f32 v62, v62, v74
    v_add_f32 v63, v63, v75
    v_add_f32 v64, v64, v76
    v_add_f32 v65, v65, v77
    v_add_f32 v66, v66, v78
    v_add_f32 v67, v67, v79
    v_add_f32 v68, v68, v80
    v_add_f32 v69, v69, v81
    v_add_f32 v70, v70, v82
    v_add_f32 v71, v71, v83
    v_add_f32_dpp v60, v60, v60 row_ror:8 row_mask:0xf bank_mask:0xf
    v_add_f32_dpp v61, v61, v61 row_ror:8 row_mask:0xf bank_mask:0xf
    v_add_f32_dpp v62, v62, v62 row_ror:8 row_mask:0xf bank_mask:0xf
    v_add_f32_dpp v63, v63, v63 row_ror:8 row_mask:0xf bank_mask:0xf
    v_add_f32_dpp v64, v64, v64 row_ror:8 row_mask:0xf bank_mask:0xf
    v_add_f32_dpp v65, v65, v65 row_ror:8 row_mask:0xf bank_mask:0xf
    v_add_f32_dpp v66, v66, v66 row_ror:8 row_mask:0xf bank_mask:0xf
    v_add_f32_dpp v67, v67, v67 row_ror:8 row_mask:0xf bank_mask:0xf
    v_add_f32_dpp v68, v68, v68 row_ror:8 row_mask:0xf bank_mask:0xf
    v_add_f32_dpp v69, v69, v69 row_ror:8 row_mask:0xf bank_mask:0xf
    v_add_f32_dpp v70, v70, v70 row_ror:8 row_mask:0xf bank_mask:0xf
    v_add_f32_dpp v71, v71, v71 row_ror:8 row_mask:0xf bank_mask:0xf
    v_add_f32_dpp v60, v60, v60 row_ror:4 row_mask:0xf bank_mask:0xf
    v_add_f32_dpp v61, v61, v61 row_ror:4 row_mask:0xf bank_mask:0xf
    v_add_f32_dpp v62, v62, v62 row_ror:4 row_mask:0xf bank_mask:0xf
    v_add_f32_dpp v63, v63, v63 row_ror:4 row_mask:0xf bank_mask:0xf
    v_add_f32_dpp v64, v64, v64 row_ror:4 row_mask:0xf bank_mask:0xf
    v_add_f32_dpp v65, v65, v65 row_ror:4 row_mask:0xf bank_mask:0xf
    v_add_f32_dpp v66, v66, v66 row_ror:4 row_mask:0xf bank_mask:0xf
    v_add_f32_dpp v67, v67, v67 row_ror:4 row_mask:0xf bank_mask:0xf
    v_add_f32_dpp v68, v68, v68 row_ror:4 row_mask:0xf bank_mask:0xf
    v_add_f32_dpp v69, v69, v69 row_ror:4 row_mask:0xf bank_mask:0xf
    v_add_f32_dpp v70, v70, v70 row_ror:4 row_mask:0xf bank_mask:0xf
    v_add_f32_dpp v71, v71, v71 row_ror:4 row_mask:0xf bank_mask:0xf
    v_add_f32_dpp v60, v60, v60 row_ror:2 row_mask:0xf bank_mask:0xf
    v_add_f32_dpp v61, v61, v61 row_ror:2 row_mask:0xf bank_mask:0xf
    v_add_f32_dpp v62, v62, v62 row_ror:2 row_mask:0xf bank_mask:0xf
    v_add_f32_dpp v63, v63, v63 row_ror:2 row_mask:0xf bank_mask:0xf
    v_add_f32_dpp v64, v64, v64 row_ror:2 row_mask:0xf bank_mask:0xf
    v_add_f32_dpp v65, v65, v65 row_ror:2 row_mask:0xf bank_mask:0xf
    v_add_f32_dpp v66, v66, v66 row_ror:2 row_mask:0xf bank_mask:0xf
    v_add_f32_dpp v67, v67, v67 row_ror:2 row_mask:0xf bank_mask:0xf
    v_add_f32_dpp v68, v68, v68 row_ror:2 row_mask:0xf bank_mask:0xf
    v_add_f32_dpp v69, v69, v69 row_ror:2 row_mask:0xf bank_mask:0xf
    v_add_f32_dpp v70, v70, v70 row_ror:2 row_mask:0xf bank_mask:0xf
    v_add_f32_dpp v71, v71, v71 row_ror:2 row_mask:0xf bank_mask:0xf
    v_add_f32_dpp v60, v60, v60 row_ror:1 row_mask:0xf bank_mask:0xf
    v_add_f32_dpp v61, v61, v61 row_ror:1 row_mask:0xf bank_mask:0xf
    v_add_f32_dpp v62, v62, v62 row_ror:1 row_mask:0xf bank_mask:0xf
    v_add_f32_dpp v63, v63, v63 row_ror:1 row_mask:0xf bank_mask:0xf
    v_add_f32_dpp v64, v64, v64 row_ror:1 row_mask:0xf bank_mask:0xf
    v_add_f32_dpp v65, v65, v65 row_ror:1 row_mask:0xf bank_mask:0xf
    v_add_f32_dpp v66, v66, v66 row_ror:1 row_mask:0xf bank_mask:0xf
    v_add_f32_dpp v67, v67, v67 row_ror:1 row_mask:0xf bank_mask:0xf
    v_add_f32_dpp v68, v68, v68 row_ror:1 row_mask:0xf bank_mask:0xf
    v_add_f32_dpp v69, v69, v69 row_ror:1 row_mask:0xf bank_mask:0xf
    v_add_f32_dpp v70, v70, v70 row_ror:1 row_mask:0xf bank_mask:0xf
    v_add_f32_dpp v71, v71, v71 row_ror:1 row_mask:0xf bank_mask:0xf
    s_lshl_b32 s12, s46, 13
    s_lshl_b32 s13, s10, 8
    s_add_u32 s12, s12, s13
    s_add_u32 s12, s12, 2686976
    s_lshl_b32 s13, s11, 4
    v_and_b32 v19, 31, v1
    v_xor_b32 v19, s13, v19
    v_lshl_add_u32 v19, v19, 3, s12
    s_lshl_b32 s13, s47, 1
    s_add_u32 s13, s13, s11
    s_lshl_b32 s13, s13, 9
    v_add_u32 v18, s13, v19
    v_lshrrev_b32 v10, 5, v1
    v_lshl_add_u32 v19, v10, 12, v19
    v_and_b32 v122, 3, v1
    v_mov_b32 v8, 0x3f803f80
    v_mov_b32 v9, 0x3f803f80
    v_mov_b32 v10, 0x3f803f80
    v_mov_b32 v11, 0x3f803f80
    s_cmp_ge_u32 s7, 12
    s_cbranch_scc1 K3_NB
    s_waitcnt lgkmcnt(0)
    s_barrier
    s_barrier
K3_NB:
    s_lshl_b32 s12, s3, 8
    s_add_u32 s12, s12, 96768
    v_lshl_add_u32 v4, v3, 4, s12
    ds_write_b128 v4, v[60:63] offset:0
    ds_write_b128 v4, v[64:67] offset:64
    ds_write_b128 v4, v[68:71] offset:128
    s_lshl_b32 s12, s11, 8
    s_add_u32 s12, s12, 97280
    v_lshl_add_u32 v4, v3, 4, s12
    s_setprio 2
    s_barrier
    s_barrier
    ds_read_b64_tr_b16 v[60:61], v12 offset:0
    ds_read_b64_tr_b16 v[62:63], v12 offset:2048
    ds_read_b128 v[68:71], v16 offset:24576
    ds_read_b128 v[72:75], v16 offset:25600
    ds_read_b128 v[76:79], v16 offset:26624
    ds_read_b64_tr_b16 v[64:65], v13 offset:0
    ds_read_b64_tr_b16 v[66:67], v13 offset:2048
    ds_read_b64_tr_b16 v[80:81], v12 offset:4096
    ds_read_b64_tr_b16 v[82:83], v12 offset:6144
    ds_read_b128 v[88:91], v16 offset:30720
    ds_read_b128 v[92:95], v16 offset:31744
    ds_read_b128 v[96:99], v16 offset:32768
    ds_read_b64_tr_b16 v[84:85], v13 offset:4096
    ds_read_b64_tr_b16 v[86:87], v13 offset:6144
    s_barrier
    s_waitcnt lgkmcnt(11)
    v_mfma_f32_16x16x32_bf16 v[36:39], v[68:71], v[60:63], 0
    ds_read_b64_tr_b16 v[100:101], v12 offset:8192
    s_waitcnt lgkmcnt(11)
    v_mfma_f32_16x16x32_bf16 v[40:43], v[72:75], v[60:63], 0
    ds_read_b64_tr_b16 v[102:103], v12 offset:10240
    s_waitcnt lgkmcnt(11)
    v_mfma_f32_16x16x32_bf16 v[44:47], v[76:79], v[60:63], 0
    ds_read_b128 v[108:111], v16 offset:36864
    s_waitcnt lgkmcnt(10)
    v_mfma_f32_16x16x32_bf16 v[48:51], v[68:71], v[64:67], 0
    ds_read_b128 v[112:115], v16 offset:37888
    v_mfma_f32_16x16x32_bf16 v[52:55], v[72:75], v[64:67], 0
    ds_read_b128 v[116:119], v16 offset:38912
    v_mfma_f32_16x16x32_bf16 v[56:59], v[76:79], v[64:67], 0
    ds_read_b64_tr_b16 v[104:105], v13 offset:8192
    v_mfma_f32_16x16x32_bf16 v[20:23], v[8:11], v[60:63], 0
    ds_read_b64_tr_b16 v[106:107], v13 offset:10240
    v_mfma_f32_16x16x32_bf16 v[124:127], v[60:63], v[60:63], 0
    s_waitcnt lgkmcnt(7)
    v_mfma_f32_16x16x32_bf16 v[36:39], v[88:91], v[80:83], v[36:39]
    ds_read_b64_tr_b16 v[60:61], v12 offset:12288
    v_mfma_f32_16x16x32_bf16 v[40:43], v[92:95], v[80:83], v[40:43]
    ds_read_b64_tr_b16 v[62:63], v12 offset:14336
    v_mfma_f32_16x16x32_bf16 v[44:47], v[96:99], v[80:83], v[44:47]
    ds_read_b128 v[68:71], v16 offset:43008
    v_mfma_f32_16x16x32_bf16 v[48:51], v[88:91], v[84:87], v[48:51]
    ds_read_b128 v[72:75], v16 offset:44032
    v_mfma_f32_16x16x32_bf16 v[52:55], v[92:95], v[84:87], v[52:55]
    ds_read_b128 v[76:79], v16 offset:45056
    v_mfma_f32_16x16x32_bf16 v[56:59], v[96:99], v[84:87], v[56:59]
    ds_read_b64_tr_b16 v[64:65], v13 offset:12288
    v_mfma_f32_16x16x32_bf16 v[20:23], v[8:11], v[80:83], v[20:23]
    ds_read_b64_tr_b16 v[66:67], v13 offset:14336
    v_mfma_f32_16x16x32_bf16 v[124:127], v[80:83], v[80:83], v[124:127]
    s_barrier
    s_waitcnt lgkmcnt(7)
    v_mfma_f32_16x16x32_bf16 v[36:39], v[108:111], v[100:103], v[36:39]
    ds_read_b64_tr_b16 v[80:81], v12 offset:16384
    v_mfma_f32_16x16x32_bf16 v[40:43], v[112:115], v[100:103], v[40:43]
    ds_read_b64_tr_b16 v[82:83], v12 offset:18432
    v_mfma_f32_16x16x32_bf16 v[44:47], v[116:119], v[100:103], v[44:47]
    ds_read_b128 v[88:91], v16 offset:49152
    v_mfma_f32_16x16x32_bf16 v[48:51], v[108:111], v[104:107], v[48:51]
    ds_read_b128 v[92:95], v16 offset:50176
    v_mfma_f32_16x16x32_bf16 v[52:55], v[112:115], v[104:107], v[52:55]
    ds_read_b128 v[96:99], v16 offset:51200
    v_mfma_f32_16x16x32_bf16 v[56:59], v[116:119], v[104:107], v[56:59]
    ds_read_b64_tr_b16 v[84:85], v13 offset:16384
    v_mfma_f32_16x16x32_bf16 v[20:23], v[8:11], v[100:103], v[20:23]
    ds_read_b64_tr_b16 v[86:87], v13 offset:18432
    v_mfma_f32_16x16x32_bf16 v[124:127], v[100:103], v[100:103], v[124:127]
    s_waitcnt lgkmcnt(7)
    v_mfma_f32_16x16x32_bf16 v[36:39], v[68:71], v[60:63], v[36:39]
    ds_read_b64_tr_b16 v[100:101], v12 offset:20480
    v_mfma_f32_16x16x32_bf16 v[40:43], v[72:75], v[60:63], v[40:43]
    ds_read_b64_tr_b16 v[102:103], v12 offset:22528
    v_mfma_f32_16x16x32_bf16 v[44:47], v[76:79], v[60:63], v[44:47]
    ds_read_b128 v[108:111], v16 offset:55296
    v_mfma_f32_16x16x32_bf16 v[48:51], v[68:71], v[64:67], v[48:51]
    ds_read_b128 v[112:115], v16 offset:56320
    v_mfma_f32_16x16x32_bf16 v[52:55], v[72:75], v[64:67], v[52:55]
    ds_read_b128 v[116:119], v16 offset:57344
    v_mfma_f32_16x16x32_bf16 v[56:59], v[76:79], v[64:67], v[56:59]
    ds_read_b64_tr_b16 v[104:105], v13 offset:20480
    v_mfma_f32_16x16x32_bf16 v[20:23], v[8:11], v[60:63], v[20:23]
    ds_read_b64_tr_b16 v[106:107], v13 offset:22528
    v_mfma_f32_16x16x32_bf16 v[124:127], v[60:63], v[60:63], v[124:127]
    s_barrier
    s_waitcnt lgkmcnt(7)
    v_mfma_f32_16x16x32_bf16 v[36:39], v[88:91], v[80:83], v[36:39]
    ds_read_b64_tr_b16 v[60:61], v12 offset:24576
    v_mfma_f32_16x16x32_bf16 v[40:43], v[92:95], v[80:83], v[40:43]
    ds_read_b64_tr_b16 v[62:63], v12 offset:26624
    v_mfma_f32_16x16x32_bf16 v[44:47], v[96:99], v[80:83], v[44:47]
    ds_read_b128 v[68:71], v16 offset:0
    v_mfma_f32_16x16x32_bf16 v[48:51], v[88:91], v[84:87], v[48:51]
    ds_read_b128 v[72:75], v16 offset:1024
    v_mfma_f32_16x16x32_bf16 v[52:55], v[92:95], v[84:87], v[52:55]
    ds_read_b128 v[76:79], v16 offset:2048
    v_mfma_f32_16x16x32_bf16 v[56:59], v[96:99], v[84:87], v[56:59]
    ds_read_b64_tr_b16 v[64:65], v13 offset:24576
    v_mfma_f32_16x16x32_bf16 v[20:23], v[8:11], v[80:83], v[20:23]
    ds_read_b64_tr_b16 v[66:67], v13 offset:26624
    v_mfma_f32_16x16x32_bf16 v[124:127], v[80:83], v[80:83], v[124:127]
    s_waitcnt lgkmcnt(7)
    v_mfma_f32_16x16x32_bf16 v[36:39], v[108:111], v[100:103], v[36:39]
    ds_read_b64_tr_b16 v[80:81], v12 offset:28672
    v_mfma_f32_16x16x32_bf16 v[40:43], v[112:115], v[100:103], v[40:43]
    ds_read_b64_tr_b16 v[82:83], v12 offset:30720
    v_mfma_f32_16x16x32_bf16 v[44:47], v[116:119], v[100:103], v[44:47]
    ds_read_b128 v[88:91], v16 offset:6144
    v_mfma_f32_16x16x32_bf16 v[48:51], v[108:111], v[104:107], v[48:51]
    ds_read_b128 v[92:95], v16 offset:7168
    v_mfma_f32_16x16x32_bf16 v[52:55], v[112:115], v[104:107], v[52:55]
    ds_read_b128 v[96:99], v16 offset:8192
    v_mfma_f32_16x16x32_bf16 v[56:59], v[116:119], v[104:107], v[56:59]
    ds_read_b64_tr_b16 v[84:85], v13 offset:28672
    v_mfma_f32_16x16x32_bf16 v[20:23], v[8:11], v[100:103], v[20:23]
    ds_read_b64_tr_b16 v[86:87], v13 offset:30720
    v_mfma_f32_16x16x32_bf16 v[124:127], v[100:103], v[100:103], v[124:127]
    s_barrier
    s_waitcnt lgkmcnt(7)
    v_mfma_f32_16x16x32_bf16 v[36:39], v[68:71], v[60:63], v[36:39]
    ds_read_b64_tr_b16 v[100:101], v12 offset:32768
    v_mfma_f32_16x16x32_bf16 v[40:43], v[72:75], v[60:63], v[40:43]
    ds_read_b64_tr_b16 v[102:103], v12 offset:34816
    v_mfma_f32_16x16x32_bf16 v[44:47], v[76:79], v[60:63], v[44:47]
    ds_read_b128 v[108:111], v16 offset:12288
    v_mfma_f32_16x16x32_bf16 v[48:51], v[68:71], v[64:67], v[48:51]
    ds_read_b128 v[112:115], v16 offset:13312
    v_mfma_f32_16x16x32_bf16 v[52:55], v[72:75], v[64:67], v[52:55]
    ds_read_b128 v[116:119], v16 offset:14336
    v_mfma_f32_16x16x32_bf16 v[56:59], v[76:79], v[64:67], v[56:59]
    ds_read_b64_tr_b16 v[104:105], v13 offset:32768
    v_mfma_f32_16x16x32_bf16 v[20:23], v[8:11], v[60:63], v[20:23]
    ds_read_b64_tr_b16 v[106:107], v13 offset:34816
    v_mfma_f32_16x16x32_bf16 v[124:127], v[60:63], v[60:63], v[124:127]
    s_waitcnt lgkmcnt(7)
    v_mfma_f32_16x16x32_bf16 v[36:39], v[88:91], v[80:83], v[36:39]
    ds_read_b64_tr_b16 v[60:61], v12 offset:36864
    v_mfma_f32_16x16x32_bf16 v[40:43], v[92:95], v[80:83], v[40:43]
    ds_read_b64_tr_b16 v[62:63], v12 offset:38912
    v_mfma_f32_16x16x32_bf16 v[44:47], v[96:99], v[80:83], v[44:47]
    ds_read_b128 v[68:71], v16 offset:18432
    v_mfma_f32_16x16x32_bf16 v[48:51], v[88:91], v[84:87], v[48:51]
    ds_read_b128 v[72:75], v16 offset:19456
    v_mfma_f32_16x16x32_bf16 v[52:55], v[92:95], v[84:87], v[52:55]
    ds_read_b128 v[76:79], v16 offset:20480
    v_mfma_f32_16x16x32_bf16 v[56:59], v[96:99], v[84:87], v[56:59]
    ds_read_b64_tr_b16 v[64:65], v13 offset:36864
    v_mfma_f32_16x16x32_bf16 v[20:23], v[8:11], v[80:83], v[20:23]
    ds_read_b64_tr_b16 v[66:67], v13 offset:38912
    v_mfma_f32_16x16x32_bf16 v[124:127], v[80:83], v[80:83], v[124:127]
    s_barrier
    s_waitcnt lgkmcnt(7)
    v_mfma_f32_16x16x32_bf16 v[36:39], v[108:111], v[100:103], v[36:39]
    ds_read_b64_tr_b16 v[80:81], v14 offset:0
    v_mfma_f32_16x16x32_bf16 v[40:43], v[112:115], v[100:103], v[40:43]
    ds_read_b64_tr_b16 v[82:83], v14 offset:2048
    v_mfma_f32_16x16x32_bf16 v[44:47], v[116:119], v[100:103], v[44:47]
    ds_read_b128 v[88:91], v16 offset:24576
    v_mfma_f32_16x16x32_bf16 v[48:51], v[108:111], v[104:107], v[48:51]
    ds_read_b128 v[92:95], v16 offset:25600
    v_mfma_f32_16x16x32_bf16 v[52:55], v[112:115], v[104:107], v[52:55]
    ds_read_b128 v[96:99], v16 offset:26624
    v_mfma_f32_16x16x32_bf16 v[56:59], v[116:119], v[104:107], v[56:59]
    ds_read_b64_tr_b16 v[84:85], v15 offset:0
    v_mfma_f32_16x16x32_bf16 v[20:23], v[8:11], v[100:103], v[20:23]
    ds_read_b64_tr_b16 v[86:87], v15 offset:2048
    v_mfma_f32_16x16x32_bf16 v[124:127], v[100:103], v[100:103], v[124:127]
    s_waitcnt lgkmcnt(7)
    v_mfma_f32_16x16x32_bf16 v[36:39], v[68:71], v[60:63], v[36:39]
    ds_read_b64_tr_b16 v[100:101], v14 offset:4096
    v_mfma_f32_16x16x32_bf16 v[40:43], v[72:75], v[60:63], v[40:43]
    ds_read_b64_tr_b16 v[102:103], v14 offset:6144
    v_mfma_f32_16x16x32_bf16 v[44:47], v[76:79], v[60:63], v[44:47]
    ds_read_b128 v[108:111], v16 offset:30720
    v_mfma_f32_16x16x32_bf16 v[48:51], v[68:71], v[64:67], v[48:51]
    ds_read_b128 v[112:115], v16 offset:31744
    v_mfma_f32_16x16x32_bf16 v[52:55], v[72:75], v[64:67], v[52:55]
    ds_read_b128 v[116:119], v16 offset:32768
    v_mfma_f32_16x16x32_bf16 v[56:59], v[76:79], v[64:67], v[56:59]
    ds_read_b64_tr_b16 v[104:105], v15 offset:4096
    v_mfma_f32_16x16x32_bf16 v[20:23], v[8:11], v[60:63], v[20:23]
    ds_read_b64_tr_b16 v[106:107], v15 offset:6144
    v_mfma_f32_16x16x32_bf16 v[124:127], v[60:63], v[60:63], v[124:127]
    s_barrier
    s_waitcnt lgkmcnt(7)
    v_mfma_f32_16x16x32_bf16 v[36:39], v[88:91], v[80:83], v[36:39]
    ds_read_b64_tr_b16 v[60:61], v14 offset:8192
    v_mfma_f32_16x16x32_bf16 v[40:43], v[92:95], v[80:83], v[40:43]
    ds_read_b64_tr_b16 v[62:63], v14 offset:10240
    v_mfma_f32_16x16x32_bf16 v[44:47], v[96:99], v[80:83], v[44:47]
    ds_read_b128 v[68:71], v16 offset:36864
    v_mfma_f32_16x16x32_bf16 v[48:51], v[88:91], v[84:87], v[48:51]
    ds_read_b128 v[72:75], v16 offset:37888
    v_mfma_f32_16x16x32_bf16 v[52:55], v[92:95], v[84:87], v[52:55]
    ds_read_b128 v[76:79], v16 offset:38912
    v_mfma_f32_16x16x32_bf16 v[56:59], v[96:99], v[84:87], v[56:59]
    ds_read_b64_tr_b16 v[64:65], v15 offset:8192
    v_mfma_f32_16x16x32_bf16 v[20:23], v[8:11], v[80:83], v[20:23]
    ds_read_b64_tr_b16 v[66:67], v15 offset:10240
    v_mfma_f32_16x16x32_bf16 v[124:127], v[80:83], v[80:83], v[124:127]
    s_waitcnt lgkmcnt(7)
    v_mfma_f32_16x16x32_bf16 v[36:39], v[108:111], v[100:103], v[36:39]
    ds_read_b64_tr_b16 v[80:81], v14 offset:12288
    v_mfma_f32_16x16x32_bf16 v[40:43], v[112:115], v[100:103], v[40:43]
    ds_read_b64_tr_b16 v[82:83], v14 offset:14336
    v_mfma_f32_16x16x32_bf16 v[44:47], v[116:119], v[100:103], v[44:47]
    ds_read_b128 v[88:91], v16 offset:43008
    v_mfma_f32_16x16x32_bf16 v[48:51], v[108:111], v[104:107], v[48:51]
    ds_read_b128 v[92:95], v16 offset:44032
    v_mfma_f32_16x16x32_bf16 v[52:55], v[112:115], v[104:107], v[52:55]
    ds_read_b128 v[96:99], v16 offset:45056
    v_mfma_f32_16x16x32_bf16 v[56:59], v[116:119], v[104:107], v[56:59]
    ds_read_b64_tr_b16 v[84:85], v15 offset:12288
    v_mfma_f32_16x16x32_bf16 v[20:23], v[8:11], v[100:103], v[20:23]
    ds_read_b64_tr_b16 v[86:87], v15 offset:14336
    v_mfma_f32_16x16x32_bf16 v[124:127], v[100:103], v[100:103], v[124:127]
    s_barrier
    s_waitcnt lgkmcnt(7)
    v_mfma_f32_16x16x32_bf16 v[36:39], v[68:71], v[60:63], v[36:39]
    ds_read_b64_tr_b16 v[100:101], v14 offset:16384
    v_mfma_f32_16x16x32_bf16 v[40:43], v[72:75], v[60:63], v[40:43]
    ds_read_b64_tr_b16 v[102:103], v14 offset:18432
    v_mfma_f32_16x16x32_bf16 v[44:47], v[76:79], v[60:63], v[44:47]
    ds_read_b128 v[108:111], v16 offset:49152
    v_mfma_f32_16x16x32_bf16 v[48:51], v[68:71], v[64:67], v[48:51]
    ds_read_b128 v[112:115], v16 offset:50176
    v_mfma_f32_16x16x32_bf16 v[52:55], v[72:75], v[64:67], v[52:55]
    ds_read_b128 v[116:119], v16 offset:51200
    v_mfma_f32_16x16x32_bf16 v[56:59], v[76:79], v[64:67], v[56:59]
    ds_read_b64_tr_b16 v[104:105], v15 offset:16384
    v_mfma_f32_16x16x32_bf16 v[20:23], v[8:11], v[60:63], v[20:23]
    ds_read_b64_tr_b16 v[106:107], v15 offset:18432
    v_mfma_f32_16x16x32_bf16 v[124:127], v[60:63], v[60:63], v[124:127]
    s_waitcnt lgkmcnt(7)
    v_mfma_f32_16x16x32_bf16 v[36:39], v[88:91], v[80:83], v[36:39]
    ds_read_b64_tr_b16 v[60:61], v14 offset:20480
    v_mfma_f32_16x16x32_bf16 v[40:43], v[92:95], v[80:83], v[40:43]
    ds_read_b64_tr_b16 v[62:63], v14 offset:22528
    v_mfma_f32_16x16x32_bf16 v[44:47], v[96:99], v[80:83], v[44:47]
    ds_read_b128 v[68:71], v16 offset:55296
    v_mfma_f32_16x16x32_bf16 v[48:51], v[88:91], v[84:87], v[48:51]
    ds_read_b128 v[72:75], v16 offset:56320
    v_mfma_f32_16x16x32_bf16 v[52:55], v[92:95], v[84:87], v[52:55]
    ds_read_b128 v[76:79], v16 offset:57344
    v_mfma_f32_16x16x32_bf16 v[56:59], v[96:99], v[84:87], v[56:59]
    ds_read_b64_tr_b16 v[64:65], v15 offset:20480
    v_mfma_f32_16x16x32_bf16 v[20:23], v[8:11], v[80:83], v[20:23]
    ds_read_b64_tr_b16 v[66:67], v15 offset:22528
    v_mfma_f32_16x16x32_bf16 v[124:127], v[80:83], v[80:83], v[124:127]
    s_barrier
    s_waitcnt lgkmcnt(7)
    v_mfma_f32_16x16x32_bf16 v[36:39], v[108:111], v[100:103], v[36:39]
    ds_read_b64_tr_b16 v[80:81], v14 offset:24576
    v_mfma_f32_16x16x32_bf16 v[40:43], v[112:115], v[100:103], v[40:43]
    ds_read_b64_tr_b16 v[82:83], v14 offset:26624
    v_mfma_f32_16x16x32_bf16 v[44:47], v[116:119], v[100:103], v[44:47]
    ds_read_b128 v[88:91], v16 offset:0
    v_mfma_f32_16x16x32_bf16 v[48:51], v[108:111], v[104:107], v[48:51]
    ds_read_b128 v[92:95], v16 offset:1024
    v_mfma_f32_16x16x32_bf16 v[52:55], v[112:115], v[104:107], v[52:55]
    ds_read_b128 v[96:99], v16 offset:2048
    v_mfma_f32_16x16x32_bf16 v[56:59], v[116:119], v[104:107], v[56:59]
    ds_read_b64_tr_b16 v[84:85], v15 offset:24576
    v_mfma_f32_16x16x32_bf16 v[20:23], v[8:11], v[100:103], v[20:23]
    ds_read_b64_tr_b16 v[86:87], v15 offset:26624
    v_mfma_f32_16x16x32_bf16 v[124:127], v[100:103], v[100:103], v[124:127]
    s_waitcnt lgkmcnt(7)
    v_mfma_f32_16x16x32_bf16 v[36:39], v[68:71], v[60:63], v[36:39]
    ds_read_b64_tr_b16 v[100:101], v14 offset:28672
    v_mfma_f32_16x16x32_bf16 v[40:43], v[72:75], v[60:63], v[40:43]
    ds_read_b64_tr_b16 v[102:103], v14 offset:30720
    v_mfma_f32_16x16x32_bf16 v[44:47], v[76:79], v[60:63], v[44:47]
    ds_read_b128 v[108:111], v16 offset:6144
    v_mfma_f32_16x16x32_bf16 v[48:51], v[68:71], v[64:67], v[48:51]
    ds_read_b128 v[112:115], v16 offset:7168
    v_mfma_f32_16x16x32_bf16 v[52:55], v[72:75], v[64:67], v[52:55]
    ds_read_b128 v[116:119], v16 offset:8192
    v_mfma_f32_16x16x32_bf16 v[56:59], v[76:79], v[64:67], v[56:59]
    ds_read_b64_tr_b16 v[104:105], v15 offset:28672
    v_mfma_f32_16x16x32_bf16 v[20:23], v[8:11], v[60:63], v[20:23]
    ds_read_b64_tr_b16 v[106:107], v15 offset:30720
    v_mfma_f32_16x16x32_bf16 v[124:127], v[60:63], v[60:63], v[124:127]
    s_barrier
    s_waitcnt lgkmcnt(7)
    v_mfma_f32_16x16x32_bf16 v[36:39], v[88:91], v[80:83], v[36:39]
    ds_read_b64_tr_b16 v[60:61], v14 offset:32768
    v_mfma_f32_16x16x32_bf16 v[40:43], v[92:95], v[80:83], v[40:43]
    ds_read_b64_tr_b16 v[62:63], v14 offset:34816
    v_mfma_f32_16x16x32_bf16 v[44:47], v[96:99], v[80:83], v[44:47]
    ds_read_b128 v[68:71], v16 offset:12288
    v_mfma_f32_16x16x32_bf16 v[48:51], v[88:91], v[84:87], v[48:51]
    ds_read_b128 v[72:75], v16 offset:13312
    v_mfma_f32_16x16x32_bf16 v[52:55], v[92:95], v[84:87], v[52:55]
    ds_read_b128 v[76:79], v16 offset:14336
    v_mfma_f32_16x16x32_bf16 v[56:59], v[96:99], v[84:87], v[56:59]
    ds_read_b64_tr_b16 v[64:65], v15 offset:32768
    v_mfma_f32_16x16x32_bf16 v[20:23], v[8:11], v[80:83], v[20:23]
    ds_read_b64_tr_b16 v[66:67], v15 offset:34816
    v_mfma_f32_16x16x32_bf16 v[124:127], v[80:83], v[80:83], v[124:127]
    s_waitcnt lgkmcnt(7)
    v_mfma_f32_16x16x32_bf16 v[36:39], v[108:111], v[100:103], v[36:39]
    ds_read_b64_tr_b16 v[80:81], v14 offset:36864
    v_mfma_f32_16x16x32_bf16 v[40:43], v[112:115], v[100:103], v[40:43]
    ds_read_b64_tr_b16 v[82:83], v14 offset:38912
    v_mfma_f32_16x16x32_bf16 v[44:47], v[116:119], v[100:103], v[44:47]
    ds_read_b128 v[88:91], v16 offset:18432
    v_mfma_f32_16x16x32_bf16 v[48:51], v[108:111], v[104:107], v[48:51]
    ds_read_b128 v[92:95], v16 offset:19456
    v_mfma_f32_16x16x32_bf16 v[52:55], v[112:115], v[104:107], v[52:55]
    ds_read_b128 v[96:99], v16 offset:20480
    v_mfma_f32_16x16x32_bf16 v[56:59], v[116:119], v[104:107], v[56:59]
    ds_read_b64_tr_b16 v[84:85], v15 offset:36864
    v_mfma_f32_16x16x32_bf16 v[20:23], v[8:11], v[100:103], v[20:23]
    ds_read_b64_tr_b16 v[86:87], v15 offset:38912
    v_mfma_f32_16x16x32_bf16 v[124:127], v[100:103], v[100:103], v[124:127]
    s_waitcnt lgkmcnt(7)
    v_mfma_f32_16x16x32_bf16 v[36:39], v[68:71], v[60:63], v[36:39]
    v_mfma_f32_16x16x32_bf16 v[40:43], v[72:75], v[60:63], v[40:43]
    v_mfma_f32_16x16x32_bf16 v[44:47], v[76:79], v[60:63], v[44:47]
    v_mfma_f32_16x16x32_bf16 v[48:51], v[68:71], v[64:67], v[48:51]
    v_mfma_f32_16x16x32_bf16 v[52:55], v[72:75], v[64:67], v[52:55]
    v_mfma_f32_16x16x32_bf16 v[56:59], v[76:79], v[64:67], v[56:59]
    v_mfma_f32_16x16x32_bf16 v[20:23], v[8:11], v[60:63], v[20:23]
    v_mfma_f32_16x16x32_bf16 v[124:127], v[60:63], v[60:63], v[124:127]
    s_waitcnt lgkmcnt(0)
    v_mfma_f32_16x16x32_bf16 v[36:39], v[88:91], v[80:83], v[36:39]
    v_mfma_f32_16x16x32_bf16 v[40:43], v[92:95], v[80:83], v[40:43]
    v_mfma_f32_16x16x32_bf16 v[44:47], v[96:99], v[80:83], v[44:47]
    v_mfma_f32_16x16x32_bf16 v[48:51], v[88:91], v[84:87], v[48:51]
    v_mfma_f32_16x16x32_bf16 v[52:55], v[92:95], v[84:87], v[52:55]
    v_mfma_f32_16x16x32_bf16 v[56:59], v[96:99], v[84:87], v[56:59]
    v_mfma_f32_16x16x32_bf16 v[20:23], v[8:11], v[80:83], v[20:23]
    v_mfma_f32_16x16x32_bf16 v[124:127], v[80:83], v[80:83], v[124:127]
    ds_read_b128 v[24:27], v4 offset:0
    ds_read_b128 v[28:31], v4 offset:64
    ds_read_b128 v[32:35], v4 offset:128
    v_cmp_eq_u32 vcc, 1, v122
    s_nop 3
    v_cndmask_b32 v21, v124, v125, vcc
    v_cmp_eq_u32 vcc, 2, v122
    s_nop 1
    v_cndmask_b32 v21, v21, v126, vcc
    v_cmp_eq_u32 vcc, 3, v122
    s_nop 1
    v_cndmask_b32 v21, v21, v127, vcc
    v_mul_f32 v20, 0x3acccccd, v20
    v_mul_f32 v100, v20, v20
    v_mul_f32 v21, 0x3acccccd, v21
    v_sub_f32 v21, v21, v100
    v_max_f32 v21, 0, v21
    v_cvt_pk_bf16_f32 v21, 0, v21
    v_add_f32 v21, 0x3727c5ac, v21
    v_cvt_pk_bf16_f32 v21, 0, v21
    v_sqrt_f32 v21, v21
    v_cvt_pk_bf16_f32 v20, 0, v20
    v_cvt_pk_bf16_f32 v21, 0, v21
    v_rcp_f32 v21, v21
    s_mov_b32 exec_lo, 0x00f0000f
    s_mov_b32 exec_hi, 0xf0000f00
    ds_write_b64 v17, v[20:21]
    s_mov_b64 exec, -1
    s_waitcnt lgkmcnt(0)
    s_barrier
    ds_read_b64 v[122:123], v17
    ds_read_b64 v[124:125], v7
    s_waitcnt lgkmcnt(0)
    v_fma_f32 v36, -v24, v122, v36
    v_fma_f32 v37, -v25, v122, v37
    v_fma_f32 v38, -v26, v122, v38
    v_fma_f32 v39, -v27, v122, v39
    v_mul_f32 v36, v36, v123
    v_mul_f32 v37, v37, v123
    v_mul_f32 v38, v38, v123
    v_mul_f32 v39, v39, v123
    v_mul_f32 v100, v36, v36
    v_mul_f32 v101, v37, v37
    v_mul_f32 v102, v38, v38
    v_mul_f32 v103, v39, v39
    v_fma_f32 v100, v100, v121, v120
    v_fma_f32 v101, v101, v121, v120
    v_fma_f32 v102, v102, v121, v120
    v_fma_f32 v103, v103, v121, v120
    v_mul_f32 v100, v100, v36
    v_mul_f32 v101, v101, v37
    v_mul_f32 v102, v102, v38
    v_mul_f32 v103, v103, v39
    v_exp_f32 v100, v100
    v_exp_f32 v101, v101
    v_exp_f32 v102, v102
    v_exp_f32 v103, v103
    v_add_f32 v100, 1.0, v100
    v_add_f32 v101, 1.0, v101
    v_add_f32 v102, 1.0, v102
    v_add_f32 v103, 1.0, v103
    v_rcp_f32 v100, v100
    v_rcp_f32 v101, v101
    v_rcp_f32 v102, v102
    v_rcp_f32 v103, v103
    v_mul_f32 v36, v36, v100
    v_mul_f32 v37, v37, v101
    v_mul_f32 v38, v38, v102
    v_mul_f32 v39, v39, v103
    v_mov_b32 v104, v36
    v_mul_f32 v106, v36, v36
    v_mov_b32 v105, v37
    v_mul_f32 v107, v37, v37
    v_add_f32 v104, v104, v38
    v_fmac_f32 v106, v38, v38
    v_add_f32 v105, v105, v39
    v_fmac_f32 v107, v39, v39
    v_fma_f32 v40, -v28, v122, v40
    v_fma_f32 v41, -v29, v122, v41
    v_fma_f32 v42, -v30, v122, v42
    v_fma_f32 v43, -v31, v122, v43
    v_mul_f32 v40, v40, v123
    v_mul_f32 v41, v41, v123
    v_mul_f32 v42, v42, v123
    v_mul_f32 v43, v43, v123
    v_mul_f32 v100, v40, v40
    v_mul_f32 v101, v41, v41
    v_mul_f32 v102, v42, v42
    v_mul_f32 v103, v43, v43
    v_fma_f32 v100, v100, v121, v120
    v_fma_f32 v101, v101, v121, v120
    v_fma_f32 v102, v102, v121, v120
    v_fma_f32 v103, v103, v121, v120
    v_mul_f32 v100, v100, v40
    v_mul_f32 v101, v101, v41
    v_mul_f32 v102, v102, v42
    v_mul_f32 v103, v103, v43
    v_exp_f32 v100, v100
    v_exp_f32 v101, v101
    v_exp_f32 v102, v102
    v_exp_f32 v103, v103
    v_add_f32 v100, 1.0, v100
    v_add_f32 v101, 1.0, v101
    v_add_f32 v102, 1.0, v102
    v_add_f32 v103, 1.0, v103
    v_rcp_f32 v100, v100
    v_rcp_f32 v101, v101
    v_rcp_f32 v102, v102
    v_rcp_f32 v103, v103
    v_mul_f32 v40, v40, v100
    v_mul_f32 v41, v41, v101
    v_mul_f32 v42, v42, v102
    v_mul_f32 v43, v43, v103
    v_add_f32 v104, v104, v40
    v_fmac_f32 v106, v40, v40
    v_add_f32 v105, v105, v41
    v_fmac_f32 v107, v41, v41
    v_add_f32 v104, v104, v42
    v_fmac_f32 v106, v42, v42
    v_add_f32 v105, v105, v43
    v_fmac_f32 v107, v43, v43
    v_fma_f32 v44, -v32, v122, v44
    v_fma_f32 v45, -v33, v122, v45
    v_fma_f32 v46, -v34, v122, v46
    v_fma_f32 v47, -v35, v122, v47
    v_mul_f32 v44, v44, v123
    v_mul_f32 v45, v45, v123
    v_mul_f32 v46, v46, v123
    v_mul_f32 v47, v47, v123
    v_mul_f32 v100, v44, v44
    v_mul_f32 v101, v45, v45
    v_mul_f32 v102, v46, v46
    v_mul_f32 v103, v47, v47
    v_fma_f32 v100, v100, v121, v120
    v_fma_f32 v101, v101, v121, v120
    v_fma_f32 v102, v102, v121, v120
    v_fma_f32 v103, v103, v121, v120
    v_mul_f32 v100, v100, v44
    v_mul_f32 v101, v101, v45
    v_mul_f32 v102, v102, v46
    v_mul_f32 v103, v103, v47
    v_exp_f32 v100, v100
    v_exp_f32 v101, v101
    v_exp_f32 v102, v102
    v_exp_f32 v103, v103
    v_add_f32 v100, 1.0, v100
    v_add_f32 v101, 1.0, v101
    v_add_f32 v102, 1.0, v102
    v_add_f32 v103, 1.0, v103
    v_rcp_f32 v100, v100
    v_rcp_f32 v101, v101
    v_rcp_f32 v102, v102
    v_rcp_f32 v103, v103
    v_mul_f32 v44, v44, v100
    v_mul_f32 v45, v45, v101
    v_mul_f32 v46, v46, v102
    v_mul_f32 v47, v47, v103
    v_add_f32 v104, v104, v44
    v_fmac_f32 v106, v44, v44
    v_add_f32 v105, v105, v45
    v_fmac_f32 v107, v45, v45
    v_add_f32 v104, v104, v46
    v_fmac_f32 v106, v46, v46
    v_add_f32 v105, v105, v47
    v_fmac_f32 v107, v47, v47
    v_fma_f32 v48, -v24, v124, v48
    v_fma_f32 v49, -v25, v124, v49
    v_fma_f32 v50, -v26, v124, v50
    v_fma_f32 v51, -v27, v124, v51
    v_mul_f32 v48, v48, v125
    v_mul_f32 v49, v49, v125
    v_mul_f32 v50, v50, v125
    v_mul_f32 v51, v51, v125
    v_mul_f32 v100, v48, v48
    v_mul_f32 v101, v49, v49
    v_mul_f32 v102, v50, v50
    v_mul_f32 v103, v51, v51
    v_fma_f32 v100, v100, v121, v120
    v_fma_f32 v101, v101, v121, v120
    v_fma_f32 v102, v102, v121, v120
    v_fma_f32 v103, v103, v121, v120
    v_mul_f32 v100, v100, v48
    v_mul_f32 v101, v101, v49
    v_mul_f32 v102, v102, v50
    v_mul_f32 v103, v103, v51
    v_exp_f32 v100, v100
    v_exp_f32 v101, v101
    v_exp_f32 v102, v102
    v_exp_f32 v103, v103
    v_add_f32 v100, 1.0, v100
    v_add_f32 v101, 1.0, v101
    v_add_f32 v102, 1.0, v102
    v_add_f32 v103, 1.0, v103
    v_rcp_f32 v100, v100
    v_rcp_f32 v101, v101
    v_rcp_f32 v102, v102
    v_rcp_f32 v103, v103
    v_mul_f32 v48, v48, v100
    v_mul_f32 v49, v49, v101
    v_mul_f32 v50, v50, v102
    v_mul_f32 v51, v51, v103
    v_mov_b32 v108, v48
    v_mul_f32 v110, v48, v48
    v_mov_b32 v109, v49
    v_mul_f32 v111, v49, v49
    v_add_f32 v108, v108, v50
    v_fmac_f32 v110, v50, v50
    v_add_f32 v109, v109, v51
    v_fmac_f32 v111, v51, v51
    v_fma_f32 v52, -v28, v124, v52
    v_fma_f32 v53, -v29, v124, v53
    v_fma_f32 v54, -v30, v124, v54
    v_fma_f32 v55, -v31, v124, v55
    v_mul_f32 v52, v52, v125
    v_mul_f32 v53, v53, v125
    v_mul_f32 v54, v54, v125
    v_mul_f32 v55, v55, v125
    v_mul_f32 v100, v52, v52
    v_mul_f32 v101, v53, v53
    v_mul_f32 v102, v54, v54
    v_mul_f32 v103, v55, v55
    v_fma_f32 v100, v100, v121, v120
    v_fma_f32 v101, v101, v121, v120
    v_fma_f32 v102, v102, v121, v120
    v_fma_f32 v103, v103, v121, v120
    v_mul_f32 v100, v100, v52
    v_mul_f32 v101, v101, v53
    v_mul_f32 v102, v102, v54
    v_mul_f32 v103, v103, v55
    v_exp_f32 v100, v100
    v_exp_f32 v101, v101
    v_exp_f32 v102, v102
    v_exp_f32 v103, v103
    v_add_f32 v100, 1.0, v100
    v_add_f32 v101, 1.0, v101
    v_add_f32 v102, 1.0, v102
    v_add_f32 v103, 1.0, v103
    v_rcp_f32 v100, v100
    v_rcp_f32 v101, v101
    v_rcp_f32 v102, v102
    v_rcp_f32 v103, v103
    v_mul_f32 v52, v52, v100
    v_mul_f32 v53, v53, v101
    v_mul_f32 v54, v54, v102
    v_mul_f32 v55, v55, v103
    v_add_f32 v108, v108, v52
    v_fmac_f32 v110, v52, v52
    v_add_f32 v109, v109, v53
    v_fmac_f32 v111, v53, v53
    v_add_f32 v108, v108, v54
    v_fmac_f32 v110, v54, v54
    v_add_f32 v109, v109, v55
    v_fmac_f32 v111, v55, v55
    v_fma_f32 v56, -v32, v124, v56
    v_fma_f32 v57, -v33, v124, v57
    v_fma_f32 v58, -v34, v124, v58
    v_fma_f32 v59, -v35, v124, v59
    v_mul_f32 v56, v56, v125
    v_mul_f32 v57, v57, v125
    v_mul_f32 v58, v58, v125
    v_mul_f32 v59, v59, v125
    v_mul_f32 v100, v56, v56
    v_mul_f32 v101, v57, v57
    v_mul_f32 v102, v58, v58
    v_mul_f32 v103, v59, v59
    v_fma_f32 v100, v100, v121, v120
    v_fma_f32 v101, v101, v121, v120
    v_fma_f32 v102, v102, v121, v120
    v_fma_f32 v103, v103, v121, v120
    v_mul_f32 v100, v100, v56
    v_mul_f32 v101, v101, v57
    v_mul_f32 v102, v102, v58
    v_mul_f32 v103, v103, v59
    v_exp_f32 v100, v100
    v_exp_f32 v101, v101
    v_exp_f32 v102, v102
    v_exp_f32 v103, v103
    v_add_f32 v100, 1.0, v100
    v_add_f32 v101, 1.0, v101
    v_add_f32 v102, 1.0, v102
    v_add_f32 v103, 1.0, v103
    v_rcp_f32 v100, v100
    v_rcp_f32 v101, v101
    v_rcp_f32 v102, v102
    v_rcp_f32 v103, v103
    v_mul_f32 v56, v56, v100
    v_mul_f32 v57, v57, v101
    v_mul_f32 v58, v58, v102
    v_mul_f32 v59, v59, v103
    v_add_f32 v108, v108, v56
    v_fmac_f32 v110, v56, v56
    v_add_f32 v109, v109, v57
    v_fmac_f32 v111, v57, v57
    v_add_f32 v108, v108, v58
    v_fmac_f32 v110, v58, v58
    v_add_f32 v109, v109, v59
    v_fmac_f32 v111, v59, v59
    v_add_f32 v20, v104, v105
    v_add_f32 v21, v106, v107
    v_add_f32 v22, v108, v109
    v_add_f32 v23, v110, v111
    s_nop 0
    v_permlane16_swap_b32 v20, v22
    v_permlane16_swap_b32 v21, v23
    v_add_f32 v20, v20, v22
    v_add_f32 v21, v21, v23
    v_mov_b32 v22, v20
    v_mov_b32 v23, v21
    s_nop 0
    v_permlane32_swap_b32 v20, v22
    v_permlane32_swap_b32 v21, v23
    v_add_f32 v20, v20, v22
    v_add_f32 v21, v21, v23
    v_max_f32 v21, 0, v21
    s_mov_b32 exec_hi, 0
    global_store_dwordx2 v18, v[20:21], s[42:43] sc1
    s_mov_b32 exec_hi, -1
    s_mul_i32 s12, s47, 10240
    v_add_u32 v9, s12, v12
    ds_read_b64_tr_b16 v[22:23], v9 offset:0
    ds_read_b64_tr_b16 v[24:25], v9 offset:2048
    ds_read_b64_tr_b16 v[26:27], v9 offset:4096
    ds_read_b64_tr_b16 v[28:29], v9 offset:6144
    ds_read_b64_tr_b16 v[30:31], v9 offset:8192
    s_mul_i32 s12, s3, 3584
    s_add_u32 s12, s12, 81920
    v_mul_u32_u24 v11, 112, v2
    v_lshl_add_u32 v11, v3, 3, v11
    v_add_u32 v11, s12, v11
    s_lshl_b32 s13, s11, 1
    v_xor_b32 v13, s13, v3
    v_lshrrev_b32 v12, 2, v2
    v_lshl_add_u32 v12, v13, 3, v12
    v_mul_u32_u24 v12, 112, v12
    v_and_b32 v13, 3, v2
    v_lshl_add_u32 v12, v13, 3, v12
    v_add_u32 v12, s12, v12
    s_lshl_b32 s12, s47, 5
    s_add_u32 s12, s12, s46
    s_mul_i32 s12, s12, 12288
    s_mul_i32 s13, s3, 3072
    s_add_u32 s12, s12, s13
    s_add_u32 s12, s12, 3145728
    v_lshl_add_u32 v10, v1, 4, s12
    s_lshl_b32 s73, s46, 1
    s_lshr_b32 s13, s3, 1
    s_add_u32 s73, s73, s13
    s_lshl_b32 s73, s73, 17
    s_lshr_b32 s13, s8, 2
    s_lshl_b32 s13, s13, 1
    s_and_b32 s9, s8, 1
    s_add_u32 s13, s13, s9
    s_lshl_b32 s13, s13, 10
    s_add_u32 s73, s73, s13
    s_lshl_b32 s9, s9, 16
    s_add_u32 s73, s73, s9
    s_xor_b32 s75, s73, 0x10000
    s_mul_i32 s72, s3, 4096
    s_add_u32 s72, s72, 0
    v_lshrrev_b32 v112, 3, v1
    v_lshrrev_b32 v113, 4, v1
    v_and_b32 v114, 7, v1
    v_xor_b32 v113, v113, v114
    v_lshlrev_b32 v112, 12, v112
    v_lshl_add_u32 v112, v113, 4, v112
    v_xor_b32 v113, 64, v112
    v_add_u32 v113, 31744, v113
    v_and_b32 v115, 15, v1
    v_lshrrev_b32 v114, 1, v115
    v_lshlrev_b32 v114, 4, v114
    v_lshl_add_u32 v114, v115, 7, v114
    v_and_b32 v115, 48, v1
    v_xor_b32 v114, v114, v115
    v_add_u32 v114, s72, v114
    v_xor_b32 v115, 64, v114
    s_mov_b32 s68, s34
    s_mov_b32 s69, s35
    s_mov_b32 s70, 8388608
    s_mov_b32 s71, 0x20000
    s_waitcnt lgkmcnt(0)
    s_barrier
    global_load_dwordx2 v[60:61], v19, s[42:43] offset:0 sc1
    global_load_dwordx2 v[62:63], v19, s[42:43] offset:512 sc1
    global_load_dwordx2 v[64:65], v19, s[42:43] offset:1024 sc1
    global_load_dwordx2 v[66:67], v19, s[42:43] offset:1536 sc1
    global_load_dwordx2 v[68:69], v19, s[42:43] offset:2048 sc1
    global_load_dwordx2 v[70:71], v19, s[42:43] offset:2560 sc1
    global_load_dwordx2 v[72:73], v19, s[42:43] offset:3072 sc1
    global_load_dwordx2 v[74:75], v19, s[42:43] offset:3584 sc1
    s_add_u32 m0, s72, 0
    s_add_u32 s13, s73, 512
    buffer_load_dwordx4 v112, s[68:71], s13 offen lds
    buffer_load_dwordx4 v113, s[68:71], s13 offen offset:1024 lds
    s_add_u32 m0, s72, 2048
    s_add_u32 s13, s75, 512
    buffer_load_dwordx4 v112, s[68:71], s13 offen lds
    buffer_load_dwordx4 v113, s[68:71], s13 offen offset:1024 lds
    s_add_u32 m0, s72, 16384
    s_add_u32 s13, s73, 640
    buffer_load_dwordx4 v112, s[68:71], s13 offen lds
    buffer_load_dwordx4 v113, s[68:71], s13 offen offset:1024 lds
    s_add_u32 m0, s72, 18432
    s_add_u32 s13, s75, 640
    buffer_load_dwordx4 v112, s[68:71], s13 offen lds
    buffer_load_dwordx4 v113, s[68:71], s13 offen offset:1024 lds
    s_mov_b32 s58, 0
    s_waitcnt vmcnt(8)
K3_POLL:
    v_max_u32 v13, v60, v61
    v_max3_u32 v13, v13, v62, v63
    v_max3_u32 v13, v13, v64, v65
    v_max3_u32 v13, v13, v66, v67
    v_max3_u32 v13, v13, v68, v69
    v_max3_u32 v13, v13, v70, v71
    v_max3_u32 v13, v13, v72, v73
    v_max3_u32 v13, v13, v74, v75
    v_cmp_eq_u32 vcc, -1, v13
    s_add_u32 s58, s58, 1
    s_cbranch_vccz K3_READY
    s_cmp_ge_u32 s58, 0x20000
    s_cbranch_scc1 K3_READY
    s_sleep 1
    global_load_dwordx2 v[60:61], v19, s[42:43] offset:0 sc1
    global_load_dwordx2 v[62:63], v19, s[42:43] offset:512 sc1
    global_load_dwordx2 v[64:65], v19, s[42:43] offset:1024 sc1
    global_load_dwordx2 v[66:67], v19, s[42:43] offset:1536 sc1
    global_load_dwordx2 v[68:69], v19, s[42:43] offset:2048 sc1
    global_load_dwordx2 v[70:71], v19, s[42:43] offset:2560 sc1
    global_load_dwordx2 v[72:73], v19, s[42:43] offset:3072 sc1
    global_load_dwordx2 v[74:75], v19, s[42:43] offset:3584 sc1
    s_waitcnt vmcnt(0)
    s_branch K3_POLL
K3_READY:
    v_add_f32 v60, v60, v62
    v_add_f32 v61, v61, v63
    v_add_f32 v64, v64, v66
    v_add_f32 v65, v65, v67
    v_add_f32 v68, v68, v70
    v_add_f32 v69, v69, v71
    v_add_f32 v72, v72, v74
    v_add_f32 v73, v73, v75
    v_add_f32 v60, v60, v64
    v_add_f32 v61, v61, v65
    v_add_f32 v68, v68, v72
    v_add_f32 v69, v69, v73
    v_add_f32 v60, v60, v68
    v_add_f32 v61, v61, v69
    v_mov_b32 v62, v60
    v_mov_b32 v63, v61
    s_nop 0
    v_permlane32_swap_b32 v60, v62
    v_permlane32_swap_b32 v61, v63
    v_add_f32 v60, v60, v62
    v_add_f32 v61, v61, v63
    v_mul_f32 v60, 0x3aaaaaab, v60
    v_mul_f32 v64, v60, v60
    v_mul_f32 v61, 0x3aaaaaab, v61
    v_sub_f32 v61, v61, v64
    v_max_f32 v61, 0, v61
    v_cvt_pk_bf16_f32 v61, 0, v61
    v_add_f32 v61, 0x3727c5ac, v61
    v_cvt_pk_bf16_f32 v61, 0, v61
    v_sqrt_f32 v61, v61
    v_cvt_pk_bf16_f32 v60, 0, v60
    v_cvt_pk_bf16_f32 v61, 0, v61
    v_rcp_f32 v61, v61
    s_nop 0
    v_mul_f32 v60, v60, -v61
    v_mov_b32 v62, v60
    v_mov_b32 v63, v61
    s_nop 0
    v_permlane16_swap_b32 v60, v62
    v_permlane16_swap_b32 v61, v63
    v_fma_f32 v36, v36, v61, v60
    v_fma_f32 v37, v37, v61, v60
    v_fma_f32 v38, v38, v61, v60
    v_fma_f32 v39, v39, v61, v60
    v_cvt_pk_bf16_f32 v36, v36, v37
    v_cvt_pk_bf16_f32 v37, v38, v39
    ds_write_b64 v11, v[36:37] offset:0
    v_fma_f32 v48, v48, v63, v62
    v_fma_f32 v49, v49, v63, v62
    v_fma_f32 v50, v50, v63, v62
    v_fma_f32 v51, v51, v63, v62
    v_cvt_pk_bf16_f32 v48, v48, v49
    v_cvt_pk_bf16_f32 v49, v50, v51
    ds_write_b64 v11, v[48:49] offset:1792
    ds_read_b64_tr_b16 v[80:81], v12 offset:0
    ds_read_b64_tr_b16 v[82:83], v12 offset:448
    v_fma_f32 v40, v40, v61, v60
    v_fma_f32 v41, v41, v61, v60
    v_fma_f32 v42, v42, v61, v60
    v_fma_f32 v43, v43, v61, v60
    v_cvt_pk_bf16_f32 v40, v40, v41
    v_cvt_pk_bf16_f32 v41, v42, v43
    ds_write_b64 v11, v[40:41] offset:32
    v_fma_f32 v52, v52, v63, v62
    v_fma_f32 v53, v53, v63, v62
    v_fma_f32 v54, v54, v63, v62
    v_fma_f32 v55, v55, v63, v62
    v_cvt_pk_bf16_f32 v52, v52, v53
    v_cvt_pk_bf16_f32 v53, v54, v55
    ds_write_b64 v11, v[52:53] offset:1824
    ds_read_b64_tr_b16 v[84:85], v12 offset:32
    ds_read_b64_tr_b16 v[86:87], v12 offset:480
    s_waitcnt lgkmcnt(4)
    global_store_dwordx4 v10, v[80:83], s[42:43] offset:0 sc1
    v_fma_f32 v44, v44, v61, v60
    v_fma_f32 v45, v45, v61, v60
    v_fma_f32 v46, v46, v61, v60
    v_fma_f32 v47, v47, v61, v60
    v_cvt_pk_bf16_f32 v44, v44, v45
    v_cvt_pk_bf16_f32 v45, v46, v47
    ds_write_b64 v11, v[44:45] offset:64
    v_fma_f32 v56, v56, v63, v62
    v_fma_f32 v57, v57, v63, v62
    v_fma_f32 v58, v58, v63, v62
    v_fma_f32 v59, v59, v63, v62
    v_cvt_pk_bf16_f32 v56, v56, v57
    v_cvt_pk_bf16_f32 v57, v58, v59
    ds_write_b64 v11, v[56:57] offset:1856
    ds_read_b64_tr_b16 v[88:89], v12 offset:64
    ds_read_b64_tr_b16 v[90:91], v12 offset:512
    s_waitcnt lgkmcnt(4)
    global_store_dwordx4 v10, v[84:87], s[42:43] offset:1024 sc1
    s_waitcnt lgkmcnt(0)
    global_store_dwordx4 v10, v[88:91], s[42:43] offset:2048 sc1
    s_lshl_b32 s12, s47, 10
    s_add_u32 s12, s12, 2635776
    s_lshl_b32 s58, s6, 7
    s_add_u32 s58, s58, s12
    s_waitcnt vmcnt(0)
    ds_read_b128 v[160:163], v114 offset:0
    ds_read_b128 v[224:227], v114 offset:2048
    ds_read_b128 v[164:167], v115 offset:0
    ds_read_b128 v[228:231], v115 offset:2048
    ds_read_b128 v[168:171], v114 offset:16384
    ds_read_b128 v[232:235], v114 offset:18432
    ds_read_b128 v[172:175], v115 offset:16384
    ds_read_b128 v[236:239], v115 offset:18432
    v_mov_b32 v10, 163796
    v_mov_b32 v11, 1
    s_mov_b64 exec, 1
    ds_add_rtn_u32 v12, v10, v11
    s_mov_b64 exec, 1
    v_lshl_add_u32 v10, v1, 10, s58
    s_waitcnt lgkmcnt(0)
    v_readfirstlane_b32 s15, v12
    s_nop 0
    s_cmp_lg_u32 s15, 3
    s_cbranch_scc1 K3A_NL
    global_atomic_add v10, v11, s[42:43] sc1
K3A_NL:
    s_mov_b64 exec, -1
    s_setprio 0
    s_barrier
    s_add_u32 m0, s72, 32768
    s_add_u32 s13, s73, 768
    buffer_load_dwordx4 v112, s[68:71], s13 offen lds
    buffer_load_dwordx4 v113, s[68:71], s13 offen offset:1024 lds
    s_add_u32 m0, s72, 34816
    s_add_u32 s13, s75, 768
    buffer_load_dwordx4 v112, s[68:71], s13 offen lds
    buffer_load_dwordx4 v113, s[68:71], s13 offen offset:1024 lds
    s_add_u32 m0, s72, 49152
    s_add_u32 s13, s73, 896
    buffer_load_dwordx4 v112, s[68:71], s13 offen lds
    buffer_load_dwordx4 v113, s[68:71], s13 offen offset:1024 lds
    s_add_u32 m0, s72, 51200
    s_add_u32 s13, s75, 896
    buffer_load_dwordx4 v112, s[68:71], s13 offen lds
    buffer_load_dwordx4 v113, s[68:71], s13 offen offset:1024 lds
    s_mul_i32 s62, s3, 5120
    s_mul_i32 s12, s47, 122880
    s_add_u32 s12, s12, s62
    v_lshl_add_u32 v4, v1, 4, s12
    s_add_u32 s64, s42, 11403264
    s_addc_u32 s65, s43, 0
    s_mov_b32 s66, 983040
    s_mov_b32 s67, 0x20000
    s_add_u32 m0, s62, 98304
    s_mov_b32 s56, 0
    buffer_load_dwordx4 v4, s[64:67], s56 offen offset:0 sc1 lds
    buffer_load_dwordx4 v4, s[64:67], s56 offen offset:1024 sc1 lds
    buffer_load_dwordx4 v4, s[64:67], s56 offen offset:2048 sc1 lds
    s_add_u32 m0, s62, 101376
    s_mov_b32 s56, 3072
    buffer_load_dwordx4 v4, s[64:67], s56 offen offset:0 sc1 lds
    buffer_load_dwordx4 v4, s[64:67], s56 offen offset:1024 sc1 lds
    s_add_u32 m0, s62, 118784
    s_mov_b32 s56, 20480
    buffer_load_dwordx4 v4, s[64:67], s56 offen offset:0 sc1 lds
    buffer_load_dwordx4 v4, s[64:67], s56 offen offset:1024 sc1 lds
    buffer_load_dwordx4 v4, s[64:67], s56 offen offset:2048 sc1 lds
    s_add_u32 m0, s62, 121856
    s_mov_b32 s56, 23552
    buffer_load_dwordx4 v4, s[64:67], s56 offen offset:0 sc1 lds
    buffer_load_dwordx4 v4, s[64:67], s56 offen offset:1024 sc1 lds
    s_waitcnt vmcnt(14)
    ds_read_b128 v[176:179], v114 offset:32768
    ds_read_b128 v[240:243], v114 offset:34816
    ds_read_b128 v[180:183], v115 offset:32768
    ds_read_b128 v[244:247], v115 offset:34816
    s_waitcnt vmcnt(10)
    ds_read_b128 v[184:187], v114 offset:49152
    ds_read_b128 v[248:251], v114 offset:51200
    ds_read_b128 v[188:191], v115 offset:49152
    ds_read_b128 v[252:255], v115 offset:51200
    s_branch PH4
PH3Y:
    v_and_b32 v2, 15, v1
    v_lshrrev_b32 v3, 4, v1
    s_lshr_b32 s10, s3, 1
    s_and_b32 s11, s3, 1
    v_lshrrev_b32 v9, 3, v1
    v_and_b32 v10, 7, v1
    v_and_b32 v11, 6, v9
    v_xor_b32 v10, v10, v11
    v_lshlrev_b32 v9, 7, v9
    v_lshl_add_u32 v5, v10, 4, v9
    s_mul_i32 s12, s46, 81920
    v_add_u32 v5, s12, v5
    s_lshl_b32 s12, s3, 11
    v_add_u32 v4, s12, v5
    s_mul_i32 s59, s3, 3072
    s_mul_i32 s12, s47, 122880
    s_add_u32 s12, s12, s59
    v_lshl_add_u32 v6, v1, 4, s12
    s_lshl_b32 s14, s3, 11
    s_add_u32 s59, s59, 101888
    s_mov_b32 s48, s42
    s_mov_b32 s49, s43
    s_mov_b32 s50, 2621440
    s_mov_b32 s51, 0x20000
    s_add_u32 s52, s42, 9437184
    s_addc_u32 s53, s43, 0
    s_mov_b32 s54, 1966080
    s_mov_b32 s55, 0x20000
    v_lshrrev_b32 v9, 2, v1
    v_lshrrev_b32 v10, 1, v9
    v_and_b32 v10, 3, v10
    v_and_b32 v11, 3, v2
    v_lshlrev_b32 v11, 3, v11
    s_mov_b32 s63, 0
    s_lshl_b32 s12, s10, 1
    s_add_u32 s12, s12, s63
    v_xor_b32 v12, s12, v10
    v_xor_b32 v13, 1, v12
    v_lshl_add_u32 v19, v9, 7, v11
    v_lshl_add_u32 v12, v12, 5, v19
    v_lshl_add_u32 v13, v13, 5, v19
    v_add_u32 v14, 40960, v12
    v_add_u32 v15, 40960, v13
    s_mul_i32 s12, s11, 3072
    s_add_u32 s12, s12, 101888
    v_lshl_add_u32 v16, v1, 4, s12
    s_lshl_b32 s12, s10, 8
    s_lshl_b32 s13, s63, 7
    s_add_u32 s12, s12, s13
    s_add_u32 s12, s12, 96256
    v_lshl_add_u32 v17, v2, 3, s12
    v_xor_b32 v7, 0x80, v17
    v_mov_b32 v120, 0xc0135761
    v_mov_b32 v121, 0xbdd2d3e8
    s_lshl_b32 s12, s10, 12
    s_lshl_b32 s13, s10, 6
    v_xor_b32 v12, s13, v12
    v_xor_b32 v13, s13, v13
    v_add_u32 v12, s12, v12
    v_add_u32 v13, s12, v13
    v_xor_b32 v14, 64, v12
    v_xor_b32 v15, 64, v13
    v_lshl_add_u32 v16, v1, 4, s59
    s_lshl_b32 s12, s6, 10
    s_add_u32 s12, s12, 2643968
    v_and_b32 v20, 7, v1
    v_lshl_add_u32 v20, v20, 7, s12
    s_barrier
    s_cmp_lt_u32 s7, 12
    s_cbranch_scc1 K3_PD
    s_add_u32 m0, s59, 24576
    s_mov_b32 s57, 983040
    buffer_load_dwordx4 v6, s[52:55], s57 offen offset:0 sc1 lds
    buffer_load_dwordx4 v6, s[52:55], s57 offen offset:1024 sc1 lds
    buffer_load_dwordx4 v6, s[52:55], s57 offen offset:2048 sc1 lds
    s_add_u32 m0, s59, 36864
    s_mov_b32 s57, 995328
    buffer_load_dwordx4 v6, s[52:55], s57 offen offset:0 sc1 lds
    buffer_load_dwordx4 v6, s[52:55], s57 offen offset:1024 sc1 lds
    buffer_load_dwordx4 v6, s[52:55], s57 offen offset:2048 sc1 lds
    s_add_u32 m0, s59, 49152
    s_mov_b32 s57, 1007616
    buffer_load_dwordx4 v6, s[52:55], s57 offen offset:0 sc1 lds
    buffer_load_dwordx4 v6, s[52:55], s57 offen offset:1024 sc1 lds
    buffer_load_dwordx4 v6, s[52:55], s57 offen offset:2048 sc1 lds
    s_add_u32 m0, s59, 0
    s_mov_b32 s57, 1019904
    buffer_load_dwordx4 v6, s[52:55], s57 offen offset:0 sc1 lds
    buffer_load_dwordx4 v6, s[52:55], s57 offen offset:1024 sc1 lds
    buffer_load_dwordx4 v6, s[52:55], s57 offen offset:2048 sc1 lds
    s_add_u32 m0, s59, 12288
    s_mov_b32 s57, 1032192
    buffer_load_dwordx4 v6, s[52:55], s57 offen offset:0 sc1 lds
    buffer_load_dwordx4 v6, s[52:55], s57 offen offset:1024 sc1 lds
    buffer_load_dwordx4 v6, s[52:55], s57 offen offset:2048 sc1 lds
K3_PD:
    s_cmp_lg_u32 s8, 4
    s_cbranch_scc1 K3_NP
    s_mov_b32 s15, 0
S1_PL:
    global_load_dword v21, v20, s[42:43] sc1
    s_waitcnt vmcnt(0)
    v_cmp_gt_u32 vcc, 20, v21
    s_add_u32 s15, s15, 1
    s_cbranch_vccz S1_OK
    s_sleep 1
    s_cmp_lt_u32 s15, 0x20000
    s_cbranch_scc1 S1_PL
S1_OK:
K3_NP:
    s_setprio 3
    s_barrier
    s_add_u32 m0, s14, 0
    s_mov_b32 s56, 0
    buffer_load_dwordx4 v4, s[48:51], s56 offen sc1 lds
    buffer_load_dwordx4 v4, s[48:51], s56 offen offset:1024 sc1 lds
    s_add_u32 m0, s14, 8192
    s_mov_b32 s56, 8192
    buffer_load_dwordx4 v4, s[48:51], s56 offen sc1 lds
    buffer_load_dwordx4 v4, s[48:51], s56 offen offset:1024 sc1 lds
    s_add_u32 m0, s14, 16384
    s_mov_b32 s56, 16384
    buffer_load_dwordx4 v4, s[48:51], s56 offen sc1 lds
    buffer_load_dwordx4 v4, s[48:51], s56 offen offset:1024 sc1 lds
    s_add_u32 m0, s14, 24576
    s_mov_b32 s56, 24576
    buffer_load_dwordx4 v4, s[48:51], s56 offen sc1 lds
    buffer_load_dwordx4 v4, s[48:51], s56 offen offset:1024 sc1 lds
    s_waitcnt vmcnt(6)
    s_barrier
    s_add_u32 m0, s14, 32768
    s_mov_b32 s56, 32768
    buffer_load_dwordx4 v4, s[48:51], s56 offen sc1 lds
    buffer_load_dwordx4 v4, s[48:51], s56 offen offset:1024 sc1 lds
    s_waitcnt vmcnt(6)
    s_barrier
    s_add_u32 m0, s14, 40960
    s_mov_b32 s56, 40960
    buffer_load_dwordx4 v4, s[48:51], s56 offen sc1 lds
    buffer_load_dwordx4 v4, s[48:51], s56 offen offset:1024 sc1 lds
    s_waitcnt vmcnt(6)
    s_barrier
    s_add_u32 m0, s59, 24576
    s_mov_b32 s57, 1044480
    buffer_load_dwordx4 v6, s[52:55], s57 offen offset:0 sc1 lds
    buffer_load_dwordx4 v6, s[52:55], s57 offen offset:1024 sc1 lds
    buffer_load_dwordx4 v6, s[52:55], s57 offen offset:2048 sc1 lds
    s_add_u32 m0, s14, 49152
    s_mov_b32 s56, 49152
    buffer_load_dwordx4 v4, s[48:51], s56 offen sc1 lds
    buffer_load_dwordx4 v4, s[48:51], s56 offen offset:1024 sc1 lds
    s_waitcnt vmcnt(9)
    s_barrier
    s_add_u32 m0, s59, 36864
    s_mov_b32 s57, 1056768
    buffer_load_dwordx4 v6, s[52:55], s57 offen offset:0 sc1 lds
    buffer_load_dwordx4 v6, s[52:55], s57 offen offset:1024 sc1 lds
    buffer_load_dwordx4 v6, s[52:55], s57 offen offset:2048 sc1 lds
    s_add_u32 m0, s14, 57344
    s_mov_b32 s56, 57344
    buffer_load_dwordx4 v4, s[48:51], s56 offen sc1 lds
    buffer_load_dwordx4 v4, s[48:51], s56 offen offset:1024 sc1 lds
    s_waitcnt vmcnt(12)
    s_barrier
    s_add_u32 m0, s59, 49152
    s_mov_b32 s57, 1069056
    buffer_load_dwordx4 v6, s[52:55], s57 offen offset:0 sc1 lds
    buffer_load_dwordx4 v6, s[52:55], s57 offen offset:1024 sc1 lds
    buffer_load_dwordx4 v6, s[52:55], s57 offen offset:2048 sc1 lds
    s_add_u32 m0, s14, 65536
    s_mov_b32 s56, 65536
    buffer_load_dwordx4 v4, s[48:51], s56 offen sc1 lds
    buffer_load_dwordx4 v4, s[48:51], s56 offen offset:1024 sc1 lds
    s_waitcnt vmcnt(12)
    s_barrier
    s_add_u32 m0, s59, 0
    s_mov_b32 s57, 1081344
    buffer_load_dwordx4 v6, s[52:55], s57 offen offset:0 sc1 lds
    buffer_load_dwordx4 v6, s[52:55], s57 offen offset:1024 sc1 lds
    buffer_load_dwordx4 v6, s[52:55], s57 offen offset:2048 sc1 lds
    s_add_u32 m0, s14, 73728
    s_mov_b32 s56, 73728
    buffer_load_dwordx4 v4, s[48:51], s56 offen sc1 lds
    buffer_load_dwordx4 v4, s[48:51], s56 offen offset:1024 sc1 lds
    s_waitcnt vmcnt(12)
    s_barrier
    s_add_u32 m0, s59, 12288
    s_mov_b32 s57, 1093632
    buffer_load_dwordx4 v6, s[52:55], s57 offen offset:0 sc1 lds
    buffer_load_dwordx4 v6, s[52:55], s57 offen offset:1024 sc1 lds
    buffer_load_dwordx4 v6, s[52:55], s57 offen offset:2048 sc1 lds
    s_waitcnt vmcnt(10)
    s_barrier
    s_add_u32 m0, s59, 24576
    s_mov_b32 s57, 0
    buffer_load_dwordx4 v6, s[52:55], s57 offen offset:0 sc1 lds
    buffer_load_dwordx4 v6, s[52:55], s57 offen offset:1024 sc1 lds
    buffer_load_dwordx4 v6, s[52:55], s57 offen offset:2048 sc1 lds
    s_waitcnt vmcnt(8)
    s_barrier
    s_add_u32 m0, s59, 36864
    s_mov_b32 s57, 12288
    buffer_load_dwordx4 v6, s[52:55], s57 offen offset:0 sc1 lds
    buffer_load_dwordx4 v6, s[52:55], s57 offen offset:1024 sc1 lds
    buffer_load_dwordx4 v6, s[52:55], s57 offen offset:2048 sc1 lds
    s_waitcnt vmcnt(6)
    s_barrier
    s_add_u32 m0, s59, 49152
    s_mov_b32 s57, 24576
    buffer_load_dwordx4 v6, s[52:55], s57 offen offset:0 sc1 lds
    buffer_load_dwordx4 v6, s[52:55], s57 offen offset:1024 sc1 lds
    buffer_load_dwordx4 v6, s[52:55], s57 offen offset:2048 sc1 lds
    s_barrier
    s_add_u32 m0, s59, 0
    s_mov_b32 s57, 36864
    buffer_load_dwordx4 v6, s[52:55], s57 offen offset:0 sc1 lds
    buffer_load_dwordx4 v6, s[52:55], s57 offen offset:1024 sc1 lds
    buffer_load_dwordx4 v6, s[52:55], s57 offen offset:2048 sc1 lds
    s_add_u32 m0, s59, 12288
    s_mov_b32 s57, 49152
    buffer_load_dwordx4 v6, s[52:55], s57 offen offset:0 sc1 lds
    buffer_load_dwordx4 v6, s[52:55], s57 offen offset:1024 sc1 lds
    buffer_load_dwordx4 v6, s[52:55], s57 offen offset:2048 sc1 lds
    s_setprio 0
    v_and_b32 v8, 7, v1
    v_lshlrev_b32 v8, 7, v8
    v_add_u32 v8, 2630656, v8
    global_load_dword v9, v8, s[42:43] sc1
    s_waitcnt vmcnt(13)
    ds_read_b128 v[84:87], v16 offset:24576
    ds_read_b128 v[88:91], v16 offset:25600
    ds_read_b128 v[92:95], v16 offset:26624
    ds_read_b64_tr_b16 v[68:69], v12 offset:0
    ds_read_b64_tr_b16 v[70:71], v12 offset:2048
    ds_read_b64_tr_b16 v[72:73], v13 offset:0
    ds_read_b64_tr_b16 v[74:75], v13 offset:2048
    ds_read_b64_tr_b16 v[76:77], v14 offset:0
    ds_read_b64_tr_b16 v[78:79], v14 offset:2048
    ds_read_b64_tr_b16 v[80:81], v15 offset:0
    ds_read_b64_tr_b16 v[82:83], v15 offset:2048
    s_waitcnt lgkmcnt(8)
    s_add_u32 m0, s59, 24576
    s_mov_b32 s57, 61440
    buffer_load_dwordx4 v6, s[52:55], s57 offen offset:0 sc1 lds
    buffer_load_dwordx4 v6, s[52:55], s57 offen offset:1024 sc1 lds
    buffer_load_dwordx4 v6, s[52:55], s57 offen offset:2048 sc1 lds
    s_waitcnt vmcnt(13)
    s_waitcnt lgkmcnt(6)
    v_mfma_f32_16x16x32_bf16 v[20:23], v[84:87], v[68:71], 0
    ds_read_b128 v[112:115], v16 offset:36864
    v_mfma_f32_16x16x32_bf16 v[24:27], v[88:91], v[68:71], 0
    ds_read_b128 v[116:119], v16 offset:37888
    v_mfma_f32_16x16x32_bf16 v[28:31], v[92:95], v[68:71], 0
    ds_read_b128 v[120:123], v16 offset:38912
    s_waitcnt lgkmcnt(7)
    v_mfma_f32_16x16x32_bf16 v[32:35], v[84:87], v[72:75], 0
    ds_read_b64_tr_b16 v[96:97], v12 offset:8192
    v_mfma_f32_16x16x32_bf16 v[36:39], v[88:91], v[72:75], 0
    ds_read_b64_tr_b16 v[98:99], v12 offset:10240
    v_mfma_f32_16x16x32_bf16 v[40:43], v[92:95], v[72:75], 0
    ds_read_b64_tr_b16 v[100:101], v13 offset:8192
    s_waitcnt lgkmcnt(8)
    v_mfma_f32_16x16x32_bf16 v[44:47], v[84:87], v[76:79], 0
    ds_read_b64_tr_b16 v[102:103], v13 offset:10240
    v_mfma_f32_16x16x32_bf16 v[48:51], v[88:91], v[76:79], 0
    ds_read_b64_tr_b16 v[104:105], v14 offset:8192
    v_mfma_f32_16x16x32_bf16 v[52:55], v[92:95], v[76:79], 0
    ds_read_b64_tr_b16 v[106:107], v14 offset:10240
    s_waitcnt lgkmcnt(9)
    v_mfma_f32_16x16x32_bf16 v[56:59], v[84:87], v[80:83], 0
    ds_read_b64_tr_b16 v[108:109], v15 offset:8192
    v_mfma_f32_16x16x32_bf16 v[60:63], v[88:91], v[80:83], 0
    ds_read_b64_tr_b16 v[110:111], v15 offset:10240
    v_mfma_f32_16x16x32_bf16 v[64:67], v[92:95], v[80:83], 0
    s_waitcnt lgkmcnt(8)
    s_add_u32 m0, s59, 36864
    s_mov_b32 s57, 73728
    buffer_load_dwordx4 v6, s[52:55], s57 offen offset:0 sc1 lds
    buffer_load_dwordx4 v6, s[52:55], s57 offen offset:1024 sc1 lds
    buffer_load_dwordx4 v6, s[52:55], s57 offen offset:2048 sc1 lds
    s_waitcnt vmcnt(13)
    s_waitcnt lgkmcnt(6)
    v_mfma_f32_16x16x32_bf16 v[20:23], v[112:115], v[96:99], v[20:23]
    ds_read_b128 v[84:87], v16 offset:49152
    v_mfma_f32_16x16x32_bf16 v[24:27], v[116:119], v[96:99], v[24:27]
    ds_read_b128 v[88:91], v16 offset:50176
    v_mfma_f32_16x16x32_bf16 v[28:31], v[120:123], v[96:99], v[28:31]
    ds_read_b128 v[92:95], v16 offset:51200
    s_waitcnt lgkmcnt(7)
    v_mfma_f32_16x16x32_bf16 v[32:35], v[112:115], v[100:103], v[32:35]
    ds_read_b64_tr_b16 v[68:69], v12 offset:16384
    v_mfma_f32_16x16x32_bf16 v[36:39], v[116:119], v[100:103], v[36:39]
    ds_read_b64_tr_b16 v[70:71], v12 offset:18432
    v_mfma_f32_16x16x32_bf16 v[40:43], v[120:123], v[100:103], v[40:43]
    ds_read_b64_tr_b16 v[72:73], v13 offset:16384
    s_waitcnt lgkmcnt(8)
    v_mfma_f32_16x16x32_bf16 v[44:47], v[112:115], v[104:107], v[44:47]
    ds_read_b64_tr_b16 v[74:75], v13 offset:18432
    v_mfma_f32_16x16x32_bf16 v[48:51], v[116:119], v[104:107], v[48:51]
    ds_read_b64_tr_b16 v[76:77], v14 offset:16384
    v_mfma_f32_16x16x32_bf16 v[52:55], v[120:123], v[104:107], v[52:55]
    ds_read_b64_tr_b16 v[78:79], v14 offset:18432
    s_waitcnt lgkmcnt(9)
    v_mfma_f32_16x16x32_bf16 v[56:59], v[112:115], v[108:111], v[56:59]
    ds_read_b64_tr_b16 v[80:81], v15 offset:16384
    v_mfma_f32_16x16x32_bf16 v[60:63], v[116:119], v[108:111], v[60:63]
    ds_read_b64_tr_b16 v[82:83], v15 offset:18432
    v_mfma_f32_16x16x32_bf16 v[64:67], v[120:123], v[108:111], v[64:67]
    s_waitcnt lgkmcnt(8)
    s_add_u32 m0, s59, 49152
    s_mov_b32 s57, 86016
    buffer_load_dwordx4 v6, s[52:55], s57 offen offset:0 sc1 lds
    buffer_load_dwordx4 v6, s[52:55], s57 offen offset:1024 sc1 lds
    buffer_load_dwordx4 v6, s[52:55], s57 offen offset:2048 sc1 lds
    s_waitcnt vmcnt(13)
    s_waitcnt lgkmcnt(6)
    v_mfma_f32_16x16x32_bf16 v[20:23], v[84:87], v[68:71], v[20:23]
    ds_read_b128 v[112:115], v16 offset:0
    v_mfma_f32_16x16x32_bf16 v[24:27], v[88:91], v[68:71], v[24:27]
    ds_read_b128 v[116:119], v16 offset:1024
    v_mfma_f32_16x16x32_bf16 v[28:31], v[92:95], v[68:71], v[28:31]
    ds_read_b128 v[120:123], v16 offset:2048
    s_waitcnt lgkmcnt(7)
    v_mfma_f32_16x16x32_bf16 v[32:35], v[84:87], v[72:75], v[32:35]
    ds_read_b64_tr_b16 v[96:97], v12 offset:24576
    v_mfma_f32_16x16x32_bf16 v[36:39], v[88:91], v[72:75], v[36:39]
    ds_read_b64_tr_b16 v[98:99], v12 offset:26624
    v_mfma_f32_16x16x32_bf16 v[40:43], v[92:95], v[72:75], v[40:43]
    ds_read_b64_tr_b16 v[100:101], v13 offset:24576
    s_waitcnt lgkmcnt(8)
    v_mfma_f32_16x16x32_bf16 v[44:47], v[84:87], v[76:79], v[44:47]
    ds_read_b64_tr_b16 v[102:103], v13 offset:26624
    v_mfma_f32_16x16x32_bf16 v[48:51], v[88:91], v[76:79], v[48:51]
    ds_read_b64_tr_b16 v[104:105], v14 offset:24576
    v_mfma_f32_16x16x32_bf16 v[52:55], v[92:95], v[76:79], v[52:55]
    ds_read_b64_tr_b16 v[106:107], v14 offset:26624
    s_waitcnt lgkmcnt(9)
    v_mfma_f32_16x16x32_bf16 v[56:59], v[84:87], v[80:83], v[56:59]
    ds_read_b64_tr_b16 v[108:109], v15 offset:24576
    v_mfma_f32_16x16x32_bf16 v[60:63], v[88:91], v[80:83], v[60:63]
    ds_read_b64_tr_b16 v[110:111], v15 offset:26624
    v_mfma_f32_16x16x32_bf16 v[64:67], v[92:95], v[80:83], v[64:67]
    s_waitcnt lgkmcnt(8)
    s_add_u32 m0, s59, 0
    s_mov_b32 s57, 98304
    buffer_load_dwordx4 v6, s[52:55], s57 offen offset:0 sc1 lds
    buffer_load_dwordx4 v6, s[52:55], s57 offen offset:1024 sc1 lds
    buffer_load_dwordx4 v6, s[52:55], s57 offen offset:2048 sc1 lds
    s_waitcnt vmcnt(13)
    s_waitcnt lgkmcnt(6)
    v_mfma_f32_16x16x32_bf16 v[20:23], v[112:115], v[96:99], v[20:23]
    ds_read_b128 v[84:87], v16 offset:12288
    v_mfma_f32_16x16x32_bf16 v[24:27], v[116:119], v[96:99], v[24:27]
    ds_read_b128 v[88:91], v16 offset:13312
    v_mfma_f32_16x16x32_bf16 v[28:31], v[120:123], v[96:99], v[28:31]
    ds_read_b128 v[92:95], v16 offset:14336
    s_waitcnt lgkmcnt(7)
    v_mfma_f32_16x16x32_bf16 v[32:35], v[112:115], v[100:103], v[32:35]
    ds_read_b64_tr_b16 v[68:69], v12 offset:32768
    v_mfma_f32_16x16x32_bf16 v[36:39], v[116:119], v[100:103], v[36:39]
    ds_read_b64_tr_b16 v[70:71], v12 offset:34816
    v_mfma_f32_16x16x32_bf16 v[40:43], v[120:123], v[100:103], v[40:43]
    ds_read_b64_tr_b16 v[72:73], v13 offset:32768
    s_waitcnt lgkmcnt(8)
    v_mfma_f32_16x16x32_bf16 v[44:47], v[112:115], v[104:107], v[44:47]
    ds_read_b64_tr_b16 v[74:75], v13 offset:34816
    v_mfma_f32_16x16x32_bf16 v[48:51], v[116:119], v[104:107], v[48:51]
    ds_read_b64_tr_b16 v[76:77], v14 offset:32768
    v_mfma_f32_16x16x32_bf16 v[52:55], v[120:123], v[104:107], v[52:55]
    ds_read_b64_tr_b16 v[78:79], v14 offset:34816
    s_waitcnt lgkmcnt(9)
    v_mfma_f32_16x16x32_bf16 v[56:59], v[112:115], v[108:111], v[56:59]
    ds_read_b64_tr_b16 v[80:81], v15 offset:32768
    v_mfma_f32_16x16x32_bf16 v[60:63], v[116:119], v[108:111], v[60:63]
    ds_read_b64_tr_b16 v[82:83], v15 offset:34816
    v_mfma_f32_16x16x32_bf16 v[64:67], v[120:123], v[108:111], v[64:67]
    s_waitcnt lgkmcnt(8)
    s_add_u32 m0, s59, 12288
    s_mov_b32 s57, 110592
    buffer_load_dwordx4 v6, s[52:55], s57 offen offset:0 sc1 lds
    buffer_load_dwordx4 v6, s[52:55], s57 offen offset:1024 sc1 lds
    buffer_load_dwordx4 v6, s[52:55], s57 offen offset:2048 sc1 lds
    s_barrier
    v_add_u32 v12, 40960, v12
    v_add_u32 v13, 40960, v13
    v_add_u32 v14, 40960, v14
    v_add_u32 v15, 40960, v15
    s_waitcnt vmcnt(12)
    s_waitcnt lgkmcnt(6)
    v_mfma_f32_16x16x32_bf16 v[20:23], v[84:87], v[68:71], v[20:23]
    ds_read_b128 v[112:115], v16 offset:24576
    v_mfma_f32_16x16x32_bf16 v[24:27], v[88:91], v[68:71], v[24:27]
    ds_read_b128 v[116:119], v16 offset:25600
    v_mfma_f32_16x16x32_bf16 v[28:31], v[92:95], v[68:71], v[28:31]
    ds_read_b128 v[120:123], v16 offset:26624
    s_waitcnt lgkmcnt(7)
    v_mfma_f32_16x16x32_bf16 v[32:35], v[84:87], v[72:75], v[32:35]
    ds_read_b64_tr_b16 v[96:97], v12 offset:0
    v_mfma_f32_16x16x32_bf16 v[36:39], v[88:91], v[72:75], v[36:39]
    ds_read_b64_tr_b16 v[98:99], v12 offset:2048
    v_mfma_f32_16x16x32_bf16 v[40:43], v[92:95], v[72:75], v[40:43]
    ds_read_b64_tr_b16 v[100:101], v13 offset:0
    s_waitcnt lgkmcnt(8)
    v_mfma_f32_16x16x32_bf16 v[44:47], v[84:87], v[76:79], v[44:47]
    ds_read_b64_tr_b16 v[102:103], v13 offset:2048
    v_mfma_f32_16x16x32_bf16 v[48:51], v[88:91], v[76:79], v[48:51]
    ds_read_b64_tr_b16 v[104:105], v14 offset:0
    v_mfma_f32_16x16x32_bf16 v[52:55], v[92:95], v[76:79], v[52:55]
    ds_read_b64_tr_b16 v[106:107], v14 offset:2048
    s_waitcnt lgkmcnt(9)
    v_mfma_f32_16x16x32_bf16 v[56:59], v[84:87], v[80:83], v[56:59]
    ds_read_b64_tr_b16 v[108:109], v15 offset:0
    v_mfma_f32_16x16x32_bf16 v[60:63], v[88:91], v[80:83], v[60:63]
    ds_read_b64_tr_b16 v[110:111], v15 offset:2048
    v_mfma_f32_16x16x32_bf16 v[64:67], v[92:95], v[80:83], v[64:67]
    s_waitcnt lgkmcnt(8)
    s_waitcnt vmcnt(9)
    s_waitcnt lgkmcnt(6)
    v_mfma_f32_16x16x32_bf16 v[20:23], v[112:115], v[96:99], v[20:23]
    ds_read_b128 v[84:87], v16 offset:36864
    v_mfma_f32_16x16x32_bf16 v[24:27], v[116:119], v[96:99], v[24:27]
    ds_read_b128 v[88:91], v16 offset:37888
    v_mfma_f32_16x16x32_bf16 v[28:31], v[120:123], v[96:99], v[28:31]
    ds_read_b128 v[92:95], v16 offset:38912
    s_waitcnt lgkmcnt(7)
    v_mfma_f32_16x16x32_bf16 v[32:35], v[112:115], v[100:103], v[32:35]
    ds_read_b64_tr_b16 v[68:69], v12 offset:8192
    v_mfma_f32_16x16x32_bf16 v[36:39], v[116:119], v[100:103], v[36:39]
    ds_read_b64_tr_b16 v[70:71], v12 offset:10240
    v_mfma_f32_16x16x32_bf16 v[40:43], v[120:123], v[100:103], v[40:43]
    ds_read_b64_tr_b16 v[72:73], v13 offset:8192
    s_waitcnt lgkmcnt(8)
    v_mfma_f32_16x16x32_bf16 v[44:47], v[112:115], v[104:107], v[44:47]
    ds_read_b64_tr_b16 v[74:75], v13 offset:10240
    v_mfma_f32_16x16x32_bf16 v[48:51], v[116:119], v[104:107], v[48:51]
    ds_read_b64_tr_b16 v[76:77], v14 offset:8192
    v_mfma_f32_16x16x32_bf16 v[52:55], v[120:123], v[104:107], v[52:55]
    ds_read_b64_tr_b16 v[78:79], v14 offset:10240
    s_waitcnt lgkmcnt(9)
    v_mfma_f32_16x16x32_bf16 v[56:59], v[112:115], v[108:111], v[56:59]
    ds_read_b64_tr_b16 v[80:81], v15 offset:8192
    v_mfma_f32_16x16x32_bf16 v[60:63], v[116:119], v[108:111], v[60:63]
    ds_read_b64_tr_b16 v[82:83], v15 offset:10240
    v_mfma_f32_16x16x32_bf16 v[64:67], v[120:123], v[108:111], v[64:67]
    s_waitcnt lgkmcnt(8)
    s_waitcnt vmcnt(6)
    s_waitcnt lgkmcnt(6)
    v_mfma_f32_16x16x32_bf16 v[20:23], v[84:87], v[68:71], v[20:23]
    ds_read_b128 v[112:115], v16 offset:49152
    v_mfma_f32_16x16x32_bf16 v[24:27], v[88:91], v[68:71], v[24:27]
    ds_read_b128 v[116:119], v16 offset:50176
    v_mfma_f32_16x16x32_bf16 v[28:31], v[92:95], v[68:71], v[28:31]
    ds_read_b128 v[120:123], v16 offset:51200
    s_waitcnt lgkmcnt(7)
    v_mfma_f32_16x16x32_bf16 v[32:35], v[84:87], v[72:75], v[32:35]
    ds_read_b64_tr_b16 v[96:97], v12 offset:16384
    v_mfma_f32_16x16x32_bf16 v[36:39], v[88:91], v[72:75], v[36:39]
    ds_read_b64_tr_b16 v[98:99], v12 offset:18432
    v_mfma_f32_16x16x32_bf16 v[40:43], v[92:95], v[72:75], v[40:43]
    ds_read_b64_tr_b16 v[100:101], v13 offset:16384
    s_waitcnt lgkmcnt(8)
    v_mfma_f32_16x16x32_bf16 v[44:47], v[84:87], v[76:79], v[44:47]
    ds_read_b64_tr_b16 v[102:103], v13 offset:18432
    v_mfma_f32_16x16x32_bf16 v[48:51], v[88:91], v[76:79], v[48:51]
    ds_read_b64_tr_b16 v[104:105], v14 offset:16384
    v_mfma_f32_16x16x32_bf16 v[52:55], v[92:95], v[76:79], v[52:55]
    ds_read_b64_tr_b16 v[106:107], v14 offset:18432
    s_waitcnt lgkmcnt(9)
    v_mfma_f32_16x16x32_bf16 v[56:59], v[84:87], v[80:83], v[56:59]
    ds_read_b64_tr_b16 v[108:109], v15 offset:16384
    v_mfma_f32_16x16x32_bf16 v[60:63], v[88:91], v[80:83], v[60:63]
    ds_read_b64_tr_b16 v[110:111], v15 offset:18432
    v_mfma_f32_16x16x32_bf16 v[64:67], v[92:95], v[80:83], v[64:67]
    s_waitcnt lgkmcnt(8)
    s_waitcnt vmcnt(3)
    s_waitcnt lgkmcnt(6)
    v_mfma_f32_16x16x32_bf16 v[20:23], v[112:115], v[96:99], v[20:23]
    ds_read_b128 v[84:87], v16 offset:0
    v_mfma_f32_16x16x32_bf16 v[24:27], v[116:119], v[96:99], v[24:27]
    ds_read_b128 v[88:91], v16 offset:1024
    v_mfma_f32_16x16x32_bf16 v[28:31], v[120:123], v[96:99], v[28:31]
    ds_read_b128 v[92:95], v16 offset:2048
    s_waitcnt lgkmcnt(7)
    v_mfma_f32_16x16x32_bf16 v[32:35], v[112:115], v[100:103], v[32:35]
    ds_read_b64_tr_b16 v[68:69], v12 offset:24576
    v_mfma_f32_16x16x32_bf16 v[36:39], v[116:119], v[100:103], v[36:39]
    ds_read_b64_tr_b16 v[70:71], v12 offset:26624
    v_mfma_f32_16x16x32_bf16 v[40:43], v[120:123], v[100:103], v[40:43]
    ds_read_b64_tr_b16 v[72:73], v13 offset:24576
    s_waitcnt lgkmcnt(8)
    v_mfma_f32_16x16x32_bf16 v[44:47], v[112:115], v[104:107], v[44:47]
    ds_read_b64_tr_b16 v[74:75], v13 offset:26624
    v_mfma_f32_16x16x32_bf16 v[48:51], v[116:119], v[104:107], v[48:51]
    ds_read_b64_tr_b16 v[76:77], v14 offset:24576
    v_mfma_f32_16x16x32_bf16 v[52:55], v[120:123], v[104:107], v[52:55]
    ds_read_b64_tr_b16 v[78:79], v14 offset:26624
    s_waitcnt lgkmcnt(9)
    v_mfma_f32_16x16x32_bf16 v[56:59], v[112:115], v[108:111], v[56:59]
    ds_read_b64_tr_b16 v[80:81], v15 offset:24576
    v_mfma_f32_16x16x32_bf16 v[60:63], v[116:119], v[108:111], v[60:63]
    ds_read_b64_tr_b16 v[82:83], v15 offset:26624
    v_mfma_f32_16x16x32_bf16 v[64:67], v[120:123], v[108:111], v[64:67]
    s_waitcnt lgkmcnt(8)
    s_waitcnt vmcnt(0)
    s_waitcnt lgkmcnt(6)
    v_mfma_f32_16x16x32_bf16 v[20:23], v[84:87], v[68:71], v[20:23]
    ds_read_b128 v[112:115], v16 offset:12288
    v_mfma_f32_16x16x32_bf16 v[24:27], v[88:91], v[68:71], v[24:27]
    ds_read_b128 v[116:119], v16 offset:13312
    v_mfma_f32_16x16x32_bf16 v[28:31], v[92:95], v[68:71], v[28:31]
    ds_read_b128 v[120:123], v16 offset:14336
    s_waitcnt lgkmcnt(7)
    v_mfma_f32_16x16x32_bf16 v[32:35], v[84:87], v[72:75], v[32:35]
    ds_read_b64_tr_b16 v[96:97], v12 offset:32768
    v_mfma_f32_16x16x32_bf16 v[36:39], v[88:91], v[72:75], v[36:39]
    ds_read_b64_tr_b16 v[98:99], v12 offset:34816
    v_mfma_f32_16x16x32_bf16 v[40:43], v[92:95], v[72:75], v[40:43]
    ds_read_b64_tr_b16 v[100:101], v13 offset:32768
    s_waitcnt lgkmcnt(8)
    v_mfma_f32_16x16x32_bf16 v[44:47], v[84:87], v[76:79], v[44:47]
    ds_read_b64_tr_b16 v[102:103], v13 offset:34816
    v_mfma_f32_16x16x32_bf16 v[48:51], v[88:91], v[76:79], v[48:51]
    ds_read_b64_tr_b16 v[104:105], v14 offset:32768
    v_mfma_f32_16x16x32_bf16 v[52:55], v[92:95], v[76:79], v[52:55]
    ds_read_b64_tr_b16 v[106:107], v14 offset:34816
    s_waitcnt lgkmcnt(9)
    v_mfma_f32_16x16x32_bf16 v[56:59], v[84:87], v[80:83], v[56:59]
    ds_read_b64_tr_b16 v[108:109], v15 offset:32768
    v_mfma_f32_16x16x32_bf16 v[60:63], v[88:91], v[80:83], v[60:63]
    ds_read_b64_tr_b16 v[110:111], v15 offset:34816
    v_mfma_f32_16x16x32_bf16 v[64:67], v[92:95], v[80:83], v[64:67]
    s_waitcnt lgkmcnt(8)
    s_waitcnt lgkmcnt(6)
    v_mfma_f32_16x16x32_bf16 v[20:23], v[112:115], v[96:99], v[20:23]
    v_mfma_f32_16x16x32_bf16 v[24:27], v[116:119], v[96:99], v[24:27]
    v_mfma_f32_16x16x32_bf16 v[28:31], v[120:123], v[96:99], v[28:31]
    s_waitcnt lgkmcnt(4)
    v_mfma_f32_16x16x32_bf16 v[32:35], v[112:115], v[100:103], v[32:35]
    v_mfma_f32_16x16x32_bf16 v[36:39], v[116:119], v[100:103], v[36:39]
    v_mfma_f32_16x16x32_bf16 v[40:43], v[120:123], v[100:103], v[40:43]
    s_waitcnt lgkmcnt(2)
    v_mfma_f32_16x16x32_bf16 v[44:47], v[112:115], v[104:107], v[44:47]
    v_mfma_f32_16x16x32_bf16 v[48:51], v[116:119], v[104:107], v[48:51]
    v_mfma_f32_16x16x32_bf16 v[52:55], v[120:123], v[104:107], v[52:55]
    s_waitcnt lgkmcnt(0)
    v_mfma_f32_16x16x32_bf16 v[56:59], v[112:115], v[108:111], v[56:59]
    v_mfma_f32_16x16x32_bf16 v[60:63], v[116:119], v[108:111], v[60:63]
    v_mfma_f32_16x16x32_bf16 v[64:67], v[120:123], v[108:111], v[64:67]
    v_cmp_gt_u32 vcc, 4, v9
    s_nop 0
    s_cbranch_vccz K3O_OK
    s_mov_b32 s15, 0
K3O_PL:
    global_load_dword v9, v8, s[42:43] sc1
    s_waitcnt vmcnt(0)
    v_cmp_gt_u32 vcc, 4, v9
    s_add_u32 s15, s15, 1
    s_cbranch_vccz K3O_OK
    s_sleep 2
    s_cmp_lt_u32 s15, 0x20000
    s_cbranch_scc1 K3O_PL
K3O_OK:
    v_mov_b32 v8, 163808
    v_mov_b32 v10, 1
    s_mul_i32 s12, s3, 12288
    s_add_u32 s12, s12, 101888
    v_lshl_add_u32 v11, v1, 4, s12
    s_lshl_b32 s12, s3, 7
    s_add_u32 s12, s12, 96256
    v_lshl_add_u32 v17, v2, 3, s12
    v_lshlrev_b32 v18, 4, v3
    v_add_u32 v18, 96768, v18
    v_mov_b32 v120, 0xc0135761
    v_mov_b32 v121, 0xbdd2d3e8
    ds_write_b128 v16, v[20:23] offset:0
    ds_write_b128 v16, v[24:27] offset:1024
    ds_write_b128 v16, v[28:31] offset:2048
    ds_write_b128 v16, v[32:35] offset:12288
    ds_write_b128 v16, v[36:39] offset:13312
    ds_write_b128 v16, v[40:43] offset:14336
    ds_write_b128 v16, v[44:47] offset:24576
    ds_write_b128 v16, v[48:51] offset:25600
    ds_write_b128 v16, v[52:55] offset:26624
    ds_write_b128 v16, v[56:59] offset:36864
    ds_write_b128 v16, v[60:63] offset:37888
    ds_write_b128 v16, v[64:67] offset:38912
    s_mov_b64 exec, 1
    ds_add_u32 v8, v10
    s_mov_b64 exec, -1
    ds_read_b64 v[122:123], v17
    ds_read_b128 v[80:83], v18 offset:0
    ds_read_b128 v[84:87], v18 offset:64
    ds_read_b128 v[88:91], v18 offset:128
    ds_read_b128 v[92:95], v18 offset:256
    ds_read_b128 v[96:99], v18 offset:320
    ds_read_b128 v[100:103], v18 offset:384
K3_YW:
    ds_read_b32 v10, v8
    s_waitcnt lgkmcnt(0)
    v_readfirstlane_b32 s12, v10
    s_nop 0
    s_cmp_lt_u32 s12, 4
    s_cbranch_scc1 K3_YW
    ds_read_b128 v[32:35], v11 offset:0
    ds_read_b128 v[36:39], v11 offset:6144
    ds_read_b128 v[40:43], v11 offset:1024
    ds_read_b128 v[44:47], v11 offset:7168
    ds_read_b128 v[48:51], v11 offset:2048
    ds_read_b128 v[52:55], v11 offset:8192
    ds_read_b128 v[56:59], v11 offset:3072
    ds_read_b128 v[60:63], v11 offset:9216
    ds_read_b128 v[64:67], v11 offset:4096
    ds_read_b128 v[68:71], v11 offset:10240
    ds_read_b128 v[72:75], v11 offset:5120
    ds_read_b128 v[76:79], v11 offset:11264
    s_waitcnt lgkmcnt(0)
    s_barrier
    v_pk_add_f32 v[32:33], v[32:33], v[36:37]
    v_pk_add_f32 v[34:35], v[34:35], v[38:39]
    v_pk_fma_f32 v[32:33], v[80:81], v[122:123], v[32:33] op_sel:[0,0,0] op_sel_hi:[1,0,1] neg_lo:[1,0,0] neg_hi:[1,0,0]
    v_pk_fma_f32 v[34:35], v[82:83], v[122:123], v[34:35] op_sel:[0,0,0] op_sel_hi:[1,0,1] neg_lo:[1,0,0] neg_hi:[1,0,0]
    v_pk_mul_f32 v[32:33], v[32:33], v[122:123] op_sel:[0,1] op_sel_hi:[1,1]
    v_pk_mul_f32 v[34:35], v[34:35], v[122:123] op_sel:[0,1] op_sel_hi:[1,1]
    v_pk_mul_f32 v[116:117], v[32:33], v[32:33]
    v_pk_mul_f32 v[118:119], v[34:35], v[34:35]
    v_pk_fma_f32 v[116:117], v[116:117], v[120:121], v[120:121] op_sel:[0,1,0] op_sel_hi:[1,1,0]
    v_pk_fma_f32 v[118:119], v[118:119], v[120:121], v[120:121] op_sel:[0,1,0] op_sel_hi:[1,1,0]
    v_pk_mul_f32 v[116:117], v[116:117], v[32:33]
    v_pk_mul_f32 v[118:119], v[118:119], v[34:35]
    v_exp_f32 v116, v116
    v_exp_f32 v117, v117
    v_exp_f32 v118, v118
    v_exp_f32 v119, v119
    v_add_f32 v116, 1.0, v116
    v_add_f32 v117, 1.0, v117
    v_add_f32 v118, 1.0, v118
    v_add_f32 v119, 1.0, v119
    v_rcp_f32 v116, v116
    v_rcp_f32 v117, v117
    v_rcp_f32 v118, v118
    v_rcp_f32 v119, v119
    v_pk_mul_f32 v[32:33], v[32:33], v[116:117]
    v_pk_mul_f32 v[34:35], v[34:35], v[118:119]
    v_cvt_pk_bf16_f32 v20, v32, v33
    v_cvt_pk_bf16_f32 v21, v34, v35
    v_pk_add_f32 v[40:41], v[40:41], v[44:45]
    v_pk_add_f32 v[42:43], v[42:43], v[46:47]
    v_pk_fma_f32 v[40:41], v[84:85], v[122:123], v[40:41] op_sel:[0,0,0] op_sel_hi:[1,0,1] neg_lo:[1,0,0] neg_hi:[1,0,0]
    v_pk_fma_f32 v[42:43], v[86:87], v[122:123], v[42:43] op_sel:[0,0,0] op_sel_hi:[1,0,1] neg_lo:[1,0,0] neg_hi:[1,0,0]
    v_pk_mul_f32 v[40:41], v[40:41], v[122:123] op_sel:[0,1] op_sel_hi:[1,1]
    v_pk_mul_f32 v[42:43], v[42:43], v[122:123] op_sel:[0,1] op_sel_hi:[1,1]
    v_pk_mul_f32 v[116:117], v[40:41], v[40:41]
    v_pk_mul_f32 v[118:119], v[42:43], v[42:43]
    v_pk_fma_f32 v[116:117], v[116:117], v[120:121], v[120:121] op_sel:[0,1,0] op_sel_hi:[1,1,0]
    v_pk_fma_f32 v[118:119], v[118:119], v[120:121], v[120:121] op_sel:[0,1,0] op_sel_hi:[1,1,0]
    v_pk_mul_f32 v[116:117], v[116:117], v[40:41]
    v_pk_mul_f32 v[118:119], v[118:119], v[42:43]
    v_exp_f32 v116, v116
    v_exp_f32 v117, v117
    v_exp_f32 v118, v118
    v_exp_f32 v119, v119
    v_add_f32 v116, 1.0, v116
    v_add_f32 v117, 1.0, v117
    v_add_f32 v118, 1.0, v118
    v_add_f32 v119, 1.0, v119
    v_rcp_f32 v116, v116
    v_rcp_f32 v117, v117
    v_rcp_f32 v118, v118
    v_rcp_f32 v119, v119
    v_pk_mul_f32 v[40:41], v[40:41], v[116:117]
    v_pk_mul_f32 v[42:43], v[42:43], v[118:119]
    v_cvt_pk_bf16_f32 v22, v40, v41
    v_cvt_pk_bf16_f32 v23, v42, v43
    v_pk_add_f32 v[48:49], v[48:49], v[52:53]
    v_pk_add_f32 v[50:51], v[50:51], v[54:55]
    v_pk_fma_f32 v[48:49], v[88:89], v[122:123], v[48:49] op_sel:[0,0,0] op_sel_hi:[1,0,1] neg_lo:[1,0,0] neg_hi:[1,0,0]
    v_pk_fma_f32 v[50:51], v[90:91], v[122:123], v[50:51] op_sel:[0,0,0] op_sel_hi:[1,0,1] neg_lo:[1,0,0] neg_hi:[1,0,0]
    v_pk_mul_f32 v[48:49], v[48:49], v[122:123] op_sel:[0,1] op_sel_hi:[1,1]
    v_pk_mul_f32 v[50:51], v[50:51], v[122:123] op_sel:[0,1] op_sel_hi:[1,1]
    v_pk_mul_f32 v[116:117], v[48:49], v[48:49]
    v_pk_mul_f32 v[118:119], v[50:51], v[50:51]
    v_pk_fma_f32 v[116:117], v[116:117], v[120:121], v[120:121] op_sel:[0,1,0] op_sel_hi:[1,1,0]
    v_pk_fma_f32 v[118:119], v[118:119], v[120:121], v[120:121] op_sel:[0,1,0] op_sel_hi:[1,1,0]
    v_pk_mul_f32 v[116:117], v[116:117], v[48:49]
    v_pk_mul_f32 v[118:119], v[118:119], v[50:51]
    v_exp_f32 v116, v116
    v_exp_f32 v117, v117
    v_exp_f32 v118, v118
    v_exp_f32 v119, v119
    v_add_f32 v116, 1.0, v116
    v_add_f32 v117, 1.0, v117
    v_add_f32 v118, 1.0, v118
    v_add_f32 v119, 1.0, v119
    v_rcp_f32 v116, v116
    v_rcp_f32 v117, v117
    v_rcp_f32 v118, v118
    v_rcp_f32 v119, v119
    v_pk_mul_f32 v[48:49], v[48:49], v[116:117]
    v_pk_mul_f32 v[50:51], v[50:51], v[118:119]
    v_cvt_pk_bf16_f32 v24, v48, v49
    v_cvt_pk_bf16_f32 v25, v50, v51
    v_pk_add_f32 v[56:57], v[56:57], v[60:61]
    v_pk_add_f32 v[58:59], v[58:59], v[62:63]
    v_pk_fma_f32 v[56:57], v[92:93], v[122:123], v[56:57] op_sel:[0,0,0] op_sel_hi:[1,0,1] neg_lo:[1,0,0] neg_hi:[1,0,0]
    v_pk_fma_f32 v[58:59], v[94:95], v[122:123], v[58:59] op_sel:[0,0,0] op_sel_hi:[1,0,1] neg_lo:[1,0,0] neg_hi:[1,0,0]
    v_pk_mul_f32 v[56:57], v[56:57], v[122:123] op_sel:[0,1] op_sel_hi:[1,1]
    v_pk_mul_f32 v[58:59], v[58:59], v[122:123] op_sel:[0,1] op_sel_hi:[1,1]
    v_pk_mul_f32 v[116:117], v[56:57], v[56:57]
    v_pk_mul_f32 v[118:119], v[58:59], v[58:59]
    v_pk_fma_f32 v[116:117], v[116:117], v[120:121], v[120:121] op_sel:[0,1,0] op_sel_hi:[1,1,0]
    v_pk_fma_f32 v[118:119], v[118:119], v[120:121], v[120:121] op_sel:[0,1,0] op_sel_hi:[1,1,0]
    v_pk_mul_f32 v[116:117], v[116:117], v[56:57]
    v_pk_mul_f32 v[118:119], v[118:119], v[58:59]
    v_exp_f32 v116, v116
    v_exp_f32 v117, v117
    v_exp_f32 v118, v118
    v_exp_f32 v119, v119
    v_add_f32 v116, 1.0, v116
    v_add_f32 v117, 1.0, v117
    v_add_f32 v118, 1.0, v118
    v_add_f32 v119, 1.0, v119
    v_rcp_f32 v116, v116
    v_rcp_f32 v117, v117
    v_rcp_f32 v118, v118
    v_rcp_f32 v119, v119
    v_pk_mul_f32 v[56:57], v[56:57], v[116:117]
    v_pk_mul_f32 v[58:59], v[58:59], v[118:119]
    v_cvt_pk_bf16_f32 v26, v56, v57
    v_cvt_pk_bf16_f32 v27, v58, v59
    v_pk_add_f32 v[64:65], v[64:65], v[68:69]
    v_pk_add_f32 v[66:67], v[66:67], v[70:71]
    v_pk_fma_f32 v[64:65], v[96:97], v[122:123], v[64:65] op_sel:[0,0,0] op_sel_hi:[1,0,1] neg_lo:[1,0,0] neg_hi:[1,0,0]
    v_pk_fma_f32 v[66:67], v[98:99], v[122:123], v[66:67] op_sel:[0,0,0] op_sel_hi:[1,0,1] neg_lo:[1,0,0] neg_hi:[1,0,0]
    v_pk_mul_f32 v[64:65], v[64:65], v[122:123] op_sel:[0,1] op_sel_hi:[1,1]
    v_pk_mul_f32 v[66:67], v[66:67], v[122:123] op_sel:[0,1] op_sel_hi:[1,1]
    v_pk_mul_f32 v[116:117], v[64:65], v[64:65]
    v_pk_mul_f32 v[118:119], v[66:67], v[66:67]
    v_pk_fma_f32 v[116:117], v[116:117], v[120:121], v[120:121] op_sel:[0,1,0] op_sel_hi:[1,1,0]
    v_pk_fma_f32 v[118:119], v[118:119], v[120:121], v[120:121] op_sel:[0,1,0] op_sel_hi:[1,1,0]
    v_pk_mul_f32 v[116:117], v[116:117], v[64:65]
    v_pk_mul_f32 v[118:119], v[118:119], v[66:67]
    v_exp_f32 v116, v116
    v_exp_f32 v117, v117
    v_exp_f32 v118, v118
    v_exp_f32 v119, v119
    v_add_f32 v116, 1.0, v116
    v_add_f32 v117, 1.0, v117
    v_add_f32 v118, 1.0, v118
    v_add_f32 v119, 1.0, v119
    v_rcp_f32 v116, v116
    v_rcp_f32 v117, v117
    v_rcp_f32 v118, v118
    v_rcp_f32 v119, v119
    v_pk_mul_f32 v[64:65], v[64:65], v[116:117]
    v_pk_mul_f32 v[66:67], v[66:67], v[118:119]
    v_cvt_pk_bf16_f32 v28, v64, v65
    v_cvt_pk_bf16_f32 v29, v66, v67
    v_pk_add_f32 v[72:73], v[72:73], v[76:77]
    v_pk_add_f32 v[74:75], v[74:75], v[78:79]
    v_pk_fma_f32 v[72:73], v[100:101], v[122:123], v[72:73] op_sel:[0,0,0] op_sel_hi:[1,0,1] neg_lo:[1,0,0] neg_hi:[1,0,0]
    v_pk_fma_f32 v[74:75], v[102:103], v[122:123], v[74:75] op_sel:[0,0,0] op_sel_hi:[1,0,1] neg_lo:[1,0,0] neg_hi:[1,0,0]
    v_pk_mul_f32 v[72:73], v[72:73], v[122:123] op_sel:[0,1] op_sel_hi:[1,1]
    v_pk_mul_f32 v[74:75], v[74:75], v[122:123] op_sel:[0,1] op_sel_hi:[1,1]
    v_pk_mul_f32 v[116:117], v[72:73], v[72:73]
    v_pk_mul_f32 v[118:119], v[74:75], v[74:75]
    v_pk_fma_f32 v[116:117], v[116:117], v[120:121], v[120:121] op_sel:[0,1,0] op_sel_hi:[1,1,0]
    v_pk_fma_f32 v[118:119], v[118:119], v[120:121], v[120:121] op_sel:[0,1,0] op_sel_hi:[1,1,0]
    v_pk_mul_f32 v[116:117], v[116:117], v[72:73]
    v_pk_mul_f32 v[118:119], v[118:119], v[74:75]
    v_exp_f32 v116, v116
    v_exp_f32 v117, v117
    v_exp_f32 v118, v118
    v_exp_f32 v119, v119
    v_add_f32 v116, 1.0, v116
    v_add_f32 v117, 1.0, v117
    v_add_f32 v118, 1.0, v118
    v_add_f32 v119, 1.0, v119
    v_rcp_f32 v116, v116
    v_rcp_f32 v117, v117
    v_rcp_f32 v118, v118
    v_rcp_f32 v119, v119
    v_pk_mul_f32 v[72:73], v[72:73], v[116:117]
    v_pk_mul_f32 v[74:75], v[74:75], v[118:119]
    v_cvt_pk_bf16_f32 v30, v72, v73
    v_cvt_pk_bf16_f32 v31, v74, v75
PH4:
    s_lshr_b32 s60, s8, 2
    s_lshl_b32 s60, s60, 1
    s_add_u32 s60, s60, s11
    s_mul_i32 s12, s60, 6144
    v_lshl_add_u32 v12, v1, 4, s12
    v_add_u32 v13, 49152, v12
    s_mul_i32 s13, s10, 3072
    s_add_u32 s61, s12, s13
    s_mul_i32 s12, s60, 98304
    s_add_u32 s12, s12, s13
    s_mul_i32 s13, s47, 393216
    s_add_u32 s12, s12, s13
    v_lshl_add_u32 v6, v1, 4, s12
    v_lshlrev_b32 v16, 16, v126
    s_add_u32 s52, s42, 3145728
    s_addc_u32 s53, s43, 0
    s_mov_b32 s54, 3145728
    s_mov_b32 s55, 0x20000
    s_mul_i32 s12, s3, 9216
    s_add_u32 s12, s12, 61440
    v_lshl_add_u32 v9, v1, 4, s12
    s_xor_b32 s12, s3, 1
    s_mul_i32 s12, s12, 9216
    s_add_u32 s12, s12, 61440
    v_lshl_add_u32 v7, v1, 4, s12
    s_mul_i32 s62, s3, 5120
    s_mul_i32 s12, s47, 122880
    s_add_u32 s12, s12, s62
    v_lshl_add_u32 v4, v1, 4, s12
    s_add_u32 s64, s42, 11403264
    s_addc_u32 s65, s43, 0
    s_mov_b32 s66, 983040
    s_mov_b32 s67, 0x20000
    s_cmp_lg_u32 s8, 0
    s_cbranch_scc1 S2_OK
    s_lshl_b32 s12, s47, 10
    s_add_u32 s12, s12, 2635776
    v_and_b32 v10, 7, v1
    v_lshlrev_b32 v10, 7, v10
    v_add_u32 v10, s12, v10
    s_mov_b32 s15, 0
S2_PL:
    global_load_dword v11, v10, s[42:43] sc1
    s_waitcnt vmcnt(0)
    v_cmp_gt_u32 vcc, 4, v11
    s_add_u32 s15, s15, 1
    s_cbranch_vccz S2_OK
    s_sleep 1
    s_cmp_lt_u32 s15, 0x20000
    s_cbranch_scc1 S2_PL
S2_OK:
    s_waitcnt lgkmcnt(0)
    s_barrier
    s_add_u32 m0, s61, 0
    s_mov_b32 s57, 0
    buffer_load_dwordx4 v6, s[52:55], s57 offen sc1 lds
    buffer_load_dwordx4 v6, s[52:55], s57 offen offset:1024 sc1 lds
    buffer_load_dwordx4 v6, s[52:55], s57 offen offset:2048 sc1 lds
    s_add_u32 m0, s61, 24576
    s_mov_b32 s57, 6144
    buffer_load_dwordx4 v6, s[52:55], s57 offen sc1 lds
    buffer_load_dwordx4 v6, s[52:55], s57 offen offset:1024 sc1 lds
    buffer_load_dwordx4 v6, s[52:55], s57 offen offset:2048 sc1 lds
    s_add_u32 m0, s61, 49152
    s_mov_b32 s57, 12288
    buffer_load_dwordx4 v6, s[52:55], s57 offen sc1 lds
    buffer_load_dwordx4 v6, s[52:55], s57 offen offset:1024 sc1 lds
    buffer_load_dwordx4 v6, s[52:55], s57 offen offset:2048 sc1 lds
    s_waitcnt vmcnt(6)
    s_barrier
    ds_read_b128 v[80:83], v12 offset:0
    ds_read_b128 v[84:87], v12 offset:1024
    ds_read_b128 v[88:91], v12 offset:2048
    ds_read_b128 v[92:95], v12 offset:3072
    ds_read_b128 v[96:99], v12 offset:4096
    ds_read_b128 v[100:103], v12 offset:5120
    s_add_u32 m0, s61, 73728
    s_mov_b32 s57, 18432
    buffer_load_dwordx4 v6, s[52:55], s57 offen sc1 lds
    buffer_load_dwordx4 v6, s[52:55], s57 offen offset:1024 sc1 lds
    buffer_load_dwordx4 v6, s[52:55], s57 offen offset:2048 sc1 lds
    s_cmp_ge_u32 s8, 4
    s_cbranch_scc1 K4_Y
    s_mul_i32 s13, s11, 3072
    v_add_u32 v7, s13, v7
    v_add_u32 v9, s13, v9
    s_waitcnt vmcnt(6) lgkmcnt(0)
    s_barrier
    s_add_u32 m0, s61, 0
    s_mov_b32 s57, 24576
    buffer_load_dwordx4 v6, s[52:55], s57 offen sc1 lds
    buffer_load_dwordx4 v6, s[52:55], s57 offen offset:1024 sc1 lds
    buffer_load_dwordx4 v6, s[52:55], s57 offen offset:2048 sc1 lds
    v_mfma_f32_16x16x32_bf16 v[32:35], v[80:83], v[128:131], 0
    ds_read_b128 v[104:107], v12 offset:24576
    v_mfma_f32_16x16x32_bf16 v[56:59], v[80:83], v[192:195], 0
    ds_read_b128 v[108:111], v12 offset:25600
    v_mfma_f32_16x16x32_bf16 v[36:39], v[84:87], v[128:131], 0
    ds_read_b128 v[112:115], v12 offset:26624
    v_mfma_f32_16x16x32_bf16 v[60:63], v[84:87], v[192:195], 0
    ds_read_b128 v[116:119], v12 offset:27648
    v_mfma_f32_16x16x32_bf16 v[40:43], v[88:91], v[128:131], 0
    ds_read_b128 v[120:123], v12 offset:28672
    v_mfma_f32_16x16x32_bf16 v[64:67], v[88:91], v[192:195], 0
    ds_read_b128 v[124:127], v12 offset:29696
    v_mfma_f32_16x16x32_bf16 v[44:47], v[92:95], v[128:131], 0
    v_mfma_f32_16x16x32_bf16 v[68:71], v[92:95], v[192:195], 0
    v_mfma_f32_16x16x32_bf16 v[48:51], v[96:99], v[128:131], 0
    v_mfma_f32_16x16x32_bf16 v[72:75], v[96:99], v[192:195], 0
    v_mfma_f32_16x16x32_bf16 v[52:55], v[100:103], v[128:131], 0
    v_mfma_f32_16x16x32_bf16 v[76:79], v[100:103], v[192:195], 0
    s_waitcnt vmcnt(6) lgkmcnt(0)
    s_barrier
    s_add_u32 m0, s61, 24576
    s_mov_b32 s57, 30720
    buffer_load_dwordx4 v6, s[52:55], s57 offen sc1 lds
    buffer_load_dwordx4 v6, s[52:55], s57 offen offset:1024 sc1 lds
    buffer_load_dwordx4 v6, s[52:55], s57 offen offset:2048 sc1 lds
    v_mfma_f32_16x16x32_bf16 v[32:35], v[104:107], v[132:135], v[32:35]
    ds_read_b128 v[80:83], v13 offset:0
    v_mfma_f32_16x16x32_bf16 v[56:59], v[104:107], v[196:199], v[56:59]
    ds_read_b128 v[84:87], v13 offset:1024
    v_mfma_f32_16x16x32_bf16 v[36:39], v[108:111], v[132:135], v[36:39]
    ds_read_b128 v[88:91], v13 offset:2048
    v_mfma_f32_16x16x32_bf16 v[60:63], v[108:111], v[196:199], v[60:63]
    ds_read_b128 v[92:95], v13 offset:3072
    v_mfma_f32_16x16x32_bf16 v[40:43], v[112:115], v[132:135], v[40:43]
    ds_read_b128 v[96:99], v13 offset:4096
    v_mfma_f32_16x16x32_bf16 v[64:67], v[112:115], v[196:199], v[64:67]
    ds_read_b128 v[100:103], v13 offset:5120
    v_mfma_f32_16x16x32_bf16 v[44:47], v[116:119], v[132:135], v[44:47]
    v_mfma_f32_16x16x32_bf16 v[68:71], v[116:119], v[196:199], v[68:71]
    v_mfma_f32_16x16x32_bf16 v[48:51], v[120:123], v[132:135], v[48:51]
    v_mfma_f32_16x16x32_bf16 v[72:75], v[120:123], v[196:199], v[72:75]
    v_mfma_f32_16x16x32_bf16 v[52:55], v[124:127], v[132:135], v[52:55]
    v_mfma_f32_16x16x32_bf16 v[76:79], v[124:127], v[196:199], v[76:79]
    s_waitcnt vmcnt(6) lgkmcnt(0)
    s_barrier
    s_add_u32 m0, s61, 49152
    s_mov_b32 s57, 36864
    buffer_load_dwordx4 v6, s[52:55], s57 offen sc1 lds
    buffer_load_dwordx4 v6, s[52:55], s57 offen offset:1024 sc1 lds
    buffer_load_dwordx4 v6, s[52:55], s57 offen offset:2048 sc1 lds
    v_mfma_f32_16x16x32_bf16 v[32:35], v[80:83], v[136:139], v[32:35]
    ds_read_b128 v[104:107], v13 offset:24576
    v_mfma_f32_16x16x32_bf16 v[56:59], v[80:83], v[200:203], v[56:59]
    ds_read_b128 v[108:111], v13 offset:25600
    v_mfma_f32_16x16x32_bf16 v[36:39], v[84:87], v[136:139], v[36:39]
    ds_read_b128 v[112:115], v13 offset:26624
    v_mfma_f32_16x16x32_bf16 v[60:63], v[84:87], v[200:203], v[60:63]
    ds_read_b128 v[116:119], v13 offset:27648
    v_mfma_f32_16x16x32_bf16 v[40:43], v[88:91], v[136:139], v[40:43]
    ds_read_b128 v[120:123], v13 offset:28672
    v_mfma_f32_16x16x32_bf16 v[64:67], v[88:91], v[200:203], v[64:67]
    ds_read_b128 v[124:127], v13 offset:29696
    v_mfma_f32_16x16x32_bf16 v[44:47], v[92:95], v[136:139], v[44:47]
    v_mfma_f32_16x16x32_bf16 v[68:71], v[92:95], v[200:203], v[68:71]
    v_mfma_f32_16x16x32_bf16 v[48:51], v[96:99], v[136:139], v[48:51]
    v_mfma_f32_16x16x32_bf16 v[72:75], v[96:99], v[200:203], v[72:75]
    v_mfma_f32_16x16x32_bf16 v[52:55], v[100:103], v[136:139], v[52:55]
    v_mfma_f32_16x16x32_bf16 v[76:79], v[100:103], v[200:203], v[76:79]
    s_waitcnt vmcnt(6) lgkmcnt(0)
    s_barrier
    s_add_u32 m0, s61, 73728
    s_mov_b32 s57, 43008
    buffer_load_dwordx4 v6, s[52:55], s57 offen sc1 lds
    buffer_load_dwordx4 v6, s[52:55], s57 offen offset:1024 sc1 lds
    buffer_load_dwordx4 v6, s[52:55], s57 offen offset:2048 sc1 lds
    v_mfma_f32_16x16x32_bf16 v[32:35], v[104:107], v[140:143], v[32:35]
    ds_read_b128 v[80:83], v12 offset:0
    v_mfma_f32_16x16x32_bf16 v[56:59], v[104:107], v[204:207], v[56:59]
    ds_read_b128 v[84:87], v12 offset:1024
    v_mfma_f32_16x16x32_bf16 v[36:39], v[108:111], v[140:143], v[36:39]
    ds_read_b128 v[88:91], v12 offset:2048
    v_mfma_f32_16x16x32_bf16 v[60:63], v[108:111], v[204:207], v[60:63]
    ds_read_b128 v[92:95], v12 offset:3072
    v_mfma_f32_16x16x32_bf16 v[40:43], v[112:115], v[140:143], v[40:43]
    ds_read_b128 v[96:99], v12 offset:4096
    v_mfma_f32_16x16x32_bf16 v[64:67], v[112:115], v[204:207], v[64:67]
    ds_read_b128 v[100:103], v12 offset:5120
    v_mfma_f32_16x16x32_bf16 v[44:47], v[116:119], v[140:143], v[44:47]
    v_mfma_f32_16x16x32_bf16 v[68:71], v[116:119], v[204:207], v[68:71]
    v_mfma_f32_16x16x32_bf16 v[48:51], v[120:123], v[140:143], v[48:51]
    v_mfma_f32_16x16x32_bf16 v[72:75], v[120:123], v[204:207], v[72:75]
    v_mfma_f32_16x16x32_bf16 v[52:55], v[124:127], v[140:143], v[52:55]
    v_mfma_f32_16x16x32_bf16 v[76:79], v[124:127], v[204:207], v[76:79]
    s_waitcnt vmcnt(6) lgkmcnt(0)
    s_barrier
    s_add_u32 m0, s61, 0
    s_mov_b32 s57, 49152
    buffer_load_dwordx4 v6, s[52:55], s57 offen sc1 lds
    buffer_load_dwordx4 v6, s[52:55], s57 offen offset:1024 sc1 lds
    buffer_load_dwordx4 v6, s[52:55], s57 offen offset:2048 sc1 lds
    v_mfma_f32_16x16x32_bf16 v[32:35], v[80:83], v[144:147], v[32:35]
    ds_read_b128 v[104:107], v12 offset:24576
    v_mfma_f32_16x16x32_bf16 v[56:59], v[80:83], v[208:211], v[56:59]
    ds_read_b128 v[108:111], v12 offset:25600
    v_mfma_f32_16x16x32_bf16 v[36:39], v[84:87], v[144:147], v[36:39]
    ds_read_b128 v[112:115], v12 offset:26624
    v_mfma_f32_16x16x32_bf16 v[60:63], v[84:87], v[208:211], v[60:63]
    ds_read_b128 v[116:119], v12 offset:27648
    v_mfma_f32_16x16x32_bf16 v[40:43], v[88:91], v[144:147], v[40:43]
    ds_read_b128 v[120:123], v12 offset:28672
    v_mfma_f32_16x16x32_bf16 v[64:67], v[88:91], v[208:211], v[64:67]
    ds_read_b128 v[124:127], v12 offset:29696
    v_mfma_f32_16x16x32_bf16 v[44:47], v[92:95], v[144:147], v[44:47]
    v_mfma_f32_16x16x32_bf16 v[68:71], v[92:95], v[208:211], v[68:71]
    v_mfma_f32_16x16x32_bf16 v[48:51], v[96:99], v[144:147], v[48:51]
    v_mfma_f32_16x16x32_bf16 v[72:75], v[96:99], v[208:211], v[72:75]
    v_mfma_f32_16x16x32_bf16 v[52:55], v[100:103], v[144:147], v[52:55]
    v_mfma_f32_16x16x32_bf16 v[76:79], v[100:103], v[208:211], v[76:79]
    s_waitcnt vmcnt(6) lgkmcnt(0)
    s_barrier
    s_add_u32 m0, s61, 24576
    s_mov_b32 s57, 55296
    buffer_load_dwordx4 v6, s[52:55], s57 offen sc1 lds
    buffer_load_dwordx4 v6, s[52:55], s57 offen offset:1024 sc1 lds
    buffer_load_dwordx4 v6, s[52:55], s57 offen offset:2048 sc1 lds
    v_mfma_f32_16x16x32_bf16 v[32:35], v[104:107], v[148:151], v[32:35]
    ds_read_b128 v[80:83], v13 offset:0
    v_mfma_f32_16x16x32_bf16 v[56:59], v[104:107], v[212:215], v[56:59]
    ds_read_b128 v[84:87], v13 offset:1024
    v_mfma_f32_16x16x32_bf16 v[36:39], v[108:111], v[148:151], v[36:39]
    ds_read_b128 v[88:91], v13 offset:2048
    v_mfma_f32_16x16x32_bf16 v[60:63], v[108:111], v[212:215], v[60:63]
    ds_read_b128 v[92:95], v13 offset:3072
    v_mfma_f32_16x16x32_bf16 v[40:43], v[112:115], v[148:151], v[40:43]
    ds_read_b128 v[96:99], v13 offset:4096
    v_mfma_f32_16x16x32_bf16 v[64:67], v[112:115], v[212:215], v[64:67]
    ds_read_b128 v[100:103], v13 offset:5120
    v_mfma_f32_16x16x32_bf16 v[44:47], v[116:119], v[148:151], v[44:47]
    v_mfma_f32_16x16x32_bf16 v[68:71], v[116:119], v[212:215], v[68:71]
    v_mfma_f32_16x16x32_bf16 v[48:51], v[120:123], v[148:151], v[48:51]
    v_mfma_f32_16x16x32_bf16 v[72:75], v[120:123], v[212:215], v[72:75]
    v_mfma_f32_16x16x32_bf16 v[52:55], v[124:127], v[148:151], v[52:55]
    v_mfma_f32_16x16x32_bf16 v[76:79], v[124:127], v[212:215], v[76:79]
    s_waitcnt vmcnt(6) lgkmcnt(0)
    s_barrier
    s_add_u32 m0, s61, 49152
    s_mov_b32 s57, 61440
    buffer_load_dwordx4 v6, s[52:55], s57 offen sc1 lds
    buffer_load_dwordx4 v6, s[52:55], s57 offen offset:1024 sc1 lds
    buffer_load_dwordx4 v6, s[52:55], s57 offen offset:2048 sc1 lds
    v_mfma_f32_16x16x32_bf16 v[32:35], v[80:83], v[152:155], v[32:35]
    ds_read_b128 v[104:107], v13 offset:24576
    v_mfma_f32_16x16x32_bf16 v[56:59], v[80:83], v[216:219], v[56:59]
    ds_read_b128 v[108:111], v13 offset:25600
    v_mfma_f32_16x16x32_bf16 v[36:39], v[84:87], v[152:155], v[36:39]
    ds_read_b128 v[112:115], v13 offset:26624
    v_mfma_f32_16x16x32_bf16 v[60:63], v[84:87], v[216:219], v[60:63]
    ds_read_b128 v[116:119], v13 offset:27648
    v_mfma_f32_16x16x32_bf16 v[40:43], v[88:91], v[152:155], v[40:43]
    ds_read_b128 v[120:123], v13 offset:28672
    v_mfma_f32_16x16x32_bf16 v[64:67], v[88:91], v[216:219], v[64:67]
    ds_read_b128 v[124:127], v13 offset:29696
    v_mfma_f32_16x16x32_bf16 v[44:47], v[92:95], v[152:155], v[44:47]
    v_mfma_f32_16x16x32_bf16 v[68:71], v[92:95], v[216:219], v[68:71]
    v_mfma_f32_16x16x32_bf16 v[48:51], v[96:99], v[152:155], v[48:51]
    v_mfma_f32_16x16x32_bf16 v[72:75], v[96:99], v[216:219], v[72:75]
    v_mfma_f32_16x16x32_bf16 v[52:55], v[100:103], v[152:155], v[52:55]
    v_mfma_f32_16x16x32_bf16 v[76:79], v[100:103], v[216:219], v[76:79]
    s_waitcnt vmcnt(6) lgkmcnt(0)
    s_barrier
    s_add_u32 m0, s61, 73728
    s_mov_b32 s57, 67584
    buffer_load_dwordx4 v6, s[52:55], s57 offen sc1 lds
    buffer_load_dwordx4 v6, s[52:55], s57 offen offset:1024 sc1 lds
    buffer_load_dwordx4 v6, s[52:55], s57 offen offset:2048 sc1 lds
    v_mfma_f32_16x16x32_bf16 v[32:35], v[104:107], v[156:159], v[32:35]
    ds_read_b128 v[80:83], v12 offset:0
    v_mfma_f32_16x16x32_bf16 v[56:59], v[104:107], v[220:223], v[56:59]
    ds_read_b128 v[84:87], v12 offset:1024
    v_mfma_f32_16x16x32_bf16 v[36:39], v[108:111], v[156:159], v[36:39]
    ds_read_b128 v[88:91], v12 offset:2048
    v_mfma_f32_16x16x32_bf16 v[60:63], v[108:111], v[220:223], v[60:63]
    ds_read_b128 v[92:95], v12 offset:3072
    v_mfma_f32_16x16x32_bf16 v[40:43], v[112:115], v[156:159], v[40:43]
    ds_read_b128 v[96:99], v12 offset:4096
    v_mfma_f32_16x16x32_bf16 v[64:67], v[112:115], v[220:223], v[64:67]
    ds_read_b128 v[100:103], v12 offset:5120
    v_mfma_f32_16x16x32_bf16 v[44:47], v[116:119], v[156:159], v[44:47]
    v_mfma_f32_16x16x32_bf16 v[68:71], v[116:119], v[220:223], v[68:71]
    v_mfma_f32_16x16x32_bf16 v[48:51], v[120:123], v[156:159], v[48:51]
    v_mfma_f32_16x16x32_bf16 v[72:75], v[120:123], v[220:223], v[72:75]
    v_mfma_f32_16x16x32_bf16 v[52:55], v[124:127], v[156:159], v[52:55]
    v_mfma_f32_16x16x32_bf16 v[76:79], v[124:127], v[220:223], v[76:79]
    s_waitcnt vmcnt(6) lgkmcnt(0)
    s_barrier
    s_add_u32 m0, s61, 0
    s_mov_b32 s57, 73728
    buffer_load_dwordx4 v6, s[52:55], s57 offen sc1 lds
    buffer_load_dwordx4 v6, s[52:55], s57 offen offset:1024 sc1 lds
    buffer_load_dwordx4 v6, s[52:55], s57 offen offset:2048 sc1 lds
    v_mfma_f32_16x16x32_bf16 v[32:35], v[80:83], v[160:163], v[32:35]
    ds_read_b128 v[104:107], v12 offset:24576
    v_mfma_f32_16x16x32_bf16 v[56:59], v[80:83], v[224:227], v[56:59]
    ds_read_b128 v[108:111], v12 offset:25600
    v_mfma_f32_16x16x32_bf16 v[36:39], v[84:87], v[160:163], v[36:39]
    ds_read_b128 v[112:115], v12 offset:26624
    v_mfma_f32_16x16x32_bf16 v[60:63], v[84:87], v[224:227], v[60:63]
    ds_read_b128 v[116:119], v12 offset:27648
    v_mfma_f32_16x16x32_bf16 v[40:43], v[88:91], v[160:163], v[40:43]
    ds_read_b128 v[120:123], v12 offset:28672
    v_mfma_f32_16x16x32_bf16 v[64:67], v[88:91], v[224:227], v[64:67]
    ds_read_b128 v[124:127], v12 offset:29696
    v_mfma_f32_16x16x32_bf16 v[44:47], v[92:95], v[160:163], v[44:47]
    v_mfma_f32_16x16x32_bf16 v[68:71], v[92:95], v[224:227], v[68:71]
    v_mfma_f32_16x16x32_bf16 v[48:51], v[96:99], v[160:163], v[48:51]
    v_mfma_f32_16x16x32_bf16 v[72:75], v[96:99], v[224:227], v[72:75]
    v_mfma_f32_16x16x32_bf16 v[52:55], v[100:103], v[160:163], v[52:55]
    v_mfma_f32_16x16x32_bf16 v[76:79], v[100:103], v[224:227], v[76:79]
    s_waitcnt vmcnt(6) lgkmcnt(0)
    s_barrier
    s_add_u32 m0, s61, 24576
    s_mov_b32 s57, 79872
    buffer_load_dwordx4 v6, s[52:55], s57 offen sc1 lds
    buffer_load_dwordx4 v6, s[52:55], s57 offen offset:1024 sc1 lds
    buffer_load_dwordx4 v6, s[52:55], s57 offen offset:2048 sc1 lds
    v_mfma_f32_16x16x32_bf16 v[32:35], v[104:107], v[164:167], v[32:35]
    ds_read_b128 v[80:83], v13 offset:0
    v_mfma_f32_16x16x32_bf16 v[56:59], v[104:107], v[228:231], v[56:59]
    ds_read_b128 v[84:87], v13 offset:1024
    v_mfma_f32_16x16x32_bf16 v[36:39], v[108:111], v[164:167], v[36:39]
    ds_read_b128 v[88:91], v13 offset:2048
    v_mfma_f32_16x16x32_bf16 v[60:63], v[108:111], v[228:231], v[60:63]
    ds_read_b128 v[92:95], v13 offset:3072
    v_mfma_f32_16x16x32_bf16 v[40:43], v[112:115], v[164:167], v[40:43]
    ds_read_b128 v[96:99], v13 offset:4096
    v_mfma_f32_16x16x32_bf16 v[64:67], v[112:115], v[228:231], v[64:67]
    ds_read_b128 v[100:103], v13 offset:5120
    v_mfma_f32_16x16x32_bf16 v[44:47], v[116:119], v[164:167], v[44:47]
    v_mfma_f32_16x16x32_bf16 v[68:71], v[116:119], v[228:231], v[68:71]
    v_mfma_f32_16x16x32_bf16 v[48:51], v[120:123], v[164:167], v[48:51]
    v_mfma_f32_16x16x32_bf16 v[72:75], v[120:123], v[228:231], v[72:75]
    v_mfma_f32_16x16x32_bf16 v[52:55], v[124:127], v[164:167], v[52:55]
    v_mfma_f32_16x16x32_bf16 v[76:79], v[124:127], v[228:231], v[76:79]
    s_waitcnt vmcnt(6) lgkmcnt(0)
    s_barrier
    s_add_u32 m0, s61, 49152
    s_mov_b32 s57, 86016
    buffer_load_dwordx4 v6, s[52:55], s57 offen sc1 lds
    buffer_load_dwordx4 v6, s[52:55], s57 offen offset:1024 sc1 lds
    buffer_load_dwordx4 v6, s[52:55], s57 offen offset:2048 sc1 lds
    v_mfma_f32_16x16x32_bf16 v[32:35], v[80:83], v[168:171], v[32:35]
    ds_read_b128 v[104:107], v13 offset:24576
    v_mfma_f32_16x16x32_bf16 v[56:59], v[80:83], v[232:235], v[56:59]
    ds_read_b128 v[108:111], v13 offset:25600
    v_mfma_f32_16x16x32_bf16 v[36:39], v[84:87], v[168:171], v[36:39]
    ds_read_b128 v[112:115], v13 offset:26624
    v_mfma_f32_16x16x32_bf16 v[60:63], v[84:87], v[232:235], v[60:63]
    ds_read_b128 v[116:119], v13 offset:27648
    v_mfma_f32_16x16x32_bf16 v[40:43], v[88:91], v[168:171], v[40:43]
    ds_read_b128 v[120:123], v13 offset:28672
    v_mfma_f32_16x16x32_bf16 v[64:67], v[88:91], v[232:235], v[64:67]
    ds_read_b128 v[124:127], v13 offset:29696
    v_mfma_f32_16x16x32_bf16 v[44:47], v[92:95], v[168:171], v[44:47]
    v_mfma_f32_16x16x32_bf16 v[68:71], v[92:95], v[232:235], v[68:71]
    v_mfma_f32_16x16x32_bf16 v[48:51], v[96:99], v[168:171], v[48:51]
    v_mfma_f32_16x16x32_bf16 v[72:75], v[96:99], v[232:235], v[72:75]
    v_mfma_f32_16x16x32_bf16 v[52:55], v[100:103], v[168:171], v[52:55]
    v_mfma_f32_16x16x32_bf16 v[76:79], v[100:103], v[232:235], v[76:79]
    s_waitcnt vmcnt(6) lgkmcnt(0)
    s_barrier
    s_add_u32 m0, s61, 73728
    s_mov_b32 s57, 92160
    buffer_load_dwordx4 v6, s[52:55], s57 offen sc1 lds
    buffer_load_dwordx4 v6, s[52:55], s57 offen offset:1024 sc1 lds
    buffer_load_dwordx4 v6, s[52:55], s57 offen offset:2048 sc1 lds
    v_mfma_f32_16x16x32_bf16 v[32:35], v[104:107], v[172:175], v[32:35]
    ds_read_b128 v[80:83], v12 offset:0
    v_mfma_f32_16x16x32_bf16 v[56:59], v[104:107], v[236:239], v[56:59]
    ds_read_b128 v[84:87], v12 offset:1024
    v_mfma_f32_16x16x32_bf16 v[36:39], v[108:111], v[172:175], v[36:39]
    ds_read_b128 v[88:91], v12 offset:2048
    v_mfma_f32_16x16x32_bf16 v[60:63], v[108:111], v[236:239], v[60:63]
    ds_read_b128 v[92:95], v12 offset:3072
    v_mfma_f32_16x16x32_bf16 v[40:43], v[112:115], v[172:175], v[40:43]
    ds_read_b128 v[96:99], v12 offset:4096
    v_mfma_f32_16x16x32_bf16 v[64:67], v[112:115], v[236:239], v[64:67]
    ds_read_b128 v[100:103], v12 offset:5120
    v_mfma_f32_16x16x32_bf16 v[44:47], v[116:119], v[172:175], v[44:47]
    v_mfma_f32_16x16x32_bf16 v[68:71], v[116:119], v[236:239], v[68:71]
    v_mfma_f32_16x16x32_bf16 v[48:51], v[120:123], v[172:175], v[48:51]
    v_mfma_f32_16x16x32_bf16 v[72:75], v[120:123], v[236:239], v[72:75]
    v_mfma_f32_16x16x32_bf16 v[52:55], v[124:127], v[172:175], v[52:55]
    v_mfma_f32_16x16x32_bf16 v[76:79], v[124:127], v[236:239], v[76:79]
    s_waitcnt vmcnt(6) lgkmcnt(0)
    s_barrier
    s_add_u32 m0, s62, 0
    s_mov_b32 s56, 61440
    buffer_load_dwordx4 v4, s[64:67], s56 offen offset:0 sc1 lds
    buffer_load_dwordx4 v4, s[64:67], s56 offen offset:1024 sc1 lds
    buffer_load_dwordx4 v4, s[64:67], s56 offen offset:2048 sc1 lds
    v_mfma_f32_16x16x32_bf16 v[32:35], v[80:83], v[176:179], v[32:35]
    ds_read_b128 v[104:107], v12 offset:24576
    v_mfma_f32_16x16x32_bf16 v[56:59], v[80:83], v[240:243], v[56:59]
    ds_read_b128 v[108:111], v12 offset:25600
    v_mfma_f32_16x16x32_bf16 v[36:39], v[84:87], v[176:179], v[36:39]
    ds_read_b128 v[112:115], v12 offset:26624
    v_mfma_f32_16x16x32_bf16 v[60:63], v[84:87], v[240:243], v[60:63]
    ds_read_b128 v[116:119], v12 offset:27648
    v_mfma_f32_16x16x32_bf16 v[40:43], v[88:91], v[176:179], v[40:43]
    ds_read_b128 v[120:123], v12 offset:28672
    v_mfma_f32_16x16x32_bf16 v[64:67], v[88:91], v[240:243], v[64:67]
    ds_read_b128 v[124:127], v12 offset:29696
    v_mfma_f32_16x16x32_bf16 v[44:47], v[92:95], v[176:179], v[44:47]
    v_mfma_f32_16x16x32_bf16 v[68:71], v[92:95], v[240:243], v[68:71]
    v_mfma_f32_16x16x32_bf16 v[48:51], v[96:99], v[176:179], v[48:51]
    v_mfma_f32_16x16x32_bf16 v[72:75], v[96:99], v[240:243], v[72:75]
    v_mfma_f32_16x16x32_bf16 v[52:55], v[100:103], v[176:179], v[52:55]
    v_mfma_f32_16x16x32_bf16 v[76:79], v[100:103], v[240:243], v[76:79]
    s_waitcnt vmcnt(6) lgkmcnt(0)
    s_barrier
    s_add_u32 m0, s62, 20480
    s_mov_b32 s56, 81920
    buffer_load_dwordx4 v4, s[64:67], s56 offen offset:0 sc1 lds
    buffer_load_dwordx4 v4, s[64:67], s56 offen offset:1024 sc1 lds
    buffer_load_dwordx4 v4, s[64:67], s56 offen offset:2048 sc1 lds
    v_mfma_f32_16x16x32_bf16 v[32:35], v[104:107], v[180:183], v[32:35]
    ds_read_b128 v[80:83], v13 offset:0
    v_mfma_f32_16x16x32_bf16 v[56:59], v[104:107], v[244:247], v[56:59]
    ds_read_b128 v[84:87], v13 offset:1024
    v_mfma_f32_16x16x32_bf16 v[36:39], v[108:111], v[180:183], v[36:39]
    ds_read_b128 v[88:91], v13 offset:2048
    v_mfma_f32_16x16x32_bf16 v[60:63], v[108:111], v[244:247], v[60:63]
    ds_read_b128 v[92:95], v13 offset:3072
    v_mfma_f32_16x16x32_bf16 v[40:43], v[112:115], v[180:183], v[40:43]
    ds_read_b128 v[96:99], v13 offset:4096
    v_mfma_f32_16x16x32_bf16 v[64:67], v[112:115], v[244:247], v[64:67]
    ds_read_b128 v[100:103], v13 offset:5120
    v_mfma_f32_16x16x32_bf16 v[44:47], v[116:119], v[180:183], v[44:47]
    v_mfma_f32_16x16x32_bf16 v[68:71], v[116:119], v[244:247], v[68:71]
    v_mfma_f32_16x16x32_bf16 v[48:51], v[120:123], v[180:183], v[48:51]
    v_mfma_f32_16x16x32_bf16 v[72:75], v[120:123], v[244:247], v[72:75]
    v_mfma_f32_16x16x32_bf16 v[52:55], v[124:127], v[180:183], v[52:55]
    v_mfma_f32_16x16x32_bf16 v[76:79], v[124:127], v[244:247], v[76:79]
    s_waitcnt vmcnt(6) lgkmcnt(0)
    s_barrier
    s_add_u32 m0, s62, 40960
    s_mov_b32 s56, 102400
    buffer_load_dwordx4 v4, s[64:67], s56 offen offset:0 sc1 lds
    buffer_load_dwordx4 v4, s[64:67], s56 offen offset:1024 sc1 lds
    buffer_load_dwordx4 v4, s[64:67], s56 offen offset:2048 sc1 lds
    v_mfma_f32_16x16x32_bf16 v[32:35], v[80:83], v[184:187], v[32:35]
    ds_read_b128 v[104:107], v13 offset:24576
    v_mfma_f32_16x16x32_bf16 v[56:59], v[80:83], v[248:251], v[56:59]
    ds_read_b128 v[108:111], v13 offset:25600
    v_mfma_f32_16x16x32_bf16 v[36:39], v[84:87], v[184:187], v[36:39]
    ds_read_b128 v[112:115], v13 offset:26624
    v_mfma_f32_16x16x32_bf16 v[60:63], v[84:87], v[248:251], v[60:63]
    ds_read_b128 v[116:119], v13 offset:27648
    v_mfma_f32_16x16x32_bf16 v[40:43], v[88:91], v[184:187], v[40:43]
    ds_read_b128 v[120:123], v13 offset:28672
    v_mfma_f32_16x16x32_bf16 v[64:67], v[88:91], v[248:251], v[64:67]
    ds_read_b128 v[124:127], v13 offset:29696
    v_mfma_f32_16x16x32_bf16 v[44:47], v[92:95], v[184:187], v[44:47]
    v_mfma_f32_16x16x32_bf16 v[68:71], v[92:95], v[248:251], v[68:71]
    v_mfma_f32_16x16x32_bf16 v[48:51], v[96:99], v[184:187], v[48:51]
    v_mfma_f32_16x16x32_bf16 v[72:75], v[96:99], v[248:251], v[72:75]
    v_mfma_f32_16x16x32_bf16 v[52:55], v[100:103], v[184:187], v[52:55]
    v_mfma_f32_16x16x32_bf16 v[76:79], v[100:103], v[248:251], v[76:79]
    s_waitcnt lgkmcnt(0)
    s_setprio 2
    s_barrier
    v_mfma_f32_16x16x32_bf16 v[56:59], v[104:107], v[252:255], v[56:59]
    v_mfma_f32_16x16x32_bf16 v[60:63], v[108:111], v[252:255], v[60:63]
    v_mfma_f32_16x16x32_bf16 v[64:67], v[112:115], v[252:255], v[64:67]
    v_mfma_f32_16x16x32_bf16 v[68:71], v[116:119], v[252:255], v[68:71]
    v_mfma_f32_16x16x32_bf16 v[72:75], v[120:123], v[252:255], v[72:75]
    v_mfma_f32_16x16x32_bf16 v[76:79], v[124:127], v[252:255], v[76:79]
    v_mfma_f32_16x16x32_bf16 v[32:35], v[104:107], v[188:191], v[32:35]
    v_mfma_f32_16x16x32_bf16 v[36:39], v[108:111], v[188:191], v[36:39]
    v_mfma_f32_16x16x32_bf16 v[40:43], v[112:115], v[188:191], v[40:43]
    v_mfma_f32_16x16x32_bf16 v[44:47], v[116:119], v[188:191], v[44:47]
    v_mfma_f32_16x16x32_bf16 v[48:51], v[120:123], v[188:191], v[48:51]
    v_mfma_f32_16x16x32_bf16 v[52:55], v[124:127], v[188:191], v[52:55]
    v_cvt_pk_bf16_f32 v56, v56, v57
    v_cvt_pk_bf16_f32 v57, v58, v59
    v_cvt_pk_bf16_f32 v58, v60, v61
    v_cvt_pk_bf16_f32 v59, v62, v63
    ds_write_b128 v7, v[56:59] offset:0
    v_cvt_pk_bf16_f32 v64, v64, v65
    v_cvt_pk_bf16_f32 v65, v66, v67
    v_cvt_pk_bf16_f32 v66, v68, v69
    v_cvt_pk_bf16_f32 v67, v70, v71
    ds_write_b128 v7, v[64:67] offset:1024
    v_cvt_pk_bf16_f32 v72, v72, v73
    v_cvt_pk_bf16_f32 v73, v74, v75
    v_cvt_pk_bf16_f32 v74, v76, v77
    v_cvt_pk_bf16_f32 v75, v78, v79
    ds_write_b128 v7, v[72:75] offset:2048
    v_cvt_pk_bf16_f32 v32, v32, v33
    v_cvt_pk_bf16_f32 v33, v34, v35
    v_cvt_pk_bf16_f32 v34, v36, v37
    v_cvt_pk_bf16_f32 v35, v38, v39
    ds_write_b128 v9, v[32:35] offset:0
    v_cvt_pk_bf16_f32 v40, v40, v41
    v_cvt_pk_bf16_f32 v41, v42, v43
    v_cvt_pk_bf16_f32 v42, v44, v45
    v_cvt_pk_bf16_f32 v43, v46, v47
    ds_write_b128 v9, v[40:43] offset:1024
    v_cvt_pk_bf16_f32 v48, v48, v49
    v_cvt_pk_bf16_f32 v49, v50, v51
    v_cvt_pk_bf16_f32 v50, v52, v53
    v_cvt_pk_bf16_f32 v51, v54, v55
    ds_write_b128 v9, v[48:51] offset:2048
    s_waitcnt lgkmcnt(0)
    s_setprio 0
    s_barrier
    s_add_u32 m0, s62, 139264
    s_mov_b32 s56, 40960
    buffer_load_dwordx4 v4, s[64:67], s56 offen offset:0 sc1 lds
    buffer_load_dwordx4 v4, s[64:67], s56 offen offset:1024 sc1 lds
    buffer_load_dwordx4 v4, s[64:67], s56 offen offset:2048 sc1 lds
    s_add_u32 m0, s62, 142336
    s_mov_b32 s56, 44032
    buffer_load_dwordx4 v4, s[64:67], s56 offen offset:0 sc1 lds
    buffer_load_dwordx4 v4, s[64:67], s56 offen offset:1024 sc1 lds
    s_lshl_b32 s12, s46, 2
    s_add_u32 s12, s12, s3
    s_mul_i32 s12, s12, 24576
    v_lshl_add_u32 v12, v1, 4, s12
    v_lshlrev_b32 v14, 4, v1
    v_add_u32 v15, 98304, v14
    s_mul_i32 s12, s46, 81920
    s_mul_i32 s13, s3, 20480
    s_add_u32 s12, s12, s13
    s_mul_i32 s13, s47, 160
    s_add_u32 s12, s12, s13
    v_mul_u32_u24 v17, 1280, v2
    v_add_u32 v17, s12, v17
    v_and_b32 v9, 1, v3
    v_lshlrev_b32 v9, 5, v9
    v_lshrrev_b32 v10, 1, v3
    v_lshl_add_u32 v9, v10, 4, v9
    v_add_u32 v18, v17, v9
    v_lshl_add_u32 v17, v3, 3, v17
    s_lshl_b32 s12, s46, 7
    s_add_u32 s12, s12, 2631680
    v_mov_b32 v8, s12
    v_lshlrev_b32 v32, 16, v22
    v_and_b32 v33, 0xffff0000, v22
    v_lshlrev_b32 v34, 16, v23
    v_and_b32 v35, 0xffff0000, v23
    v_lshlrev_b32 v36, 16, v24
    v_and_b32 v37, 0xffff0000, v24
    v_lshlrev_b32 v38, 16, v25
    v_and_b32 v39, 0xffff0000, v25
    v_lshlrev_b32 v40, 16, v26
    v_and_b32 v41, 0xffff0000, v26
    v_lshlrev_b32 v42, 16, v27
    v_and_b32 v43, 0xffff0000, v27
    v_lshlrev_b32 v44, 16, v28
    v_and_b32 v45, 0xffff0000, v28
    v_lshlrev_b32 v46, 16, v29
    v_and_b32 v47, 0xffff0000, v29
    v_lshlrev_b32 v48, 16, v30
    v_and_b32 v49, 0xffff0000, v30
    v_lshlrev_b32 v50, 16, v31
    v_and_b32 v51, 0xffff0000, v31
    s_add_u32 s52, s42, 6291456
    s_addc_u32 s53, s43, 0
    s_mov_b32 s54, 3145728
    s_mov_b32 s55, 0x20000
    ds_read_b128 v[52:55], v15 offset:0
    ds_read_b128 v[56:59], v15 offset:1024
    ds_read_b128 v[60:63], v15 offset:2048
    ds_read_b128 v[64:67], v15 offset:3072
    ds_read_b128 v[68:71], v15 offset:4096
    ds_read_b128 v[72:75], v15 offset:5120
    ds_read_b128 v[76:79], v15 offset:6144
    ds_read_b128 v[80:83], v15 offset:7168
    ds_read_b128 v[84:87], v15 offset:8192
    ds_read_b128 v[88:91], v15 offset:9216
    s_waitcnt vmcnt(0)
    s_barrier
    s_cmp_lg_u32 s8, 0
    s_cbranch_scc1 S3_OK
    v_mov_b32 v9, 1
    s_mov_b64 exec, 1
    global_atomic_add v8, v9, s[42:43] sc1
    s_mov_b64 exec, -1
    s_mov_b32 s15, 0
S3_PL:
    global_load_dword v9, v8, s[42:43] sc1
    s_waitcnt vmcnt(0)
    v_cmp_gt_u32 vcc, 8, v9
    s_add_u32 s15, s15, 1
    s_cbranch_vccz S3_OK
    s_sleep 1
    s_cmp_lt_u32 s15, 0x20000
    s_cbranch_scc1 S3_PL
S3_OK:
    s_barrier
    s_mov_b32 s57, 0
    buffer_load_dwordx4 v[128:131], v12, s[52:55], s57 offen offset:0 sc1
    buffer_load_dwordx4 v[132:135], v12, s[52:55], s57 offen offset:1024 sc1
    buffer_load_dwordx4 v[136:139], v12, s[52:55], s57 offen offset:2048 sc1
    buffer_load_dwordx4 v[140:143], v12, s[52:55], s57 offen offset:3072 sc1
    s_mov_b32 s57, 4096
    buffer_load_dwordx4 v[144:147], v12, s[52:55], s57 offen offset:0 sc1
    buffer_load_dwordx4 v[148:151], v12, s[52:55], s57 offen offset:1024 sc1
    buffer_load_dwordx4 v[152:155], v12, s[52:55], s57 offen offset:2048 sc1
    buffer_load_dwordx4 v[156:159], v12, s[52:55], s57 offen offset:3072 sc1
    s_mov_b32 s57, 8192
    buffer_load_dwordx4 v[160:163], v12, s[52:55], s57 offen offset:0 sc1
    buffer_load_dwordx4 v[164:167], v12, s[52:55], s57 offen offset:1024 sc1
    buffer_load_dwordx4 v[168:171], v12, s[52:55], s57 offen offset:2048 sc1
    buffer_load_dwordx4 v[172:175], v12, s[52:55], s57 offen offset:3072 sc1
    s_mov_b32 s57, 12288
    buffer_load_dwordx4 v[176:179], v12, s[52:55], s57 offen offset:0 sc1
    s_waitcnt vmcnt(12)
    s_waitcnt lgkmcnt(9)
    v_mfma_f32_16x16x32_bf16 v[32:35], v[52:55], v[128:131], v[32:35]
    ds_read_b128 v[92:95], v15 offset:10240
    s_waitcnt lgkmcnt(9)
    v_mfma_f32_16x16x32_bf16 v[36:39], v[56:59], v[128:131], v[36:39]
    ds_read_b128 v[96:99], v15 offset:11264
    s_waitcnt lgkmcnt(9)
    v_mfma_f32_16x16x32_bf16 v[40:43], v[60:63], v[128:131], v[40:43]
    ds_read_b128 v[100:103], v15 offset:12288
    s_waitcnt lgkmcnt(9)
    v_mfma_f32_16x16x32_bf16 v[44:47], v[64:67], v[128:131], v[44:47]
    ds_read_b128 v[104:107], v15 offset:13312
    s_waitcnt lgkmcnt(9)
    v_mfma_f32_16x16x32_bf16 v[48:51], v[68:71], v[128:131], v[48:51]
    ds_read_b128 v[108:111], v15 offset:14336
    buffer_load_dwordx4 v[180:183], v12, s[52:55], s57 offen offset:1024 sc1
    s_waitcnt vmcnt(12)
    s_waitcnt lgkmcnt(5)
    v_mfma_f32_16x16x32_bf16 v[32:35], v[72:75], v[132:135], v[32:35]
    ds_read_b128 v[52:55], v15 offset:15360
    v_mfma_f32_16x16x32_bf16 v[36:39], v[76:79], v[132:135], v[36:39]
    ds_read_b128 v[56:59], v15 offset:16384
    v_mfma_f32_16x16x32_bf16 v[40:43], v[80:83], v[132:135], v[40:43]
    ds_read_b128 v[60:63], v15 offset:17408
    v_mfma_f32_16x16x32_bf16 v[44:47], v[84:87], v[132:135], v[44:47]
    ds_read_b128 v[64:67], v15 offset:18432
    v_mfma_f32_16x16x32_bf16 v[48:51], v[88:91], v[132:135], v[48:51]
    ds_read_b128 v[68:71], v15 offset:19456
    buffer_load_dwordx4 v[184:187], v12, s[52:55], s57 offen offset:2048 sc1
    s_waitcnt vmcnt(12)
    s_waitcnt lgkmcnt(5)
    v_mfma_f32_16x16x32_bf16 v[32:35], v[92:95], v[136:139], v[32:35]
    ds_read_b128 v[72:75], v15 offset:20480
    v_mfma_f32_16x16x32_bf16 v[36:39], v[96:99], v[136:139], v[36:39]
    ds_read_b128 v[76:79], v15 offset:21504
    v_mfma_f32_16x16x32_bf16 v[40:43], v[100:103], v[136:139], v[40:43]
    ds_read_b128 v[80:83], v15 offset:22528
    v_mfma_f32_16x16x32_bf16 v[44:47], v[104:107], v[136:139], v[44:47]
    ds_read_b128 v[84:87], v15 offset:23552
    v_mfma_f32_16x16x32_bf16 v[48:51], v[108:111], v[136:139], v[48:51]
    ds_read_b128 v[88:91], v15 offset:24576
    buffer_load_dwordx4 v[188:191], v12, s[52:55], s57 offen offset:3072 sc1
    s_waitcnt vmcnt(12)
    s_waitcnt lgkmcnt(5)
    v_mfma_f32_16x16x32_bf16 v[32:35], v[52:55], v[140:143], v[32:35]
    ds_read_b128 v[92:95], v15 offset:25600
    v_mfma_f32_16x16x32_bf16 v[36:39], v[56:59], v[140:143], v[36:39]
    ds_read_b128 v[96:99], v15 offset:26624
    v_mfma_f32_16x16x32_bf16 v[40:43], v[60:63], v[140:143], v[40:43]
    ds_read_b128 v[100:103], v15 offset:27648
    v_mfma_f32_16x16x32_bf16 v[44:47], v[64:67], v[140:143], v[44:47]
    ds_read_b128 v[104:107], v15 offset:28672
    v_mfma_f32_16x16x32_bf16 v[48:51], v[68:71], v[140:143], v[48:51]
    ds_read_b128 v[108:111], v15 offset:29696
    s_mov_b32 s57, 16384
    buffer_load_dwordx4 v[192:195], v12, s[52:55], s57 offen offset:0 sc1
    s_waitcnt vmcnt(12)
    s_waitcnt lgkmcnt(5)
    v_mfma_f32_16x16x32_bf16 v[32:35], v[72:75], v[144:147], v[32:35]
    ds_read_b128 v[52:55], v15 offset:30720
    v_mfma_f32_16x16x32_bf16 v[36:39], v[76:79], v[144:147], v[36:39]
    ds_read_b128 v[56:59], v15 offset:31744
    v_mfma_f32_16x16x32_bf16 v[40:43], v[80:83], v[144:147], v[40:43]
    ds_read_b128 v[60:63], v15 offset:32768
    v_mfma_f32_16x16x32_bf16 v[44:47], v[84:87], v[144:147], v[44:47]
    ds_read_b128 v[64:67], v15 offset:33792
    v_mfma_f32_16x16x32_bf16 v[48:51], v[88:91], v[144:147], v[48:51]
    ds_read_b128 v[68:71], v15 offset:34816
    buffer_load_dwordx4 v[196:199], v12, s[52:55], s57 offen offset:1024 sc1
    s_waitcnt vmcnt(12)
    s_waitcnt lgkmcnt(5)
    v_mfma_f32_16x16x32_bf16 v[32:35], v[92:95], v[148:151], v[32:35]
    ds_read_b128 v[72:75], v15 offset:35840
    v_mfma_f32_16x16x32_bf16 v[36:39], v[96:99], v[148:151], v[36:39]
    ds_read_b128 v[76:79], v15 offset:36864
    v_mfma_f32_16x16x32_bf16 v[40:43], v[100:103], v[148:151], v[40:43]
    ds_read_b128 v[80:83], v15 offset:37888
    v_mfma_f32_16x16x32_bf16 v[44:47], v[104:107], v[148:151], v[44:47]
    ds_read_b128 v[84:87], v15 offset:38912
    v_mfma_f32_16x16x32_bf16 v[48:51], v[108:111], v[148:151], v[48:51]
    ds_read_b128 v[88:91], v15 offset:39936
    buffer_load_dwordx4 v[200:203], v12, s[52:55], s57 offen offset:2048 sc1
    s_waitcnt vmcnt(12)
    s_waitcnt lgkmcnt(5)
    v_mfma_f32_16x16x32_bf16 v[32:35], v[52:55], v[152:155], v[32:35]
    ds_read_b128 v[92:95], v15 offset:40960
    v_mfma_f32_16x16x32_bf16 v[36:39], v[56:59], v[152:155], v[36:39]
    ds_read_b128 v[96:99], v15 offset:41984
    v_mfma_f32_16x16x32_bf16 v[40:43], v[60:63], v[152:155], v[40:43]
    ds_read_b128 v[100:103], v15 offset:43008
    v_mfma_f32_16x16x32_bf16 v[44:47], v[64:67], v[152:155], v[44:47]
    ds_read_b128 v[104:107], v15 offset:44032
    v_mfma_f32_16x16x32_bf16 v[48:51], v[68:71], v[152:155], v[48:51]
    ds_read_b128 v[108:111], v15 offset:45056
    buffer_load_dwordx4 v[204:207], v12, s[52:55], s57 offen offset:3072 sc1
    s_waitcnt vmcnt(12)
    s_waitcnt lgkmcnt(5)
    v_mfma_f32_16x16x32_bf16 v[32:35], v[72:75], v[156:159], v[32:35]
    ds_read_b128 v[52:55], v15 offset:46080
    v_mfma_f32_16x16x32_bf16 v[36:39], v[76:79], v[156:159], v[36:39]
    ds_read_b128 v[56:59], v15 offset:47104
    v_mfma_f32_16x16x32_bf16 v[40:43], v[80:83], v[156:159], v[40:43]
    ds_read_b128 v[60:63], v15 offset:48128
    v_mfma_f32_16x16x32_bf16 v[44:47], v[84:87], v[156:159], v[44:47]
    ds_read_b128 v[64:67], v15 offset:49152
    v_mfma_f32_16x16x32_bf16 v[48:51], v[88:91], v[156:159], v[48:51]
    ds_read_b128 v[68:71], v15 offset:50176
    s_mov_b32 s57, 20480
    buffer_load_dwordx4 v[208:211], v12, s[52:55], s57 offen offset:0 sc1
    s_waitcnt vmcnt(12)
    s_waitcnt lgkmcnt(5)
    v_mfma_f32_16x16x32_bf16 v[32:35], v[92:95], v[160:163], v[32:35]
    ds_read_b128 v[72:75], v15 offset:51200
    v_mfma_f32_16x16x32_bf16 v[36:39], v[96:99], v[160:163], v[36:39]
    ds_read_b128 v[76:79], v15 offset:52224
    v_mfma_f32_16x16x32_bf16 v[40:43], v[100:103], v[160:163], v[40:43]
    ds_read_b128 v[80:83], v15 offset:53248
    v_mfma_f32_16x16x32_bf16 v[44:47], v[104:107], v[160:163], v[44:47]
    ds_read_b128 v[84:87], v15 offset:54272
    v_mfma_f32_16x16x32_bf16 v[48:51], v[108:111], v[160:163], v[48:51]
    ds_read_b128 v[88:91], v15 offset:55296
    buffer_load_dwordx4 v[212:215], v12, s[52:55], s57 offen offset:1024 sc1
    s_waitcnt vmcnt(12)
    s_waitcnt lgkmcnt(5)
    v_mfma_f32_16x16x32_bf16 v[32:35], v[52:55], v[164:167], v[32:35]
    ds_read_b128 v[92:95], v15 offset:56320
    v_mfma_f32_16x16x32_bf16 v[36:39], v[56:59], v[164:167], v[36:39]
    ds_read_b128 v[96:99], v15 offset:57344
    v_mfma_f32_16x16x32_bf16 v[40:43], v[60:63], v[164:167], v[40:43]
    ds_read_b128 v[100:103], v15 offset:58368
    v_mfma_f32_16x16x32_bf16 v[44:47], v[64:67], v[164:167], v[44:47]
    ds_read_b128 v[104:107], v15 offset:59392
    v_mfma_f32_16x16x32_bf16 v[48:51], v[68:71], v[164:167], v[48:51]
    ds_read_b128 v[108:111], v15 offset:60416
    buffer_load_dwordx4 v[216:219], v12, s[52:55], s57 offen offset:2048 sc1
    s_waitcnt vmcnt(12)
    s_waitcnt lgkmcnt(5)
    v_mfma_f32_16x16x32_bf16 v[32:35], v[72:75], v[168:171], v[32:35]
    ds_read_b128 v[52:55], v14 offset:0
    v_mfma_f32_16x16x32_bf16 v[36:39], v[76:79], v[168:171], v[36:39]
    ds_read_b128 v[56:59], v14 offset:1024
    v_mfma_f32_16x16x32_bf16 v[40:43], v[80:83], v[168:171], v[40:43]
    ds_read_b128 v[60:63], v14 offset:2048
    v_mfma_f32_16x16x32_bf16 v[44:47], v[84:87], v[168:171], v[44:47]
    ds_read_b128 v[64:67], v14 offset:3072
    v_mfma_f32_16x16x32_bf16 v[48:51], v[88:91], v[168:171], v[48:51]
    ds_read_b128 v[68:71], v14 offset:4096
    buffer_load_dwordx4 v[220:223], v12, s[52:55], s57 offen offset:3072 sc1
    s_waitcnt vmcnt(12)
    s_waitcnt lgkmcnt(5)
    v_mfma_f32_16x16x32_bf16 v[32:35], v[92:95], v[172:175], v[32:35]
    ds_read_b128 v[72:75], v14 offset:5120
    v_mfma_f32_16x16x32_bf16 v[36:39], v[96:99], v[172:175], v[36:39]
    ds_read_b128 v[76:79], v14 offset:6144
    v_mfma_f32_16x16x32_bf16 v[40:43], v[100:103], v[172:175], v[40:43]
    ds_read_b128 v[80:83], v14 offset:7168
    v_mfma_f32_16x16x32_bf16 v[44:47], v[104:107], v[172:175], v[44:47]
    ds_read_b128 v[84:87], v14 offset:8192
    v_mfma_f32_16x16x32_bf16 v[48:51], v[108:111], v[172:175], v[48:51]
    ds_read_b128 v[88:91], v14 offset:9216
    s_waitcnt vmcnt(11)
    s_waitcnt lgkmcnt(5)
    v_mfma_f32_16x16x32_bf16 v[32:35], v[52:55], v[176:179], v[32:35]
    ds_read_b128 v[92:95], v14 offset:10240
    v_mfma_f32_16x16x32_bf16 v[36:39], v[56:59], v[176:179], v[36:39]
    ds_read_b128 v[96:99], v14 offset:11264
    v_mfma_f32_16x16x32_bf16 v[40:43], v[60:63], v[176:179], v[40:43]
    ds_read_b128 v[100:103], v14 offset:12288
    v_mfma_f32_16x16x32_bf16 v[44:47], v[64:67], v[176:179], v[44:47]
    ds_read_b128 v[104:107], v14 offset:13312
    v_mfma_f32_16x16x32_bf16 v[48:51], v[68:71], v[176:179], v[48:51]
    ds_read_b128 v[108:111], v14 offset:14336
    s_waitcnt vmcnt(10)
    s_waitcnt lgkmcnt(5)
    v_mfma_f32_16x16x32_bf16 v[32:35], v[72:75], v[180:183], v[32:35]
    ds_read_b128 v[52:55], v14 offset:15360
    v_mfma_f32_16x16x32_bf16 v[36:39], v[76:79], v[180:183], v[36:39]
    ds_read_b128 v[56:59], v14 offset:16384
    v_mfma_f32_16x16x32_bf16 v[40:43], v[80:83], v[180:183], v[40:43]
    ds_read_b128 v[60:63], v14 offset:17408
    v_mfma_f32_16x16x32_bf16 v[44:47], v[84:87], v[180:183], v[44:47]
    ds_read_b128 v[64:67], v14 offset:18432
    v_mfma_f32_16x16x32_bf16 v[48:51], v[88:91], v[180:183], v[48:51]
    ds_read_b128 v[68:71], v14 offset:19456
    s_waitcnt vmcnt(9)
    s_waitcnt lgkmcnt(5)
    v_mfma_f32_16x16x32_bf16 v[32:35], v[92:95], v[184:187], v[32:35]
    ds_read_b128 v[72:75], v14 offset:20480
    v_mfma_f32_16x16x32_bf16 v[36:39], v[96:99], v[184:187], v[36:39]
    ds_read_b128 v[76:79], v14 offset:21504
    v_mfma_f32_16x16x32_bf16 v[40:43], v[100:103], v[184:187], v[40:43]
    ds_read_b128 v[80:83], v14 offset:22528
    v_mfma_f32_16x16x32_bf16 v[44:47], v[104:107], v[184:187], v[44:47]
    ds_read_b128 v[84:87], v14 offset:23552
    v_mfma_f32_16x16x32_bf16 v[48:51], v[108:111], v[184:187], v[48:51]
    ds_read_b128 v[88:91], v14 offset:24576
    s_waitcnt vmcnt(8)
    s_waitcnt lgkmcnt(5)
    v_mfma_f32_16x16x32_bf16 v[32:35], v[52:55], v[188:191], v[32:35]
    ds_read_b128 v[92:95], v14 offset:25600
    v_mfma_f32_16x16x32_bf16 v[36:39], v[56:59], v[188:191], v[36:39]
    ds_read_b128 v[96:99], v14 offset:26624
    v_mfma_f32_16x16x32_bf16 v[40:43], v[60:63], v[188:191], v[40:43]
    ds_read_b128 v[100:103], v14 offset:27648
    v_mfma_f32_16x16x32_bf16 v[44:47], v[64:67], v[188:191], v[44:47]
    ds_read_b128 v[104:107], v14 offset:28672
    v_mfma_f32_16x16x32_bf16 v[48:51], v[68:71], v[188:191], v[48:51]
    ds_read_b128 v[108:111], v14 offset:29696
    s_waitcnt vmcnt(7)
    s_waitcnt lgkmcnt(5)
    v_mfma_f32_16x16x32_bf16 v[32:35], v[72:75], v[192:195], v[32:35]
    ds_read_b128 v[52:55], v14 offset:30720
    v_mfma_f32_16x16x32_bf16 v[36:39], v[76:79], v[192:195], v[36:39]
    ds_read_b128 v[56:59], v14 offset:31744
    v_mfma_f32_16x16x32_bf16 v[40:43], v[80:83], v[192:195], v[40:43]
    ds_read_b128 v[60:63], v14 offset:32768
    v_mfma_f32_16x16x32_bf16 v[44:47], v[84:87], v[192:195], v[44:47]
    ds_read_b128 v[64:67], v14 offset:33792
    v_mfma_f32_16x16x32_bf16 v[48:51], v[88:91], v[192:195], v[48:51]
    ds_read_b128 v[68:71], v14 offset:34816
    s_waitcnt vmcnt(6)
    s_waitcnt lgkmcnt(5)
    v_mfma_f32_16x16x32_bf16 v[32:35], v[92:95], v[196:199], v[32:35]
    ds_read_b128 v[72:75], v14 offset:35840
    v_mfma_f32_16x16x32_bf16 v[36:39], v[96:99], v[196:199], v[36:39]
    ds_read_b128 v[76:79], v14 offset:36864
    v_mfma_f32_16x16x32_bf16 v[40:43], v[100:103], v[196:199], v[40:43]
    ds_read_b128 v[80:83], v14 offset:37888
    v_mfma_f32_16x16x32_bf16 v[44:47], v[104:107], v[196:199], v[44:47]
    ds_read_b128 v[84:87], v14 offset:38912
    v_mfma_f32_16x16x32_bf16 v[48:51], v[108:111], v[196:199], v[48:51]
    ds_read_b128 v[88:91], v14 offset:39936
    s_waitcnt vmcnt(5)
    s_waitcnt lgkmcnt(5)
    v_mfma_f32_16x16x32_bf16 v[32:35], v[52:55], v[200:203], v[32:35]
    ds_read_b128 v[92:95], v14 offset:40960
    v_mfma_f32_16x16x32_bf16 v[36:39], v[56:59], v[200:203], v[36:39]
    ds_read_b128 v[96:99], v14 offset:41984
    v_mfma_f32_16x16x32_bf16 v[40:43], v[60:63], v[200:203], v[40:43]
    ds_read_b128 v[100:103], v14 offset:43008
    v_mfma_f32_16x16x32_bf16 v[44:47], v[64:67], v[200:203], v[44:47]
    ds_read_b128 v[104:107], v14 offset:44032
    v_mfma_f32_16x16x32_bf16 v[48:51], v[68:71], v[200:203], v[48:51]
    ds_read_b128 v[108:111], v14 offset:45056
    s_waitcnt vmcnt(4)
    s_waitcnt lgkmcnt(5)
    v_mfma_f32_16x16x32_bf16 v[32:35], v[72:75], v[204:207], v[32:35]
    ds_read_b128 v[52:55], v14 offset:46080
    v_mfma_f32_16x16x32_bf16 v[36:39], v[76:79], v[204:207], v[36:39]
    ds_read_b128 v[56:59], v14 offset:47104
    v_mfma_f32_16x16x32_bf16 v[40:43], v[80:83], v[204:207], v[40:43]
    ds_read_b128 v[60:63], v14 offset:48128
    v_mfma_f32_16x16x32_bf16 v[44:47], v[84:87], v[204:207], v[44:47]
    ds_read_b128 v[64:67], v14 offset:49152
    v_mfma_f32_16x16x32_bf16 v[48:51], v[88:91], v[204:207], v[48:51]
    ds_read_b128 v[68:71], v14 offset:50176
    s_waitcnt vmcnt(3)
    s_waitcnt lgkmcnt(5)
    v_mfma_f32_16x16x32_bf16 v[32:35], v[92:95], v[208:211], v[32:35]
    ds_read_b128 v[72:75], v14 offset:51200
    v_mfma_f32_16x16x32_bf16 v[36:39], v[96:99], v[208:211], v[36:39]
    ds_read_b128 v[76:79], v14 offset:52224
    v_mfma_f32_16x16x32_bf16 v[40:43], v[100:103], v[208:211], v[40:43]
    ds_read_b128 v[80:83], v14 offset:53248
    v_mfma_f32_16x16x32_bf16 v[44:47], v[104:107], v[208:211], v[44:47]
    ds_read_b128 v[84:87], v14 offset:54272
    v_mfma_f32_16x16x32_bf16 v[48:51], v[108:111], v[208:211], v[48:51]
    ds_read_b128 v[88:91], v14 offset:55296
    s_waitcnt vmcnt(2)
    s_waitcnt lgkmcnt(5)
    v_mfma_f32_16x16x32_bf16 v[32:35], v[52:55], v[212:215], v[32:35]
    ds_read_b128 v[92:95], v14 offset:56320
    v_mfma_f32_16x16x32_bf16 v[36:39], v[56:59], v[212:215], v[36:39]
    ds_read_b128 v[96:99], v14 offset:57344
    v_mfma_f32_16x16x32_bf16 v[40:43], v[60:63], v[212:215], v[40:43]
    ds_read_b128 v[100:103], v14 offset:58368
    v_mfma_f32_16x16x32_bf16 v[44:47], v[64:67], v[212:215], v[44:47]
    ds_read_b128 v[104:107], v14 offset:59392
    v_mfma_f32_16x16x32_bf16 v[48:51], v[68:71], v[212:215], v[48:51]
    ds_read_b128 v[108:111], v14 offset:60416
    s_waitcnt vmcnt(1)
    s_waitcnt lgkmcnt(5)
    v_mfma_f32_16x16x32_bf16 v[32:35], v[72:75], v[216:219], v[32:35]
    v_mfma_f32_16x16x32_bf16 v[36:39], v[76:79], v[216:219], v[36:39]
    v_mfma_f32_16x16x32_bf16 v[40:43], v[80:83], v[216:219], v[40:43]
    v_mfma_f32_16x16x32_bf16 v[44:47], v[84:87], v[216:219], v[44:47]
    v_mfma_f32_16x16x32_bf16 v[48:51], v[88:91], v[216:219], v[48:51]
    s_waitcnt vmcnt(0)
    s_waitcnt lgkmcnt(0)
    v_mfma_f32_16x16x32_bf16 v[32:35], v[92:95], v[220:223], v[32:35]
    v_mfma_f32_16x16x32_bf16 v[36:39], v[96:99], v[220:223], v[36:39]
    v_mfma_f32_16x16x32_bf16 v[40:43], v[100:103], v[220:223], v[40:43]
    v_mfma_f32_16x16x32_bf16 v[44:47], v[104:107], v[220:223], v[44:47]
    v_mfma_f32_16x16x32_bf16 v[48:51], v[108:111], v[220:223], v[48:51]
    s_nop 3
    v_cvt_pk_bf16_f32 v112, v32, v33
    v_cvt_pk_bf16_f32 v113, v34, v35
    v_cvt_pk_bf16_f32 v114, v36, v37
    v_cvt_pk_bf16_f32 v115, v38, v39
    s_nop 0
    v_permlane16_swap_b32 v112, v114
    v_permlane16_swap_b32 v113, v115
    global_store_dwordx4 v18, v[112:115], s[44:45] offset:0
    v_cvt_pk_bf16_f32 v116, v40, v41
    v_cvt_pk_bf16_f32 v117, v42, v43
    v_cvt_pk_bf16_f32 v118, v44, v45
    v_cvt_pk_bf16_f32 v119, v46, v47
    s_nop 0
    v_permlane16_swap_b32 v116, v118
    v_permlane16_swap_b32 v117, v119
    global_store_dwordx4 v18, v[116:119], s[44:45] offset:64
    v_cvt_pk_bf16_f32 v120, v48, v49
    v_cvt_pk_bf16_f32 v121, v50, v51
    global_store_dwordx2 v17, v[120:121], s[44:45] offset:128
    s_endpgm
K4_Y:
    s_setprio 0
    s_lshl_b32 s12, s46, 2
    s_add_u32 s12, s12, s3
    s_mul_i32 s12, s12, 24576
    s_mul_i32 s13, s47, 3072
    s_add_u32 s12, s12, s13
    s_add_u32 s12, s12, 6291456
    v_lshl_add_u32 v10, v1, 4, s12
    s_mov_b32 s58, 0x00003f80
    s_mov_b32 s59, 0x3f800000
    v_min_u32 v14, 23, v1
    v_lshl_add_u32 v14, v14, 7, s12
    s_waitcnt vmcnt(6) lgkmcnt(0)
    s_barrier
    v_mfma_f32_16x16x32_bf16 v[32:35], v[80:83], v[128:131], 0
    ds_read_b128 v[104:107], v12 offset:24576
    v_mfma_f32_16x16x32_bf16 v[56:59], v[80:83], v[192:195], 0
    ds_read_b128 v[108:111], v12 offset:25600
    v_mfma_f32_16x16x32_bf16 v[36:39], v[84:87], v[128:131], 0
    ds_read_b128 v[112:115], v12 offset:26624
    v_mfma_f32_16x16x32_bf16 v[60:63], v[84:87], v[192:195], 0
    ds_read_b128 v[116:119], v12 offset:27648
    v_mfma_f32_16x16x32_bf16 v[40:43], v[88:91], v[128:131], 0
    ds_read_b128 v[120:123], v12 offset:28672
    v_mfma_f32_16x16x32_bf16 v[64:67], v[88:91], v[192:195], 0
    ds_read_b128 v[124:127], v12 offset:29696
    v_mfma_f32_16x16x32_bf16 v[44:47], v[92:95], v[128:131], 0
    v_mfma_f32_16x16x32_bf16 v[68:71], v[92:95], v[192:195], 0
    v_mfma_f32_16x16x32_bf16 v[48:51], v[96:99], v[128:131], 0
    v_mfma_f32_16x16x32_bf16 v[72:75], v[96:99], v[192:195], 0
    v_mfma_f32_16x16x32_bf16 v[52:55], v[100:103], v[128:131], 0
    v_mfma_f32_16x16x32_bf16 v[76:79], v[100:103], v[192:195], 0
    s_add_u32 m0, s61, 0
    s_mov_b32 s57, 24576
    buffer_load_dwordx4 v6, s[52:55], s57 offen sc1 lds
    buffer_load_dwordx4 v6, s[52:55], s57 offen offset:1024 sc1 lds
    buffer_load_dwordx4 v6, s[52:55], s57 offen offset:2048 sc1 lds
    s_waitcnt vmcnt(6) lgkmcnt(0)
    s_barrier
    v_mfma_f32_16x16x32_bf16 v[32:35], v[104:107], v[132:135], v[32:35]
    ds_read_b128 v[80:83], v13 offset:0
    v_mfma_f32_16x16x32_bf16 v[56:59], v[104:107], v[196:199], v[56:59]
    ds_read_b128 v[84:87], v13 offset:1024
    v_mfma_f32_16x16x32_bf16 v[36:39], v[108:111], v[132:135], v[36:39]
    ds_read_b128 v[88:91], v13 offset:2048
    v_mfma_f32_16x16x32_bf16 v[60:63], v[108:111], v[196:199], v[60:63]
    ds_read_b128 v[92:95], v13 offset:3072
    v_mfma_f32_16x16x32_bf16 v[40:43], v[112:115], v[132:135], v[40:43]
    ds_read_b128 v[96:99], v13 offset:4096
    v_mfma_f32_16x16x32_bf16 v[64:67], v[112:115], v[196:199], v[64:67]
    ds_read_b128 v[100:103], v13 offset:5120
    v_mfma_f32_16x16x32_bf16 v[44:47], v[116:119], v[132:135], v[44:47]
    v_mfma_f32_16x16x32_bf16 v[68:71], v[116:119], v[196:199], v[68:71]
    v_mfma_f32_16x16x32_bf16 v[48:51], v[120:123], v[132:135], v[48:51]
    v_mfma_f32_16x16x32_bf16 v[72:75], v[120:123], v[196:199], v[72:75]
    v_mfma_f32_16x16x32_bf16 v[52:55], v[124:127], v[132:135], v[52:55]
    v_mfma_f32_16x16x32_bf16 v[76:79], v[124:127], v[196:199], v[76:79]
    s_add_u32 m0, s61, 24576
    s_mov_b32 s57, 30720
    buffer_load_dwordx4 v6, s[52:55], s57 offen sc1 lds
    buffer_load_dwordx4 v6, s[52:55], s57 offen offset:1024 sc1 lds
    buffer_load_dwordx4 v6, s[52:55], s57 offen offset:2048 sc1 lds
    s_waitcnt vmcnt(6) lgkmcnt(0)
    s_barrier
    v_mfma_f32_16x16x32_bf16 v[32:35], v[80:83], v[136:139], v[32:35]
    ds_read_b128 v[104:107], v13 offset:24576
    v_mfma_f32_16x16x32_bf16 v[56:59], v[80:83], v[200:203], v[56:59]
    ds_read_b128 v[108:111], v13 offset:25600
    v_mfma_f32_16x16x32_bf16 v[36:39], v[84:87], v[136:139], v[36:39]
    ds_read_b128 v[112:115], v13 offset:26624
    v_mfma_f32_16x16x32_bf16 v[60:63], v[84:87], v[200:203], v[60:63]
    ds_read_b128 v[116:119], v13 offset:27648
    v_mfma_f32_16x16x32_bf16 v[40:43], v[88:91], v[136:139], v[40:43]
    ds_read_b128 v[120:123], v13 offset:28672
    v_mfma_f32_16x16x32_bf16 v[64:67], v[88:91], v[200:203], v[64:67]
    ds_read_b128 v[124:127], v13 offset:29696
    v_mfma_f32_16x16x32_bf16 v[44:47], v[92:95], v[136:139], v[44:47]
    v_mfma_f32_16x16x32_bf16 v[68:71], v[92:95], v[200:203], v[68:71]
    v_mfma_f32_16x16x32_bf16 v[48:51], v[96:99], v[136:139], v[48:51]
    v_mfma_f32_16x16x32_bf16 v[72:75], v[96:99], v[200:203], v[72:75]
    v_mfma_f32_16x16x32_bf16 v[52:55], v[100:103], v[136:139], v[52:55]
    v_mfma_f32_16x16x32_bf16 v[76:79], v[100:103], v[200:203], v[76:79]
    s_add_u32 m0, s61, 49152
    s_mov_b32 s57, 36864
    buffer_load_dwordx4 v6, s[52:55], s57 offen sc1 lds
    buffer_load_dwordx4 v6, s[52:55], s57 offen offset:1024 sc1 lds
    buffer_load_dwordx4 v6, s[52:55], s57 offen offset:2048 sc1 lds
    s_waitcnt vmcnt(6) lgkmcnt(0)
    s_barrier
    v_mfma_f32_16x16x32_bf16 v[32:35], v[104:107], v[140:143], v[32:35]
    ds_read_b128 v[80:83], v12 offset:0
    v_mfma_f32_16x16x32_bf16 v[56:59], v[104:107], v[204:207], v[56:59]
    ds_read_b128 v[84:87], v12 offset:1024
    v_mfma_f32_16x16x32_bf16 v[36:39], v[108:111], v[140:143], v[36:39]
    ds_read_b128 v[88:91], v12 offset:2048
    v_mfma_f32_16x16x32_bf16 v[60:63], v[108:111], v[204:207], v[60:63]
    ds_read_b128 v[92:95], v12 offset:3072
    v_mfma_f32_16x16x32_bf16 v[40:43], v[112:115], v[140:143], v[40:43]
    ds_read_b128 v[96:99], v12 offset:4096
    v_mfma_f32_16x16x32_bf16 v[64:67], v[112:115], v[204:207], v[64:67]
    ds_read_b128 v[100:103], v12 offset:5120
    v_mfma_f32_16x16x32_bf16 v[44:47], v[116:119], v[140:143], v[44:47]
    v_mfma_f32_16x16x32_bf16 v[68:71], v[116:119], v[204:207], v[68:71]
    v_mfma_f32_16x16x32_bf16 v[48:51], v[120:123], v[140:143], v[48:51]
    v_mfma_f32_16x16x32_bf16 v[72:75], v[120:123], v[204:207], v[72:75]
    v_mfma_f32_16x16x32_bf16 v[52:55], v[124:127], v[140:143], v[52:55]
    v_mfma_f32_16x16x32_bf16 v[76:79], v[124:127], v[204:207], v[76:79]
    s_add_u32 m0, s61, 73728
    s_mov_b32 s57, 43008
    buffer_load_dwordx4 v6, s[52:55], s57 offen sc1 lds
    buffer_load_dwordx4 v6, s[52:55], s57 offen offset:1024 sc1 lds
    buffer_load_dwordx4 v6, s[52:55], s57 offen offset:2048 sc1 lds
    s_waitcnt vmcnt(6) lgkmcnt(0)
    s_barrier
    v_mfma_f32_16x16x32_bf16 v[32:35], v[80:83], v[144:147], v[32:35]
    ds_read_b128 v[104:107], v12 offset:24576
    v_mfma_f32_16x16x32_bf16 v[56:59], v[80:83], v[208:211], v[56:59]
    ds_read_b128 v[108:111], v12 offset:25600
    v_mfma_f32_16x16x32_bf16 v[36:39], v[84:87], v[144:147], v[36:39]
    ds_read_b128 v[112:115], v12 offset:26624
    v_mfma_f32_16x16x32_bf16 v[60:63], v[84:87], v[208:211], v[60:63]
    ds_read_b128 v[116:119], v12 offset:27648
    v_mfma_f32_16x16x32_bf16 v[40:43], v[88:91], v[144:147], v[40:43]
    ds_read_b128 v[120:123], v12 offset:28672
    v_mfma_f32_16x16x32_bf16 v[64:67], v[88:91], v[208:211], v[64:67]
    ds_read_b128 v[124:127], v12 offset:29696
    v_mfma_f32_16x16x32_bf16 v[44:47], v[92:95], v[144:147], v[44:47]
    v_mfma_f32_16x16x32_bf16 v[68:71], v[92:95], v[208:211], v[68:71]
    v_mfma_f32_16x16x32_bf16 v[48:51], v[96:99], v[144:147], v[48:51]
    v_mfma_f32_16x16x32_bf16 v[72:75], v[96:99], v[208:211], v[72:75]
    v_mfma_f32_16x16x32_bf16 v[52:55], v[100:103], v[144:147], v[52:55]
    v_mfma_f32_16x16x32_bf16 v[76:79], v[100:103], v[208:211], v[76:79]
    s_add_u32 m0, s61, 0
    s_mov_b32 s57, 49152
    buffer_load_dwordx4 v6, s[52:55], s57 offen sc1 lds
    buffer_load_dwordx4 v6, s[52:55], s57 offen offset:1024 sc1 lds
    buffer_load_dwordx4 v6, s[52:55], s57 offen offset:2048 sc1 lds
    s_waitcnt vmcnt(6) lgkmcnt(0)
    s_barrier
    v_mfma_f32_16x16x32_bf16 v[32:35], v[104:107], v[148:151], v[32:35]
    ds_read_b128 v[80:83], v13 offset:0
    v_mfma_f32_16x16x32_bf16 v[56:59], v[104:107], v[212:215], v[56:59]
    ds_read_b128 v[84:87], v13 offset:1024
    v_mfma_f32_16x16x32_bf16 v[36:39], v[108:111], v[148:151], v[36:39]
    ds_read_b128 v[88:91], v13 offset:2048
    v_mfma_f32_16x16x32_bf16 v[60:63], v[108:111], v[212:215], v[60:63]
    ds_read_b128 v[92:95], v13 offset:3072
    v_mfma_f32_16x16x32_bf16 v[40:43], v[112:115], v[148:151], v[40:43]
    ds_read_b128 v[96:99], v13 offset:4096
    v_mfma_f32_16x16x32_bf16 v[64:67], v[112:115], v[212:215], v[64:67]
    ds_read_b128 v[100:103], v13 offset:5120
    v_mfma_f32_16x16x32_bf16 v[44:47], v[116:119], v[148:151], v[44:47]
    v_mfma_f32_16x16x32_bf16 v[68:71], v[116:119], v[212:215], v[68:71]
    v_mfma_f32_16x16x32_bf16 v[48:51], v[120:123], v[148:151], v[48:51]
    v_mfma_f32_16x16x32_bf16 v[72:75], v[120:123], v[212:215], v[72:75]
    v_mfma_f32_16x16x32_bf16 v[52:55], v[124:127], v[148:151], v[52:55]
    v_mfma_f32_16x16x32_bf16 v[76:79], v[124:127], v[212:215], v[76:79]
    s_add_u32 m0, s61, 24576
    s_mov_b32 s57, 55296
    buffer_load_dwordx4 v6, s[52:55], s57 offen sc1 lds
    buffer_load_dwordx4 v6, s[52:55], s57 offen offset:1024 sc1 lds
    buffer_load_dwordx4 v6, s[52:55], s57 offen offset:2048 sc1 lds
    s_waitcnt vmcnt(6) lgkmcnt(0)
    s_barrier
    v_mfma_f32_16x16x32_bf16 v[32:35], v[80:83], v[152:155], v[32:35]
    ds_read_b128 v[104:107], v13 offset:24576
    v_mfma_f32_16x16x32_bf16 v[56:59], v[80:83], v[216:219], v[56:59]
    ds_read_b128 v[108:111], v13 offset:25600
    v_mfma_f32_16x16x32_bf16 v[36:39], v[84:87], v[152:155], v[36:39]
    ds_read_b128 v[112:115], v13 offset:26624
    v_mfma_f32_16x16x32_bf16 v[60:63], v[84:87], v[216:219], v[60:63]
    ds_read_b128 v[116:119], v13 offset:27648
    v_mfma_f32_16x16x32_bf16 v[40:43], v[88:91], v[152:155], v[40:43]
    ds_read_b128 v[120:123], v13 offset:28672
    v_mfma_f32_16x16x32_bf16 v[64:67], v[88:91], v[216:219], v[64:67]
    ds_read_b128 v[124:127], v13 offset:29696
    v_mfma_f32_16x16x32_bf16 v[44:47], v[92:95], v[152:155], v[44:47]
    v_mfma_f32_16x16x32_bf16 v[68:71], v[92:95], v[216:219], v[68:71]
    v_mfma_f32_16x16x32_bf16 v[48:51], v[96:99], v[152:155], v[48:51]
    v_mfma_f32_16x16x32_bf16 v[72:75], v[96:99], v[216:219], v[72:75]
    v_mfma_f32_16x16x32_bf16 v[52:55], v[100:103], v[152:155], v[52:55]
    v_mfma_f32_16x16x32_bf16 v[76:79], v[100:103], v[216:219], v[76:79]
    s_add_u32 m0, s61, 49152
    s_mov_b32 s57, 61440
    buffer_load_dwordx4 v6, s[52:55], s57 offen sc1 lds
    buffer_load_dwordx4 v6, s[52:55], s57 offen offset:1024 sc1 lds
    buffer_load_dwordx4 v6, s[52:55], s57 offen offset:2048 sc1 lds
    s_waitcnt vmcnt(6) lgkmcnt(0)
    s_barrier
    v_mfma_f32_16x16x32_bf16 v[32:35], v[104:107], v[156:159], v[32:35]
    ds_read_b128 v[80:83], v12 offset:0
    v_mfma_f32_16x16x32_bf16 v[56:59], v[104:107], v[220:223], v[56:59]
    ds_read_b128 v[84:87], v12 offset:1024
    v_mfma_f32_16x16x32_bf16 v[36:39], v[108:111], v[156:159], v[36:39]
    ds_read_b128 v[88:91], v12 offset:2048
    v_mfma_f32_16x16x32_bf16 v[60:63], v[108:111], v[220:223], v[60:63]
    ds_read_b128 v[92:95], v12 offset:3072
    v_mfma_f32_16x16x32_bf16 v[40:43], v[112:115], v[156:159], v[40:43]
    ds_read_b128 v[96:99], v12 offset:4096
    v_mfma_f32_16x16x32_bf16 v[64:67], v[112:115], v[220:223], v[64:67]
    ds_read_b128 v[100:103], v12 offset:5120
    v_mfma_f32_16x16x32_bf16 v[44:47], v[116:119], v[156:159], v[44:47]
    v_mfma_f32_16x16x32_bf16 v[68:71], v[116:119], v[220:223], v[68:71]
    v_mfma_f32_16x16x32_bf16 v[48:51], v[120:123], v[156:159], v[48:51]
    v_mfma_f32_16x16x32_bf16 v[72:75], v[120:123], v[220:223], v[72:75]
    v_mfma_f32_16x16x32_bf16 v[52:55], v[124:127], v[156:159], v[52:55]
    v_mfma_f32_16x16x32_bf16 v[76:79], v[124:127], v[220:223], v[76:79]
    s_add_u32 m0, s61, 73728
    s_mov_b32 s57, 67584
    buffer_load_dwordx4 v6, s[52:55], s57 offen sc1 lds
    buffer_load_dwordx4 v6, s[52:55], s57 offen offset:1024 sc1 lds
    buffer_load_dwordx4 v6, s[52:55], s57 offen offset:2048 sc1 lds
    s_waitcnt vmcnt(6) lgkmcnt(0)
    s_barrier
    v_mfma_f32_16x16x32_bf16 v[32:35], v[80:83], v[160:163], v[32:35]
    ds_read_b128 v[104:107], v12 offset:24576
    v_mfma_f32_16x16x32_bf16 v[56:59], v[80:83], v[224:227], v[56:59]
    ds_read_b128 v[108:111], v12 offset:25600
    v_mfma_f32_16x16x32_bf16 v[36:39], v[84:87], v[160:163], v[36:39]
    ds_read_b128 v[112:115], v12 offset:26624
    v_mfma_f32_16x16x32_bf16 v[60:63], v[84:87], v[224:227], v[60:63]
    ds_read_b128 v[116:119], v12 offset:27648
    v_mfma_f32_16x16x32_bf16 v[40:43], v[88:91], v[160:163], v[40:43]
    ds_read_b128 v[120:123], v12 offset:28672
    v_mfma_f32_16x16x32_bf16 v[64:67], v[88:91], v[224:227], v[64:67]
    ds_read_b128 v[124:127], v12 offset:29696
    v_mfma_f32_16x16x32_bf16 v[44:47], v[92:95], v[160:163], v[44:47]
    v_mfma_f32_16x16x32_bf16 v[68:71], v[92:95], v[224:227], v[68:71]
    v_mfma_f32_16x16x32_bf16 v[48:51], v[96:99], v[160:163], v[48:51]
    v_mfma_f32_16x16x32_bf16 v[72:75], v[96:99], v[224:227], v[72:75]
    v_mfma_f32_16x16x32_bf16 v[52:55], v[100:103], v[160:163], v[52:55]
    v_mfma_f32_16x16x32_bf16 v[76:79], v[100:103], v[224:227], v[76:79]
    s_add_u32 m0, s61, 0
    s_mov_b32 s57, 73728
    buffer_load_dwordx4 v6, s[52:55], s57 offen sc1 lds
    buffer_load_dwordx4 v6, s[52:55], s57 offen offset:1024 sc1 lds
    buffer_load_dwordx4 v6, s[52:55], s57 offen offset:2048 sc1 lds
    s_waitcnt vmcnt(6) lgkmcnt(0)
    s_barrier
    v_mfma_f32_16x16x32_bf16 v[32:35], v[104:107], v[164:167], v[32:35]
    ds_read_b128 v[80:83], v13 offset:0
    v_mfma_f32_16x16x32_bf16 v[56:59], v[104:107], v[228:231], v[56:59]
    ds_read_b128 v[84:87], v13 offset:1024
    v_mfma_f32_16x16x32_bf16 v[36:39], v[108:111], v[164:167], v[36:39]
    ds_read_b128 v[88:91], v13 offset:2048
    v_mfma_f32_16x16x32_bf16 v[60:63], v[108:111], v[228:231], v[60:63]
    ds_read_b128 v[92:95], v13 offset:3072
    v_mfma_f32_16x16x32_bf16 v[40:43], v[112:115], v[164:167], v[40:43]
    ds_read_b128 v[96:99], v13 offset:4096
    v_mfma_f32_16x16x32_bf16 v[64:67], v[112:115], v[228:231], v[64:67]
    ds_read_b128 v[100:103], v13 offset:5120
    v_mfma_f32_16x16x32_bf16 v[44:47], v[116:119], v[164:167], v[44:47]
    v_mfma_f32_16x16x32_bf16 v[68:71], v[116:119], v[228:231], v[68:71]
    v_mfma_f32_16x16x32_bf16 v[48:51], v[120:123], v[164:167], v[48:51]
    v_mfma_f32_16x16x32_bf16 v[72:75], v[120:123], v[228:231], v[72:75]
    v_mfma_f32_16x16x32_bf16 v[52:55], v[124:127], v[164:167], v[52:55]
    v_mfma_f32_16x16x32_bf16 v[76:79], v[124:127], v[228:231], v[76:79]
    s_add_u32 m0, s61, 24576
    s_mov_b32 s57, 79872
    buffer_load_dwordx4 v6, s[52:55], s57 offen sc1 lds
    buffer_load_dwordx4 v6, s[52:55], s57 offen offset:1024 sc1 lds
    buffer_load_dwordx4 v6, s[52:55], s57 offen offset:2048 sc1 lds
    s_waitcnt vmcnt(6) lgkmcnt(0)
    s_barrier
    v_mfma_f32_16x16x32_bf16 v[32:35], v[80:83], v[168:171], v[32:35]
    ds_read_b128 v[104:107], v13 offset:24576
    v_mfma_f32_16x16x32_bf16 v[56:59], v[80:83], v[232:235], v[56:59]
    ds_read_b128 v[108:111], v13 offset:25600
    v_mfma_f32_16x16x32_bf16 v[36:39], v[84:87], v[168:171], v[36:39]
    ds_read_b128 v[112:115], v13 offset:26624
    v_mfma_f32_16x16x32_bf16 v[60:63], v[84:87], v[232:235], v[60:63]
    ds_read_b128 v[116:119], v13 offset:27648
    v_mfma_f32_16x16x32_bf16 v[40:43], v[88:91], v[168:171], v[40:43]
    ds_read_b128 v[120:123], v13 offset:28672
    v_mfma_f32_16x16x32_bf16 v[64:67], v[88:91], v[232:235], v[64:67]
    ds_read_b128 v[124:127], v13 offset:29696
    v_mfma_f32_16x16x32_bf16 v[44:47], v[92:95], v[168:171], v[44:47]
    v_mfma_f32_16x16x32_bf16 v[68:71], v[92:95], v[232:235], v[68:71]
    v_mfma_f32_16x16x32_bf16 v[48:51], v[96:99], v[168:171], v[48:51]
    v_mfma_f32_16x16x32_bf16 v[72:75], v[96:99], v[232:235], v[72:75]
    v_mfma_f32_16x16x32_bf16 v[52:55], v[100:103], v[168:171], v[52:55]
    v_mfma_f32_16x16x32_bf16 v[76:79], v[100:103], v[232:235], v[76:79]
    s_add_u32 m0, s61, 49152
    s_mov_b32 s57, 86016
    buffer_load_dwordx4 v6, s[52:55], s57 offen sc1 lds
    buffer_load_dwordx4 v6, s[52:55], s57 offen offset:1024 sc1 lds
    buffer_load_dwordx4 v6, s[52:55], s57 offen offset:2048 sc1 lds
    s_waitcnt vmcnt(6) lgkmcnt(0)
    s_barrier
    v_mfma_f32_16x16x32_bf16 v[32:35], v[104:107], v[172:175], v[32:35]
    ds_read_b128 v[80:83], v12 offset:0
    v_mfma_f32_16x16x32_bf16 v[56:59], v[104:107], v[236:239], v[56:59]
    ds_read_b128 v[84:87], v12 offset:1024
    v_mfma_f32_16x16x32_bf16 v[36:39], v[108:111], v[172:175], v[36:39]
    ds_read_b128 v[88:91], v12 offset:2048
    v_mfma_f32_16x16x32_bf16 v[60:63], v[108:111], v[236:239], v[60:63]
    ds_read_b128 v[92:95], v12 offset:3072
    v_mfma_f32_16x16x32_bf16 v[40:43], v[112:115], v[172:175], v[40:43]
    ds_read_b128 v[96:99], v12 offset:4096
    v_mfma_f32_16x16x32_bf16 v[64:67], v[112:115], v[236:239], v[64:67]
    ds_read_b128 v[100:103], v12 offset:5120
    v_mfma_f32_16x16x32_bf16 v[44:47], v[116:119], v[172:175], v[44:47]
    v_mfma_f32_16x16x32_bf16 v[68:71], v[116:119], v[236:239], v[68:71]
    v_mfma_f32_16x16x32_bf16 v[48:51], v[120:123], v[172:175], v[48:51]
    v_mfma_f32_16x16x32_bf16 v[72:75], v[120:123], v[236:239], v[72:75]
    v_mfma_f32_16x16x32_bf16 v[52:55], v[124:127], v[172:175], v[52:55]
    v_mfma_f32_16x16x32_bf16 v[76:79], v[124:127], v[236:239], v[76:79]
    s_add_u32 m0, s61, 73728
    s_mov_b32 s57, 92160
    buffer_load_dwordx4 v6, s[52:55], s57 offen sc1 lds
    buffer_load_dwordx4 v6, s[52:55], s57 offen offset:1024 sc1 lds
    buffer_load_dwordx4 v6, s[52:55], s57 offen offset:2048 sc1 lds
    s_waitcnt vmcnt(6) lgkmcnt(0)
    s_barrier
    v_mfma_f32_16x16x32_bf16 v[32:35], v[80:83], v[176:179], v[32:35]
    ds_read_b128 v[104:107], v12 offset:24576
    v_mfma_f32_16x16x32_bf16 v[56:59], v[80:83], v[240:243], v[56:59]
    ds_read_b128 v[108:111], v12 offset:25600
    v_mfma_f32_16x16x32_bf16 v[36:39], v[84:87], v[176:179], v[36:39]
    ds_read_b128 v[112:115], v12 offset:26624
    v_mfma_f32_16x16x32_bf16 v[60:63], v[84:87], v[240:243], v[60:63]
    ds_read_b128 v[116:119], v12 offset:27648
    v_mfma_f32_16x16x32_bf16 v[40:43], v[88:91], v[176:179], v[40:43]
    ds_read_b128 v[120:123], v12 offset:28672
    v_mfma_f32_16x16x32_bf16 v[64:67], v[88:91], v[240:243], v[64:67]
    ds_read_b128 v[124:127], v12 offset:29696
    v_mfma_f32_16x16x32_bf16 v[44:47], v[92:95], v[176:179], v[44:47]
    v_mfma_f32_16x16x32_bf16 v[68:71], v[92:95], v[240:243], v[68:71]
    v_mfma_f32_16x16x32_bf16 v[48:51], v[96:99], v[176:179], v[48:51]
    v_mfma_f32_16x16x32_bf16 v[72:75], v[96:99], v[240:243], v[72:75]
    v_mfma_f32_16x16x32_bf16 v[52:55], v[100:103], v[176:179], v[52:55]
    v_mfma_f32_16x16x32_bf16 v[76:79], v[100:103], v[240:243], v[76:79]
    s_add_u32 m0, s62, 3072
    s_mov_b32 s56, 64512
    buffer_load_dwordx4 v4, s[64:67], s56 offen offset:0 sc1 lds
    buffer_load_dwordx4 v4, s[64:67], s56 offen offset:1024 sc1 lds
    s_waitcnt vmcnt(5) lgkmcnt(0)
    s_barrier
    v_mfma_f32_16x16x32_bf16 v[32:35], v[104:107], v[180:183], v[32:35]
    ds_read_b128 v[80:83], v13 offset:0
    v_mfma_f32_16x16x32_bf16 v[56:59], v[104:107], v[244:247], v[56:59]
    ds_read_b128 v[84:87], v13 offset:1024
    v_mfma_f32_16x16x32_bf16 v[36:39], v[108:111], v[180:183], v[36:39]
    ds_read_b128 v[88:91], v13 offset:2048
    v_mfma_f32_16x16x32_bf16 v[60:63], v[108:111], v[244:247], v[60:63]
    ds_read_b128 v[92:95], v13 offset:3072
    v_mfma_f32_16x16x32_bf16 v[40:43], v[112:115], v[180:183], v[40:43]
    ds_read_b128 v[96:99], v13 offset:4096
    v_mfma_f32_16x16x32_bf16 v[64:67], v[112:115], v[244:247], v[64:67]
    ds_read_b128 v[100:103], v13 offset:5120
    v_mfma_f32_16x16x32_bf16 v[44:47], v[116:119], v[180:183], v[44:47]
    v_mfma_f32_16x16x32_bf16 v[68:71], v[116:119], v[244:247], v[68:71]
    v_mfma_f32_16x16x32_bf16 v[48:51], v[120:123], v[180:183], v[48:51]
    v_mfma_f32_16x16x32_bf16 v[72:75], v[120:123], v[244:247], v[72:75]
    v_mfma_f32_16x16x32_bf16 v[52:55], v[124:127], v[180:183], v[52:55]
    v_mfma_f32_16x16x32_bf16 v[76:79], v[124:127], v[244:247], v[76:79]
    s_add_u32 m0, s62, 23552
    s_mov_b32 s56, 84992
    buffer_load_dwordx4 v4, s[64:67], s56 offen offset:0 sc1 lds
    buffer_load_dwordx4 v4, s[64:67], s56 offen offset:1024 sc1 lds
    s_waitcnt vmcnt(4) lgkmcnt(0)
    s_barrier
    v_mfma_f32_16x16x32_bf16 v[32:35], v[80:83], v[184:187], v[32:35]
    ds_read_b128 v[104:107], v13 offset:24576
    v_mfma_f32_16x16x32_bf16 v[56:59], v[80:83], v[248:251], v[56:59]
    ds_read_b128 v[108:111], v13 offset:25600
    v_mfma_f32_16x16x32_bf16 v[36:39], v[84:87], v[184:187], v[36:39]
    ds_read_b128 v[112:115], v13 offset:26624
    v_mfma_f32_16x16x32_bf16 v[60:63], v[84:87], v[248:251], v[60:63]
    ds_read_b128 v[116:119], v13 offset:27648
    v_mfma_f32_16x16x32_bf16 v[40:43], v[88:91], v[184:187], v[40:43]
    ds_read_b128 v[120:123], v13 offset:28672
    v_mfma_f32_16x16x32_bf16 v[64:67], v[88:91], v[248:251], v[64:67]
    ds_read_b128 v[124:127], v13 offset:29696
    v_mfma_f32_16x16x32_bf16 v[44:47], v[92:95], v[184:187], v[44:47]
    v_mfma_f32_16x16x32_bf16 v[68:71], v[92:95], v[248:251], v[68:71]
    v_mfma_f32_16x16x32_bf16 v[48:51], v[96:99], v[184:187], v[48:51]
    v_mfma_f32_16x16x32_bf16 v[72:75], v[96:99], v[248:251], v[72:75]
    v_mfma_f32_16x16x32_bf16 v[52:55], v[100:103], v[184:187], v[52:55]
    v_mfma_f32_16x16x32_bf16 v[76:79], v[100:103], v[248:251], v[76:79]
    s_add_u32 m0, s62, 44032
    s_mov_b32 s56, 105472
    buffer_load_dwordx4 v4, s[64:67], s56 offen offset:0 sc1 lds
    buffer_load_dwordx4 v4, s[64:67], s56 offen offset:1024 sc1 lds
    s_waitcnt lgkmcnt(0)
    s_barrier
    v_mfma_f32_16x16x32_bf16 v[56:59], v[104:107], v[252:255], v[56:59]
    v_mfma_f32_16x16x32_bf16 v[60:63], v[108:111], v[252:255], v[60:63]
    v_mfma_f32_16x16x32_bf16 v[64:67], v[112:115], v[252:255], v[64:67]
    v_mfma_f32_16x16x32_bf16 v[68:71], v[116:119], v[252:255], v[68:71]
    v_mfma_f32_16x16x32_bf16 v[72:75], v[120:123], v[252:255], v[72:75]
    v_mfma_f32_16x16x32_bf16 v[76:79], v[124:127], v[252:255], v[76:79]
    v_mfma_f32_16x16x32_bf16 v[32:35], v[104:107], v[188:191], v[32:35]
    v_mfma_f32_16x16x32_bf16 v[36:39], v[108:111], v[188:191], v[36:39]
    v_mfma_f32_16x16x32_bf16 v[40:43], v[112:115], v[188:191], v[40:43]
    v_mfma_f32_16x16x32_bf16 v[44:47], v[116:119], v[188:191], v[44:47]
    v_cvt_pk_bf16_f32 v56, v56, v57
    v_cvt_pk_bf16_f32 v57, v58, v59
    v_cvt_pk_bf16_f32 v58, v60, v61
    v_cvt_pk_bf16_f32 v59, v62, v63
    ds_write_b128 v7, v[56:59] offset:6144
    v_mfma_f32_16x16x32_bf16 v[48:51], v[120:123], v[188:191], v[48:51]
    v_cvt_pk_bf16_f32 v64, v64, v65
    v_cvt_pk_bf16_f32 v65, v66, v67
    v_cvt_pk_bf16_f32 v66, v68, v69
    v_cvt_pk_bf16_f32 v67, v70, v71
    ds_write_b128 v7, v[64:67] offset:7168
    v_mfma_f32_16x16x32_bf16 v[52:55], v[124:127], v[188:191], v[52:55]
    v_cvt_pk_bf16_f32 v72, v72, v73
    v_cvt_pk_bf16_f32 v73, v74, v75
    v_cvt_pk_bf16_f32 v74, v76, v77
    v_cvt_pk_bf16_f32 v75, v78, v79
    ds_write_b128 v7, v[72:75] offset:8192
    v_lshlrev_b32 v80, 16, v20
    v_and_b32 v81, 0xffff0000, v20
    v_lshlrev_b32 v82, 16, v21
    v_and_b32 v83, 0xffff0000, v21
    v_lshlrev_b32 v84, 16, v22
    v_and_b32 v85, 0xffff0000, v22
    v_lshlrev_b32 v86, 16, v23
    v_and_b32 v87, 0xffff0000, v23
    v_lshlrev_b32 v88, 16, v24
    v_and_b32 v89, 0xffff0000, v24
    v_lshlrev_b32 v90, 16, v25
    v_and_b32 v91, 0xffff0000, v25
    v_lshlrev_b32 v92, 16, v26
    v_and_b32 v93, 0xffff0000, v26
    v_lshlrev_b32 v94, 16, v27
    v_and_b32 v95, 0xffff0000, v27
    v_lshlrev_b32 v96, 16, v28
    v_and_b32 v97, 0xffff0000, v28
    v_lshlrev_b32 v98, 16, v29
    v_and_b32 v99, 0xffff0000, v29
    v_lshlrev_b32 v100, 16, v30
    v_and_b32 v101, 0xffff0000, v30
    v_lshlrev_b32 v102, 16, v31
    v_and_b32 v103, 0xffff0000, v31
    v_pk_add_f32 v[32:33], v[32:33], v[16:17] op_sel:[0,0] op_sel_hi:[1,0]
    v_pk_add_f32 v[34:35], v[34:35], v[16:17] op_sel:[0,0] op_sel_hi:[1,0]
    v_pk_add_f32 v[36:37], v[36:37], v[16:17] op_sel:[0,0] op_sel_hi:[1,0]
    v_pk_add_f32 v[38:39], v[38:39], v[16:17] op_sel:[0,0] op_sel_hi:[1,0]
    v_pk_add_f32 v[40:41], v[40:41], v[16:17] op_sel:[0,0] op_sel_hi:[1,0]
    v_pk_add_f32 v[42:43], v[42:43], v[16:17] op_sel:[0,0] op_sel_hi:[1,0]
    v_pk_add_f32 v[44:45], v[44:45], v[16:17] op_sel:[0,0] op_sel_hi:[1,0]
    v_pk_add_f32 v[46:47], v[46:47], v[16:17] op_sel:[0,0] op_sel_hi:[1,0]
    v_pk_add_f32 v[48:49], v[48:49], v[16:17] op_sel:[0,0] op_sel_hi:[1,0]
    v_pk_add_f32 v[50:51], v[50:51], v[16:17] op_sel:[0,0] op_sel_hi:[1,0]
    v_pk_add_f32 v[52:53], v[52:53], v[16:17] op_sel:[0,0] op_sel_hi:[1,0]
    v_pk_add_f32 v[54:55], v[54:55], v[16:17] op_sel:[0,0] op_sel_hi:[1,0]
    s_waitcnt lgkmcnt(0)
    s_setprio 3
    s_barrier
    ds_read_b128 v[128:131], v9 offset:0
    ds_read_b128 v[132:135], v9 offset:3072
    ds_read_b128 v[136:139], v9 offset:6144
    ds_read_b128 v[140:143], v9 offset:1024
    ds_read_b128 v[144:147], v9 offset:4096
    ds_read_b128 v[148:151], v9 offset:7168
    ds_read_b128 v[152:155], v9 offset:2048
    ds_read_b128 v[156:159], v9 offset:5120
    ds_read_b128 v[160:163], v9 offset:8192
    s_waitcnt lgkmcnt(8)
    v_dot2_f32_bf16 v32, v128, s58, v32
    v_dot2_f32_bf16 v33, v128, s59, v33
    v_dot2_f32_bf16 v34, v129, s58, v34
    v_dot2_f32_bf16 v35, v129, s59, v35
    v_dot2_f32_bf16 v36, v130, s58, v36
    v_dot2_f32_bf16 v37, v130, s59, v37
    v_dot2_f32_bf16 v38, v131, s58, v38
    v_dot2_f32_bf16 v39, v131, s59, v39
    s_waitcnt lgkmcnt(7)
    v_dot2_f32_bf16 v32, v132, s58, v32
    v_dot2_f32_bf16 v33, v132, s59, v33
    v_dot2_f32_bf16 v34, v133, s58, v34
    v_dot2_f32_bf16 v35, v133, s59, v35
    v_dot2_f32_bf16 v36, v134, s58, v36
    v_dot2_f32_bf16 v37, v134, s59, v37
    v_dot2_f32_bf16 v38, v135, s58, v38
    v_dot2_f32_bf16 v39, v135, s59, v39
    s_waitcnt lgkmcnt(6)
    v_dot2_f32_bf16 v32, v136, s58, v32
    v_dot2_f32_bf16 v33, v136, s59, v33
    v_dot2_f32_bf16 v34, v137, s58, v34
    v_dot2_f32_bf16 v35, v137, s59, v35
    v_dot2_f32_bf16 v36, v138, s58, v36
    v_dot2_f32_bf16 v37, v138, s59, v37
    v_dot2_f32_bf16 v38, v139, s58, v38
    v_dot2_f32_bf16 v39, v139, s59, v39
    v_pk_mul_f32 v[32:33], v[32:33], v[80:81]
    v_pk_mul_f32 v[34:35], v[34:35], v[82:83]
    v_pk_mul_f32 v[36:37], v[36:37], v[84:85]
    v_pk_mul_f32 v[38:39], v[38:39], v[86:87]
    v_cvt_pk_bf16_f32 v104, v32, v33
    v_cvt_pk_bf16_f32 v105, v34, v35
    v_cvt_pk_bf16_f32 v106, v36, v37
    v_cvt_pk_bf16_f32 v107, v38, v39
    global_store_dwordx4 v10, v[104:107], s[42:43] offset:0 sc1
    s_waitcnt lgkmcnt(5)
    v_dot2_f32_bf16 v40, v140, s58, v40
    v_dot2_f32_bf16 v41, v140, s59, v41
    v_dot2_f32_bf16 v42, v141, s58, v42
    v_dot2_f32_bf16 v43, v141, s59, v43
    v_dot2_f32_bf16 v44, v142, s58, v44
    v_dot2_f32_bf16 v45, v142, s59, v45
    v_dot2_f32_bf16 v46, v143, s58, v46
    v_dot2_f32_bf16 v47, v143, s59, v47
    s_waitcnt lgkmcnt(4)
    v_dot2_f32_bf16 v40, v144, s58, v40
    v_dot2_f32_bf16 v41, v144, s59, v41
    v_dot2_f32_bf16 v42, v145, s58, v42
    v_dot2_f32_bf16 v43, v145, s59, v43
    v_dot2_f32_bf16 v44, v146, s58, v44
    v_dot2_f32_bf16 v45, v146, s59, v45
    v_dot2_f32_bf16 v46, v147, s58, v46
    v_dot2_f32_bf16 v47, v147, s59, v47
    s_waitcnt lgkmcnt(3)
    v_dot2_f32_bf16 v40, v148, s58, v40
    v_dot2_f32_bf16 v41, v148, s59, v41
    v_dot2_f32_bf16 v42, v149, s58, v42
    v_dot2_f32_bf16 v43, v149, s59, v43
    v_dot2_f32_bf16 v44, v150, s58, v44
    v_dot2_f32_bf16 v45, v150, s59, v45
    v_dot2_f32_bf16 v46, v151, s58, v46
    v_dot2_f32_bf16 v47, v151, s59, v47
    v_pk_mul_f32 v[40:41], v[40:41], v[88:89]
    v_pk_mul_f32 v[42:43], v[42:43], v[90:91]
    v_pk_mul_f32 v[44:45], v[44:45], v[92:93]
    v_pk_mul_f32 v[46:47], v[46:47], v[94:95]
    v_cvt_pk_bf16_f32 v108, v40, v41
    v_cvt_pk_bf16_f32 v109, v42, v43
    v_cvt_pk_bf16_f32 v110, v44, v45
    v_cvt_pk_bf16_f32 v111, v46, v47
    global_store_dwordx4 v10, v[108:111], s[42:43] offset:1024 sc1
    s_waitcnt lgkmcnt(2)
    v_dot2_f32_bf16 v48, v152, s58, v48
    v_dot2_f32_bf16 v49, v152, s59, v49
    v_dot2_f32_bf16 v50, v153, s58, v50
    v_dot2_f32_bf16 v51, v153, s59, v51
    v_dot2_f32_bf16 v52, v154, s58, v52
    v_dot2_f32_bf16 v53, v154, s59, v53
    v_dot2_f32_bf16 v54, v155, s58, v54
    v_dot2_f32_bf16 v55, v155, s59, v55
    s_waitcnt lgkmcnt(1)
    v_dot2_f32_bf16 v48, v156, s58, v48
    v_dot2_f32_bf16 v49, v156, s59, v49
    v_dot2_f32_bf16 v50, v157, s58, v50
    v_dot2_f32_bf16 v51, v157, s59, v51
    v_dot2_f32_bf16 v52, v158, s58, v52
    v_dot2_f32_bf16 v53, v158, s59, v53
    v_dot2_f32_bf16 v54, v159, s58, v54
    v_dot2_f32_bf16 v55, v159, s59, v55
    s_waitcnt lgkmcnt(0)
    v_dot2_f32_bf16 v48, v160, s58, v48
    v_dot2_f32_bf16 v49, v160, s59, v49
    v_dot2_f32_bf16 v50, v161, s58, v50
    v_dot2_f32_bf16 v51, v161, s59, v51
    v_dot2_f32_bf16 v52, v162, s58, v52
    v_dot2_f32_bf16 v53, v162, s59, v53
    v_dot2_f32_bf16 v54, v163, s58, v54
    v_dot2_f32_bf16 v55, v163, s59, v55
    v_pk_mul_f32 v[48:49], v[48:49], v[96:97]
    v_pk_mul_f32 v[50:51], v[50:51], v[98:99]
    v_pk_mul_f32 v[52:53], v[52:53], v[100:101]
    v_pk_mul_f32 v[54:55], v[54:55], v[102:103]
    v_cvt_pk_bf16_f32 v112, v48, v49
    v_cvt_pk_bf16_f32 v113, v50, v51
    v_cvt_pk_bf16_f32 v114, v52, v53
    v_cvt_pk_bf16_f32 v115, v54, v55
    global_store_dwordx4 v10, v[112:115], s[42:43] offset:2048 sc1
    s_waitcnt vmcnt(0)
    s_setprio 0
    s_barrier
    s_barrier
K_END:
    s_endpgm
CODE_END:
    s_endpgm
.p2align 7
.type BANDTAB,@object
BANDTAB:
.long 0x0, 0x0, 0x0, 0x0
.long 0x0, 0x0, 0x0, 0x0
.long 0x0, 0x0, 0x0, 0x0
.long 0x0, 0x0, 0x0, 0x0
.long 0x0, 0x0, 0x0, 0x0
.long 0x0, 0x0, 0x0, 0x0
.long 0x0, 0x0, 0x0, 0x0
.long 0x0, 0x0, 0x0, 0x0
.long 0x0, 0x0, 0x0, 0x0
.long 0x0, 0x0, 0x0, 0x0
.long 0x0, 0x0, 0x0, 0x0
.long 0x0, 0x0, 0x0, 0x0
.long 0x0, 0x0, 0x0, 0x0
.long 0x0, 0x0, 0x0, 0x0
.long 0x0, 0x0, 0x0, 0x0
.long 0x0, 0x0, 0x0, 0x0
.long 0x0, 0x0, 0x3c003c00, 0x3c003c00
.long 0x0, 0x0, 0x3c000000, 0x3c003c00
.long 0x0, 0x0, 0x0, 0x3c003c00
.long 0x0, 0x0, 0x0, 0x3c000000
.long 0x0, 0x0, 0x0, 0x0
.long 0x0, 0x0, 0x0, 0x0
.long 0x0, 0x0, 0x0, 0x0
.long 0x0, 0x0, 0x0, 0x0
.long 0x0, 0x0, 0x0, 0x0
.long 0x0, 0x0, 0x0, 0x0
.long 0x0, 0x0, 0x0, 0x0
.long 0x0, 0x0, 0x0, 0x0
.long 0x0, 0x0, 0x0, 0x0
.long 0x0, 0x0, 0x0, 0x0
.long 0x0, 0x0, 0x0, 0x0
.long 0x0, 0x0, 0x0, 0x0
.long 0x3c00, 0x0, 0x0, 0x0
.long 0x3c003c00, 0x0, 0x0, 0x0
.long 0x3c003c00, 0x3c00, 0x0, 0x0
.long 0x3c003c00, 0x3c003c00, 0x0, 0x0
.long 0x3c003c00, 0x3c003c00, 0x3c00, 0x0
.long 0x3c000000, 0x3c003c00, 0x3c003c00, 0x0
.long 0x0, 0x3c003c00, 0x3c003c00, 0x3c00
.long 0x0, 0x3c000000, 0x3c003c00, 0x3c003c00
.long 0x0, 0x0, 0x3c003c00, 0x3c003c00
.long 0x0, 0x0, 0x3c000000, 0x3c003c00
.long 0x0, 0x0, 0x0, 0x3c003c00
.long 0x0, 0x0, 0x0, 0x3c000000
.long 0x0, 0x0, 0x0, 0x0
.long 0x0, 0x0, 0x0, 0x0
.long 0x0, 0x0, 0x0, 0x0
.long 0x0, 0x0, 0x0, 0x0
.long 0x0, 0x0, 0x0, 0x0
.long 0x0, 0x0, 0x0, 0x0
.long 0x0, 0x0, 0x0, 0x0
.long 0x0, 0x0, 0x0, 0x0
.long 0x0, 0x0, 0x0, 0x0
.long 0x0, 0x0, 0x0, 0x0
.long 0x0, 0x0, 0x0, 0x0
.long 0x0, 0x0, 0x0, 0x0
.long 0x3c00, 0x0, 0x0, 0x0
.long 0x3c003c00, 0x0, 0x0, 0x0
.long 0x3c003c00, 0x3c00, 0x0, 0x0
.long 0x3c003c00, 0x3c003c00, 0x0, 0x0
.long 0x3c003c00, 0x3c003c00, 0x3c00, 0x0
.long 0x3c000000, 0x3c003c00, 0x3c003c00, 0x0
.long 0x0, 0x3c003c00, 0x3c003c00, 0x3c00
.long 0x0, 0x3c000000, 0x3c003c00, 0x3c003c00
.long 0x0, 0x0, 0x3c000000, 0x3c003c00
.long 0x0, 0x0, 0x0, 0x3c003c00
.long 0x0, 0x0, 0x0, 0x3c000000
.long 0x0, 0x0, 0x0, 0x0
.long 0x0, 0x0, 0x0, 0x0
.long 0x0, 0x0, 0x0, 0x0
.long 0x0, 0x0, 0x0, 0x0
.long 0x0, 0x0, 0x0, 0x0
.long 0x0, 0x0, 0x0, 0x0
.long 0x0, 0x0, 0x0, 0x0
.long 0x0, 0x0, 0x0, 0x0
.long 0x0, 0x0, 0x0, 0x0
.long 0x0, 0x0, 0x0, 0x0
.long 0x0, 0x0, 0x0, 0x0
.long 0x0, 0x0, 0x0, 0x0
.long 0x0, 0x0, 0x0, 0x0
.long 0x3c003c00, 0x3c003c00, 0x0, 0x0
.long 0x3c003c00, 0x3c003c00, 0x3c00, 0x0
.long 0x3c003c00, 0x3c003c00, 0x3c003c00, 0x0
.long 0x3c003c00, 0x3c003c00, 0x3c003c00, 0x3c00
.long 0x3c000000, 0x3c003c00, 0x3c003c00, 0x3c003c00
.long 0x0, 0x3c003c00, 0x3c003c00, 0x3c003c00
.long 0x0, 0x3c000000, 0x3c003c00, 0x3c003c00
.long 0x0, 0x0, 0x3c003c00, 0x3c003c00
.long 0x0, 0x0, 0x3c000000, 0x3c003c00
.long 0x0, 0x0, 0x0, 0x3c003c00
.long 0x0, 0x0, 0x0, 0x3c000000
.long 0x0, 0x0, 0x0, 0x0
.long 0x0, 0x0, 0x0, 0x0
.long 0x0, 0x0, 0x0, 0x0
.long 0x0, 0x0, 0x0, 0x0
.long 0x0, 0x0, 0x0, 0x0
.long 0x0, 0x0, 0x0, 0x0
.long 0x0, 0x0, 0x0, 0x0
.long 0x0, 0x0, 0x0, 0x0
.long 0x0, 0x0, 0x0, 0x0
.long 0x0, 0x0, 0x0, 0x0
.long 0x3c00, 0x0, 0x0, 0x0
.long 0x3c003c00, 0x0, 0x0, 0x0
.long 0x3c003c00, 0x3c00, 0x0, 0x0
.long 0x3c003c00, 0x3c003c00, 0x0, 0x0
.long 0x3c003c00, 0x3c003c00, 0x3c00, 0x0
.long 0x3c003c00, 0x3c003c00, 0x3c003c00, 0x0
.long 0x3c003c00, 0x3c003c00, 0x3c003c00, 0x3c00
.long 0x3c000000, 0x3c003c00, 0x3c003c00, 0x3c003c00
.long 0x0, 0x3c003c00, 0x3c003c00, 0x3c003c00
.long 0x0, 0x3c000000, 0x3c003c00, 0x3c003c00
.long 0x0, 0x0, 0x3c003c00, 0x3c003c00
.long 0x0, 0x0, 0x0, 0x0
.long 0x0, 0x0, 0x0, 0x0
.long 0x0, 0x0, 0x0, 0x0
.long 0x0, 0x0, 0x0, 0x0
.long 0x0, 0x0, 0x0, 0x0
.long 0x0, 0x0, 0x0, 0x0
.long 0x0, 0x0, 0x0, 0x0
.long 0x0, 0x0, 0x0, 0x0
.long 0x0, 0x0, 0x0, 0x0
.long 0x0, 0x0, 0x0, 0x0
.long 0x0, 0x0, 0x0, 0x0
.long 0x0, 0x0, 0x0, 0x0
.long 0x0, 0x0, 0x0, 0x0
.long 0x3c00, 0x0, 0x0, 0x0
.long 0x3c003c00, 0x0, 0x0, 0x0
.long 0x3c003c00, 0x3c00, 0x0, 0x0
.long 0x3c000000, 0x3c003c00, 0x3c00, 0x0
.long 0x0, 0x3c003c00, 0x3c003c00, 0x0
.long 0x0, 0x3c000000, 0x3c003c00, 0x3c00
.long 0x0, 0x0, 0x3c003c00, 0x3c003c00
.long 0x0, 0x0, 0x3c000000, 0x3c003c00
.long 0x0, 0x0, 0x0, 0x3c003c00
.long 0x0, 0x0, 0x0, 0x3c000000
.long 0x0, 0x0, 0x0, 0x0
.long 0x0, 0x0, 0x0, 0x0
.long 0x0, 0x0, 0x0, 0x0
.long 0x0, 0x0, 0x0, 0x0
.long 0x0, 0x0, 0x0, 0x0
.long 0x0, 0x0, 0x0, 0x0
.long 0x0, 0x0, 0x0, 0x0
.long 0x0, 0x0, 0x0, 0x0
.long 0x0, 0x0, 0x0, 0x0
.long 0x0, 0x0, 0x0, 0x0
.long 0x0, 0x0, 0x0, 0x0
.long 0x0, 0x0, 0x0, 0x0
.long 0x0, 0x0, 0x0, 0x0
.long 0x3c00, 0x0, 0x0, 0x0
.long 0x3c003c00, 0x0, 0x0, 0x0
.long 0x3c003c00, 0x3c00, 0x0, 0x0
.long 0x3c003c00, 0x3c003c00, 0x0, 0x0
.long 0x3c000000, 0x3c003c00, 0x3c00, 0x0
.long 0x0, 0x3c003c00, 0x3c003c00, 0x0
.long 0x0, 0x3c000000, 0x3c003c00, 0x3c00
.long 0x0, 0x0, 0x3c003c00, 0x3c003c00
.long 0x0, 0x0, 0x3c000000, 0x3c003c00
.long 0x0, 0x0, 0x0, 0x3c003c00
.long 0x0, 0x0, 0x0, 0x3c000000
.long 0x0, 0x0, 0x0, 0x0
.long 0x0, 0x0, 0x0, 0x0
.long 0x0, 0x0, 0x0, 0x0
.long 0x0, 0x0, 0x0, 0x0
.long 0x0, 0x0, 0x0, 0x0
.long 0x0, 0x0, 0x0, 0x0
.long 0x0, 0x0, 0x0, 0x0
.long 0x0, 0x0, 0x0, 0x0
.long 0x0, 0x0, 0x0, 0x0
.long 0x0, 0x0, 0x0, 0x0
.long 0x0, 0x0, 0x0, 0x0
.long 0x0, 0x0, 0x0, 0x0
.long 0x0, 0x0, 0x0, 0x0
.long 0x3c00, 0x0, 0x0, 0x0
.long 0x3c003c00, 0x0, 0x0, 0x0
.long 0x3c003c00, 0x3c00, 0x0, 0x0
.long 0x3c003c00, 0x3c003c00, 0x0, 0x0
.long 0x0, 0x0, 0x0, 0x0
.long 0x0, 0x0, 0x0, 0x0
.long 0x0, 0x0, 0x0, 0x0
.long 0x0, 0x0, 0x0, 0x0
.long 0x0, 0x0, 0x0, 0x0
.long 0x0, 0x0, 0x0, 0x0
.long 0x0, 0x0, 0x0, 0x0
.long 0x0, 0x0, 0x0, 0x0
.long 0x0, 0x0, 0x0, 0x0
.long 0x0, 0x0, 0x0, 0x0
.long 0x0, 0x0, 0x0, 0x0
.long 0x0, 0x0, 0x0, 0x0
.long 0x0, 0x0, 0x0, 0x0
.long 0x0, 0x0, 0x0, 0x0
.long 0x0, 0x0, 0x0, 0x0
.long 0x0, 0x0, 0x0, 0x0
.size BANDTAB, 3072
.section .rodata,"a"
.p2align 6
.amdhsa_kernel sequential_preLN__ssm_conv_s4d__mixer_gmlp__prompt_kernel
  .amdhsa_next_free_vgpr 256
  .amdhsa_next_free_sgpr 102
  .amdhsa_accum_offset 256
  .amdhsa_group_segment_fixed_size 0
  .amdhsa_kernarg_size 120
  .amdhsa_user_sgpr_count 2
  .amdhsa_user_sgpr_kernarg_segment_ptr 1
  .amdhsa_system_sgpr_workgroup_id_x 1
.end_amdhsa_kernel
```
